```python
import torch

def _softmax(x, axis=-1):
    return torch.softmax(x, dim=axis)
def _gelu(x):
    return torch.nn.functional.gelu(x, approximate="tanh")
def _silu(x):
    return torch.nn.functional.silu(x)
def _sigmoid(x):
    return torch.sigmoid(x)
def _layernorm(x, axis=-1, eps=1e-5):
    m = x.mean(dim=axis, keepdim=True)
    v = x.var(dim=axis, keepdim=True, unbiased=False)
    return (x - m) / torch.sqrt(v + eps)
def _scatter_add(tgt, idx, src, axis=0):
    return tgt.clone().index_add_(axis, idx, src)
def _segment_sum(src, seg, n):
    out = torch.zeros((n,) + src.shape[1:], dtype=src.dtype)
    return out.index_add_(0, seg, src)
def _pad(x, pw):
    flat = tuple(v for pair in reversed(pw) for v in pair)
    return torch.nn.functional.pad(x, flat)

kernel_name = 'recurrent_scan__ssm_conv_h3__mixer_s_mlp__prompt'

def setup_inputs():

    _w = (lambda a: (lambda t: t.to(torch.bfloat16) if t.is_floating_point() else t)(torch.as_tensor(a)))
    def _A_setup():
        B, S, D = 1, 2048, 576
        ks = 4
        return {
            "q": _w((lambda *s: torch.randn(*s, dtype=torch.bfloat16) * 0.05)(B, S, D)),
            "k": _w((lambda *s: torch.randn(*s, dtype=torch.bfloat16) * 0.2)(B, S, D)),
            "v": _w((lambda *s: torch.randn(*s, dtype=torch.bfloat16) * 0.2)(B, S, D)),
            "shift_k": _w((lambda *s: torch.randn(*s, dtype=torch.bfloat16) * 0.2)(D, ks) * 0.5),
            "ssm_k": _w((lambda *s: torch.randn(*s, dtype=torch.bfloat16) * 0.2)(D, S) * (1.0 / S ** 0.5)),
            "ssm_D": _w((lambda *s: torch.randn(*s, dtype=torch.bfloat16) * 0.2)(D)),
        }
    _A_in = _A_setup()

    def _B_setup():
        B, S, D, F = 1, 2048, 576, 4608
        return {
            "x":  _w((lambda *s: torch.randn(*s, dtype=torch.bfloat16) * 0.05)(B, S, D)),
            "w1": _w((lambda *s: torch.randn(*s, dtype=torch.bfloat16) * 3.2)(D, D) * (D ** -0.5)),
            "w2": _w((lambda *s: torch.randn(*s, dtype=torch.bfloat16) * 3.2)(D, D) * (D ** -0.5)),
            "w3": _w((lambda *s: torch.randn(*s, dtype=torch.bfloat16) * 3.2)(D, F) * (D ** -0.5)),
            "w4": _w((lambda *s: torch.randn(*s, dtype=torch.bfloat16) * 3.2)(F, D) * (F ** -0.5)),
        }
    _B_in = _B_setup()

    return {
        "A_q": _A_in["q"],
        "A_k": _A_in["k"],
        "A_v": _A_in["v"],
        "A_shift_k": _A_in["shift_k"],
        "A_ssm_k": _A_in["ssm_k"],
        "A_ssm_D": _A_in["ssm_D"],
        "B_x": _B_in["x"],
        "B_w1": _B_in["w1"],
        "B_w2": _B_in["w2"],
        "B_w3": _B_in["w3"],
        "B_w4": _B_in["w4"],
    }

def reference(A_q, A_k, A_v, A_shift_k, A_ssm_k, A_ssm_D, B_x, B_w1, B_w2, B_w3, B_w4):
    def _A_ref(q, k, v, shift_k, ssm_k, ssm_D):
        B, S, D = q.shape
        ks = shift_k.shape[-1]
        k_pad = _pad(k, ((0, 0), (ks - 1, 0), (0, 0)))
        k_shift = torch.zeros_like(k)
        for t in range(ks):
            k_shift = k_shift + k_pad[:, t:t + S, :] * shift_k[:, ks - 1 - t][None, None, :]
        kv = k_shift * v
        L = 2 * S
        kv_pad = _pad(kv, ((0, 0), (0, S), (0, 0)))
        kf_pad = _pad(ssm_k, ((0, 0), (0, S)))
        kv_f = (lambda x, axes=(-2,-1): torch.fft.rfft2(x.float(), dim=axes))(kv_pad[:, None, :, :], axes=(1, 2))
        kf_f = (lambda x, axes=(-2,-1): torch.fft.rfft2(x.float(), dim=axes))(kf_pad[:, None, :], axes=(1, 2))
        kf_f = (lambda x, *d: x.permute(*d))(kf_f, 1, 2, 0)
        y_f = kv_f * kf_f[None, :, :, :]
        y = (lambda x, s, axes=(-2,-1): torch.fft.irfft2(x, s=s, dim=axes).to(torch.bfloat16))(y_f, (1, L), axes=(1, 2))[:, 0, :S, :]
        y = y + kv * ssm_D[None, None, :]
        return q * y

    def _B_ref(x, w1, w2, w3, w4):
        B, S, D = x.shape
        h = _gelu(_layernorm(x, axis=-1) @ w1)
        c = D // 4
        g0 = _pad(h[:, :, 0*c:1*c], ((0, 0), (1, 0), (0, 0)))[:, :S, :]
        g1 = _pad(h[:, :, 1*c:2*c], ((0, 0), (0, 1), (0, 0)))[:, 1:, :]
        g2 = _pad(h[:, :, 2*c:3*c], ((0, 0), (2, 0), (0, 0)))[:, :S, :]
        g3 = _pad(h[:, :, 3*c:   ], ((0, 0), (0, 2), (0, 0)))[:, 2:, :]
        hs = torch.concatenate([g0, g1, g2, g3], axis=-1) @ w2
        x1 = x + hs
        h2 = _gelu(_layernorm(x1, axis=-1) @ w3) @ w4
        return x1 + h2

    x = A_q
    xn = _layernorm(x, axis=-1)
    s = _A_ref(xn, A_k, A_v, A_shift_k, A_ssm_k, A_ssm_D)
    g = _silu(_B_ref(xn, B_w1, B_w2, B_w3, B_w4))
    return x + s * g
```

```asm
; @launch grid=(256,1,1) block=(512,1,1) lds=159744
.amdgcn_target "amdgcn-amd-amdhsa--gfx950"
.text
.globl recurrent_scan__ssm_conv_h3__mixer_s_mlp__prompt_kernel
.type recurrent_scan__ssm_conv_h3__mixer_s_mlp__prompt_kernel,@function
.p2align 8
recurrent_scan__ssm_conv_h3__mixer_s_mlp__prompt_kernel:
K6_start:
  s_cmp_ge_u32 s2, 256
  s_cbranch_scc1 K6_end
  s_load_dwordx16 s[16:31], s[0:1], 0
  s_load_dwordx8 s[32:39], s[0:1], 64
  s_load_dwordx4 s[40:43], s[0:1], 96
  v_lshrrev_b32 v2, 6, v0
  v_and_b32 v1, 63, v0
  v_readfirstlane_b32 s3, v2
  s_and_b32 s96, s2, 7
  s_lshr_b32 s97, s2, 3
  s_mov_b32 s101, 1
  s_mov_b32 s99, 0
  v_mov_b32 v16, 158592
  v_mov_b32 v17, 1
  s_sub_u32 s60, s2, 144
  s_cmp_lt_u32 s97, 18
  s_cbranch_scc1 K6_g
  s_cmp_lg_u32 s3, 5
  s_cbranch_scc1 K6_n5
  s_mul_i32 s8, s60, 6016
  v_min_u32 v2, 46, v1
  v_lshlrev_b32 v2, 7, v2
  v_add_u32 v2, s8, v2
  v_min_u32 v2, 663424, v2
  s_waitcnt lgkmcnt(0)
  global_load_dword v30, v2, s[30:31]
  global_load_dword v31, v2, s[32:33]
  s_branch K6_f
K6_n5:
  s_cmp_lt_u32 s3, 6
  s_cbranch_scc1 K6_f
  s_cmp_eq_u32 s3, 7
  s_cbranch_scc1 K6_pf
  s_sub_u32 s11, 255, s2
  s_cmp_ge_u32 s11, 17
  s_cbranch_scc1 K6_f
  v_lshrrev_b32 v7, 5, v1
  v_mul_u32_u24 v7, 3840, v7
  v_lshl_add_u32 v7, v1, 4, v7
  v_lshlrev_b32 v6, 4, v1
  v_mov_b32 v8, 0
  v_mov_b32 v9, 0
  v_mov_b32 v10, 0
  v_mov_b32 v11, 0
  s_lshl_b32 s8, s11, 12
  s_add_u32 s8, s8, 9699328
  s_mul_i32 s9, s11, 17408
  s_add_u32 s9, s9, 9895936
  s_add_u32 s10, s9, 8704
  s_waitcnt lgkmcnt(0)
  s_mov_b32 s56, s42
  s_mov_b32 s57, s43
  s_mov_b32 s58, 40894464
  s_mov_b32 s59, 0x20000
  buffer_store_dwordx4 v[8:11], v6, s[56:59], s8 offen offset:0 sc1
  buffer_store_dwordx4 v[8:11], v6, s[56:59], s8 offen offset:1024 sc1
  buffer_store_dwordx4 v[8:11], v6, s[56:59], s8 offen offset:2048 sc1
  buffer_store_dwordx4 v[8:11], v6, s[56:59], s8 offen offset:3072 sc1
  buffer_store_dwordx4 v[8:11], v7, s[56:59], s9 offen sc1
  buffer_store_dwordx4 v[8:11], v7, s[56:59], s10 offen sc1
  s_barrier
  s_mov_b32 s99, 1
  s_mov_b32 s8, 1
  s_waitcnt vmcnt(0)
  s_atomic_add s8, s[40:41], 128 glc
  s_waitcnt lgkmcnt(0)
  s_cmp_lg_u32 s8, 16
  s_cbranch_scc1 K6_f
  s_atomic_add s101, s[40:41], 0
  s_branch K6_f
K6_pf:
  s_getpc_b64 s[8:9]
F_pc:
  s_sub_u32 s10, s97, 18
  v_min_u32 v2, 39, v1
  v_mul_u32_u24 v2, 14, v2
  v_add_lshl_u32 v2, s10, v2, 7
  v_min_u32 v2, CODE_END-F_pc-4, v2
  global_load_dword v31, v2, s[8:9]
  s_branch K6_f
K6_g:
  s_cmp_ge_u32 s97, 9
  s_cselect_b32 s62, 1, 0
  s_mul_i32 s61, s62, 9
  s_sub_u32 s61, s97, s61
  s_lshl_b32 s60, s96, 1
  s_add_u32 s60, s60, s62
  v_lshrrev_b32 v2, 2, v1
  v_and_b32 v3, 3, v1
  v_mul_u32_u24 v4, 1152, v2
  v_lshrrev_b32 v6, 5, v1
  v_lshlrev_b32 v6, 1, v6
  v_xor_b32 v6, v6, v3
  v_lshl_add_u32 v6, v6, 4, v4
  s_mul_i32 s10, s60, 147456
  s_mul_i32 s9, s3, 18432
  s_add_u32 s10, s10, s9
  s_lshr_b32 s8, s3, 1
  s_mul_i32 s11, s8, 18432
  s_lshl_b32 s9, s61, 7
  s_add_u32 s11, s11, s9
  s_and_b32 s9, s3, 1
  s_lshl_b32 s9, s9, 6
  s_add_u32 s11, s11, s9
  s_mul_i32 s14, s62, 7
  s_add_u32 s14, s14, 1
  s_mov_b32 s12, s61
  s_lshl_b32 s13, s3, 10
  s_waitcnt lgkmcnt(0)
  s_mov_b32 s48, s16
  s_mov_b32 s49, s17
  s_mov_b32 s50, 2359296
  s_mov_b32 s51, 0x20000
  s_mov_b32 s44, s30
  s_mov_b32 s45, s31
  s_mov_b32 s46, 663552
  s_mov_b32 s47, 0x20000
  s_add_u32 s12, s12, s14
  s_sub_u32 s9, s12, 9
  s_cmp_ge_u32 s12, 9
  s_cselect_b32 s12, s9, s12
  s_lshl_b32 s15, s12, 7
  s_add_u32 s15, s15, s10
  s_add_u32 m0, s13, 2560
  s_mul_i32 s9, s12, 73728
  buffer_load_dwordx4 v6, s[48:51], s15 offen lds
  s_add_u32 m0, m0, 8128
  s_add_u32 s9, s9, s11
  buffer_load_dwordx4 v6, s[48:51], s15 offen offset:64 lds
  s_add_u32 m0, m0, 8256
  s_nop 0
  buffer_load_dwordx4 v6, s[44:47], s9 offen lds
  s_add_u32 s12, s12, s14
  s_sub_u32 s9, s12, 9
  s_cmp_ge_u32 s12, 9
  s_cselect_b32 s12, s9, s12
  s_lshl_b32 s15, s12, 7
  s_add_u32 s15, s15, s10
  s_add_u32 m0, s13, 27136
  s_mul_i32 s9, s12, 73728
  buffer_load_dwordx4 v6, s[48:51], s15 offen lds
  s_add_u32 m0, m0, 8128
  s_add_u32 s9, s9, s11
  buffer_load_dwordx4 v6, s[48:51], s15 offen offset:64 lds
  s_add_u32 m0, m0, 8256
  s_nop 0
  buffer_load_dwordx4 v6, s[44:47], s9 offen lds
  s_mov_b32 s56, s42
  s_mov_b32 s57, s43
  s_mov_b32 s58, 40894464
  s_mov_b32 s59, 0x20000
  s_cmp_lg_u32 s3, 0
  s_cbranch_scc1 G_pf
  s_mov_b64 exec, 0xffff
  v_lshl_add_u32 v7, v1, 2, v16
  v_mov_b32 v8, 0
  ds_write2_b32 v7, v8, v8 offset0:0 offset1:16
  s_mov_b64 exec, -1
G_pf:
  s_mov_b32 s52, s32
  s_mov_b32 s53, s33
  s_mov_b32 s54, 663552
  s_mov_b32 s55, 0x20000
  v_bfe_u32 v7, v1, 4, 1
  v_lshlrev_b32 v8, 1, v7
  v_xor_b32 v8, v8, v3
  v_lshl_add_u32 v30, v8, 4, v4
  v_lshlrev_b32 v12, 6, v2
  v_lshl_add_u32 v12, v7, 5, v12
  v_lshl_add_u32 v12, v3, 3, v12
  v_add_u32 v22, 2560, v12
  v_xor_b32 v23, 32, v22
  s_mov_b32 s66, s11
  s_lshl_b32 s67, s3, 10
  s_add_u32 s67, s67, 2560
  v_and_b32 v2, 15, v1
  v_lshrrev_b32 v3, 4, v1
  v_bfe_u32 v4, v1, 3, 1
  v_lshlrev_b32 v4, 1, v4
  v_xor_b32 v5, v4, v3
  v_lshl_add_u32 v5, v2, 2, v5
  v_lshlrev_b32 v5, 4, v5
  s_and_b32 s63, s3, 3
  s_lshr_b32 s64, s3, 2
  s_and_b32 s69, s3, 1
  s_lshr_b32 s70, s63, 1
  s_lshl_b32 s71, s63, 1
  s_add_u32 s71, s71, s64
  s_lshl_b32 s9, s71, 10
  s_lshl_b32 s8, s69, 13
  s_add_u32 s9, s9, s8
  v_add_u32 v5, s9, v5
  v_xor_b32 v184, 0, v5
  v_add_u32 v184, 2560, v184
  v_xor_b32 v185, 1024, v5
  v_add_u32 v185, 2560, v185
  v_xor_b32 v186, 8192, v5
  v_add_u32 v186, 2560, v186
  v_xor_b32 v187, 9216, v5
  v_add_u32 v187, 2560, v187
  v_lshrrev_b32 v5, 1, v3
  v_lshlrev_b32 v11, 11, v5
  v_and_b32 v8, 1, v3
  v_lshl_add_u32 v11, v8, 9, v11
  v_lshrrev_b32 v7, 2, v2
  v_lshl_add_u32 v11, v7, 6, v11
  v_and_b32 v7, 3, v1
  v_lshl_add_u32 v11, v7, 3, v11
  v_lshl_add_u32 v11, v8, 5, v11
  s_lshl_b32 s9, s64, 10
  s_lshl_b32 s8, s69, 12
  s_add_u32 s9, s9, s8
  v_add_u32 v11, s9, v11
  s_lshl_b32 s8, s70, 5
  v_xor_b32 v11, s8, v11
  v_xor_b32 v188, 0, v11
  v_add_u32 v188, 18944, v188
  v_xor_b32 v189, 32, v11
  v_add_u32 v189, 18944, v189
  v_xor_b32 v190, 4096, v11
  v_add_u32 v190, 18944, v190
  v_xor_b32 v191, 4128, v11
  v_add_u32 v191, 18944, v191
  v_xor_b32 v5, v5, v4
  v_lshl_add_u32 v5, v2, 2, v5
  v_lshlrev_b32 v20, 4, v5
  v_lshl_add_u32 v20, v8, 3, v20
  s_add_u32 s9, s13, 76800
  v_add_u32 v20, s9, v20
  v_xor_b32 v21, 32, v20
  v_lshlrev_b32 v13, 4, v2
  v_lshlrev_b32 v18, 4, v3
  v_lshlrev_b32 v25, 4, v1
  s_lshl_b32 s9, s71, 8
  s_add_u32 s9, s9, 150528
  v_add_u32 v26, s9, v13
  v_xor_b32 v27, 256, v26
  s_lshl_b32 s9, s64, 8
  s_lshl_b32 s8, s70, 7
  s_add_u32 s9, s9, s8
  s_add_u32 s9, s9, 152576
  v_add_u32 v28, s9, v18
  v_xor_b32 v29, 128, v28
  s_lshl_b32 s8, s69, 6
  v_add_u32 v24, s8, v28
  s_lshl_b32 s65, s60, 3
  s_add_u32 s65, s65, s71
  s_lshl_b32 s68, s65, 8
  s_add_u32 s68, s68, 10354688
  s_xor_b32 s98, s65, 1
  s_lshl_b32 s9, s61, 11
  s_lshl_b32 s8, s64, 10
  s_add_u32 s9, s9, s8
  s_add_u32 s9, s9, 0
  s_mul_i32 s65, s65, 18432
  s_add_u32 s65, s65, s9
  s_mul_i32 s98, s98, 18432
  s_add_u32 s98, s98, s9
  v_mov_b32 v160, 0xc0135761
  v_mov_b32 v161, 0xc0135761
  v_mov_b32 v162, 0xbdd2d3e8
  v_mov_b32 v163, 0xbdd2d3e8
  v_mov_b32 v164, 1.0
  v_mov_b32 v165, 1.0
  v_mov_b32 v152, 0x3f803f80
  v_mov_b32 v153, 0x3f803f80
  v_mov_b32 v154, 0x3f803f80
  v_mov_b32 v155, 0x3f803f80
  v_lshlrev_b32 v7, 2, v3
  v_sub_u32 v19, v2, v7
  v_cmp_eq_u32 s[18:19], 0, v19
  v_cmp_eq_u32 s[20:21], 1, v19
  v_cmp_eq_u32 s[22:23], 2, v19
  v_cmp_eq_u32 s[28:29], 3, v19
  s_cmp_ge_u32 s3, 4
  s_cbranch_scc1 G_lq
  s_waitcnt vmcnt(3) lgkmcnt(0)
  s_barrier
  s_add_u32 s12, s12, s14
  s_sub_u32 s9, s12, 9
  s_cmp_ge_u32 s12, 9
  s_cselect_b32 s12, s9, s12
  s_lshl_b32 s15, s12, 7
  s_add_u32 s15, s15, s10
  s_add_u32 m0, s13, 51712
  s_mul_i32 s9, s12, 73728
  buffer_load_dwordx4 v6, s[48:51], s15 offen lds
  s_add_u32 m0, m0, 8128
  s_add_u32 s9, s9, s11
  buffer_load_dwordx4 v6, s[48:51], s15 offen offset:64 lds
  s_add_u32 m0, m0, 8256
  s_nop 0
  buffer_load_dwordx4 v6, s[44:47], s9 offen lds
  ds_read_b128 v[32:35], v184 offset:0
  ds_read_b128 v[36:39], v185 offset:0
  ds_read_b64_tr_b16 v[40:41], v188 offset:0
  ds_read_b64_tr_b16 v[42:43], v188 offset:256
  ds_read_b64_tr_b16 v[44:45], v189 offset:0
  ds_read_b64_tr_b16 v[46:47], v189 offset:256
  ds_read_b128 v[48:51], v186 offset:0
  ds_read_b128 v[52:55], v187 offset:0
  ds_read_b64_tr_b16 v[56:57], v190 offset:0
  ds_read_b64_tr_b16 v[58:59], v190 offset:256
  ds_read_b64_tr_b16 v[60:61], v191 offset:0
  ds_read_b64_tr_b16 v[62:63], v191 offset:256
  s_waitcnt vmcnt(3) lgkmcnt(0)
  s_barrier
  s_add_u32 s12, s12, s14
  s_sub_u32 s9, s12, 9
  s_cmp_ge_u32 s12, 9
  s_cselect_b32 s12, s9, s12
  s_lshl_b32 s15, s12, 7
  s_add_u32 s15, s15, s10
  s_add_u32 m0, s13, 76800
  s_mul_i32 s9, s12, 73728
  buffer_load_dwordx4 v6, s[48:51], s15 offen lds
  s_add_u32 m0, m0, 8128
  s_add_u32 s9, s9, s11
  buffer_load_dwordx4 v6, s[48:51], s15 offen offset:64 lds
  s_add_u32 m0, m0, 8256
  s_nop 0
  buffer_load_dwordx4 v6, s[44:47], s9 offen lds
  ds_read_b128 v[64:67], v184 offset:24576
  v_mfma_f32_16x16x32_bf16 v[140:143], v[32:35], v[32:35], 0
  ds_read_b128 v[68:71], v185 offset:24576
  v_mfma_f32_16x16x32_bf16 v[144:147], v[152:155], v[32:35], 0
  ds_read_b64_tr_b16 v[72:73], v188 offset:24576
  v_mfma_f32_16x16x32_bf16 v[140:143], v[48:51], v[48:51], v[140:143]
  ds_read_b64_tr_b16 v[74:75], v188 offset:24832
  v_mfma_f32_16x16x32_bf16 v[144:147], v[152:155], v[48:51], v[144:147]
  ds_read_b64_tr_b16 v[76:77], v189 offset:24576
  v_mfma_f32_16x16x32_bf16 v[148:151], v[40:43], v[152:155], 0
  ds_read_b64_tr_b16 v[78:79], v189 offset:24832
  v_mfma_f32_16x16x32_bf16 v[96:99], v[40:43], v[32:35], 0
  ds_read_b128 v[80:83], v186 offset:24576
  v_mfma_f32_16x16x32_bf16 v[104:107], v[40:43], v[36:39], 0
  ds_read_b128 v[84:87], v187 offset:24576
  v_mfma_f32_16x16x32_bf16 v[100:103], v[44:47], v[32:35], 0
  ds_read_b64_tr_b16 v[88:89], v190 offset:24576
  v_mfma_f32_16x16x32_bf16 v[108:111], v[44:47], v[36:39], 0
  ds_read_b64_tr_b16 v[90:91], v190 offset:24832
  v_mfma_f32_16x16x32_bf16 v[96:99], v[56:59], v[48:51], v[96:99]
  ds_read_b64_tr_b16 v[92:93], v191 offset:24576
  v_mfma_f32_16x16x32_bf16 v[104:107], v[56:59], v[52:55], v[104:107]
  ds_read_b64_tr_b16 v[94:95], v191 offset:24832
  v_mfma_f32_16x16x32_bf16 v[100:103], v[60:63], v[48:51], v[100:103]
  v_mfma_f32_16x16x32_bf16 v[108:111], v[60:63], v[52:55], v[108:111]
  s_waitcnt vmcnt(3) lgkmcnt(0)
  s_barrier
  s_add_u32 s12, s12, s14
  s_sub_u32 s9, s12, 9
  s_cmp_ge_u32 s12, 9
  s_cselect_b32 s12, s9, s12
  s_lshl_b32 s15, s12, 7
  s_add_u32 s15, s15, s10
  s_add_u32 m0, s13, 101376
  s_mul_i32 s9, s12, 73728
  buffer_load_dwordx4 v6, s[48:51], s15 offen lds
  s_add_u32 m0, m0, 8128
  s_add_u32 s9, s9, s11
  buffer_load_dwordx4 v6, s[48:51], s15 offen offset:64 lds
  s_add_u32 m0, m0, 8256
  s_nop 0
  buffer_load_dwordx4 v6, s[44:47], s9 offen lds
  ds_read_b128 v[32:35], v184 offset:49152
  v_mfma_f32_16x16x32_bf16 v[140:143], v[64:67], v[64:67], v[140:143]
  ds_read_b128 v[36:39], v185 offset:49152
  v_mfma_f32_16x16x32_bf16 v[144:147], v[152:155], v[64:67], v[144:147]
  ds_read_b64_tr_b16 v[40:41], v188 offset:49152
  v_mfma_f32_16x16x32_bf16 v[140:143], v[80:83], v[80:83], v[140:143]
  ds_read_b64_tr_b16 v[42:43], v188 offset:49408
  v_mfma_f32_16x16x32_bf16 v[144:147], v[152:155], v[80:83], v[144:147]
  ds_read_b64_tr_b16 v[44:45], v189 offset:49152
  v_mfma_f32_16x16x32_bf16 v[148:151], v[72:75], v[152:155], v[148:151]
  ds_read_b64_tr_b16 v[46:47], v189 offset:49408
  v_mfma_f32_16x16x32_bf16 v[96:99], v[72:75], v[64:67], v[96:99]
  ds_read_b128 v[48:51], v186 offset:49152
  v_mfma_f32_16x16x32_bf16 v[104:107], v[72:75], v[68:71], v[104:107]
  ds_read_b128 v[52:55], v187 offset:49152
  v_mfma_f32_16x16x32_bf16 v[100:103], v[76:79], v[64:67], v[100:103]
  ds_read_b64_tr_b16 v[56:57], v190 offset:49152
  v_mfma_f32_16x16x32_bf16 v[108:111], v[76:79], v[68:71], v[108:111]
  ds_read_b64_tr_b16 v[58:59], v190 offset:49408
  v_mfma_f32_16x16x32_bf16 v[96:99], v[88:91], v[80:83], v[96:99]
  ds_read_b64_tr_b16 v[60:61], v191 offset:49152
  v_mfma_f32_16x16x32_bf16 v[104:107], v[88:91], v[84:87], v[104:107]
  ds_read_b64_tr_b16 v[62:63], v191 offset:49408
  v_mfma_f32_16x16x32_bf16 v[100:103], v[92:95], v[80:83], v[100:103]
  v_mfma_f32_16x16x32_bf16 v[108:111], v[92:95], v[84:87], v[108:111]
  v_add_u32 v184, 74240, v184
  v_add_u32 v185, 74240, v185
  v_add_u32 v186, 74240, v186
  v_add_u32 v187, 74240, v187
  v_add_u32 v188, 74240, v188
  v_add_u32 v189, 74240, v189
  v_add_u32 v190, 74240, v190
  v_add_u32 v191, 74240, v191
  s_waitcnt vmcnt(3) lgkmcnt(0)
  s_barrier
  s_add_u32 s12, s12, s14
  s_sub_u32 s9, s12, 9
  s_cmp_ge_u32 s12, 9
  s_cselect_b32 s12, s9, s12
  s_lshl_b32 s15, s12, 7
  s_add_u32 s15, s15, s10
  s_add_u32 m0, s13, 125952
  s_mul_i32 s9, s12, 73728
  buffer_load_dwordx4 v6, s[48:51], s15 offen lds
  s_add_u32 m0, m0, 8128
  s_add_u32 s9, s9, s11
  buffer_load_dwordx4 v6, s[48:51], s15 offen offset:64 lds
  s_add_u32 m0, m0, 8256
  s_nop 0
  buffer_load_dwordx4 v6, s[44:47], s9 offen lds
  ds_read_b128 v[64:67], v184 offset:0
  v_mfma_f32_16x16x32_bf16 v[140:143], v[32:35], v[32:35], v[140:143]
  ds_read_b128 v[68:71], v185 offset:0
  v_mfma_f32_16x16x32_bf16 v[144:147], v[152:155], v[32:35], v[144:147]
  ds_read_b64_tr_b16 v[72:73], v188 offset:0
  v_mfma_f32_16x16x32_bf16 v[140:143], v[48:51], v[48:51], v[140:143]
  ds_read_b64_tr_b16 v[74:75], v188 offset:256
  v_mfma_f32_16x16x32_bf16 v[144:147], v[152:155], v[48:51], v[144:147]
  ds_read_b64_tr_b16 v[76:77], v189 offset:0
  v_mfma_f32_16x16x32_bf16 v[148:151], v[40:43], v[152:155], v[148:151]
  ds_read_b64_tr_b16 v[78:79], v189 offset:256
  v_mfma_f32_16x16x32_bf16 v[96:99], v[40:43], v[32:35], v[96:99]
  ds_read_b128 v[80:83], v186 offset:0
  v_mfma_f32_16x16x32_bf16 v[104:107], v[40:43], v[36:39], v[104:107]
  ds_read_b128 v[84:87], v187 offset:0
  v_mfma_f32_16x16x32_bf16 v[100:103], v[44:47], v[32:35], v[100:103]
  ds_read_b64_tr_b16 v[88:89], v190 offset:0
  v_mfma_f32_16x16x32_bf16 v[108:111], v[44:47], v[36:39], v[108:111]
  ds_read_b64_tr_b16 v[90:91], v190 offset:256
  v_mfma_f32_16x16x32_bf16 v[96:99], v[56:59], v[48:51], v[96:99]
  ds_read_b64_tr_b16 v[92:93], v191 offset:0
  v_mfma_f32_16x16x32_bf16 v[104:107], v[56:59], v[52:55], v[104:107]
  ds_read_b64_tr_b16 v[94:95], v191 offset:256
  v_mfma_f32_16x16x32_bf16 v[100:103], v[60:63], v[48:51], v[100:103]
  v_mfma_f32_16x16x32_bf16 v[108:111], v[60:63], v[52:55], v[108:111]
  s_waitcnt vmcnt(3) lgkmcnt(0)
  s_barrier
  s_add_u32 s12, s12, s14
  s_sub_u32 s9, s12, 9
  s_cmp_ge_u32 s12, 9
  s_cselect_b32 s12, s9, s12
  s_lshl_b32 s15, s12, 7
  s_add_u32 s15, s15, s10
  s_add_u32 m0, s13, 2560
  s_mul_i32 s9, s12, 73728
  buffer_load_dwordx4 v6, s[48:51], s15 offen lds
  s_add_u32 m0, m0, 8128
  s_add_u32 s9, s9, s11
  buffer_load_dwordx4 v6, s[48:51], s15 offen offset:64 lds
  s_add_u32 m0, m0, 8256
  s_nop 0
  buffer_load_dwordx4 v6, s[44:47], s9 offen lds
  ds_read_b128 v[32:35], v184 offset:24576
  v_mfma_f32_16x16x32_bf16 v[140:143], v[64:67], v[64:67], v[140:143]
  ds_read_b128 v[36:39], v185 offset:24576
  v_mfma_f32_16x16x32_bf16 v[144:147], v[152:155], v[64:67], v[144:147]
  ds_read_b64_tr_b16 v[40:41], v188 offset:24576
  v_mfma_f32_16x16x32_bf16 v[140:143], v[80:83], v[80:83], v[140:143]
  ds_read_b64_tr_b16 v[42:43], v188 offset:24832
  v_mfma_f32_16x16x32_bf16 v[144:147], v[152:155], v[80:83], v[144:147]
  ds_read_b64_tr_b16 v[44:45], v189 offset:24576
  v_mfma_f32_16x16x32_bf16 v[148:151], v[72:75], v[152:155], v[148:151]
  ds_read_b64_tr_b16 v[46:47], v189 offset:24832
  v_mfma_f32_16x16x32_bf16 v[96:99], v[72:75], v[64:67], v[96:99]
  ds_read_b128 v[48:51], v186 offset:24576
  v_mfma_f32_16x16x32_bf16 v[104:107], v[72:75], v[68:71], v[104:107]
  ds_read_b128 v[52:55], v187 offset:24576
  v_mfma_f32_16x16x32_bf16 v[100:103], v[76:79], v[64:67], v[100:103]
  ds_read_b64_tr_b16 v[56:57], v190 offset:24576
  v_mfma_f32_16x16x32_bf16 v[108:111], v[76:79], v[68:71], v[108:111]
  ds_read_b64_tr_b16 v[58:59], v190 offset:24832
  v_mfma_f32_16x16x32_bf16 v[96:99], v[88:91], v[80:83], v[96:99]
  ds_read_b64_tr_b16 v[60:61], v191 offset:24576
  v_mfma_f32_16x16x32_bf16 v[104:107], v[88:91], v[84:87], v[104:107]
  ds_read_b64_tr_b16 v[62:63], v191 offset:24832
  v_mfma_f32_16x16x32_bf16 v[100:103], v[92:95], v[80:83], v[100:103]
  v_mfma_f32_16x16x32_bf16 v[108:111], v[92:95], v[84:87], v[108:111]
  s_waitcnt vmcnt(3) lgkmcnt(0)
  s_barrier
  s_add_u32 s12, s12, s14
  s_sub_u32 s9, s12, 9
  s_cmp_ge_u32 s12, 9
  s_cselect_b32 s12, s9, s12
  s_lshl_b32 s15, s12, 7
  s_add_u32 s15, s15, s10
  s_add_u32 m0, s13, 27136
  s_mul_i32 s9, s12, 73728
  buffer_load_dwordx4 v6, s[48:51], s15 offen lds
  s_add_u32 m0, m0, 8128
  s_add_u32 s9, s9, s11
  buffer_load_dwordx4 v6, s[48:51], s15 offen offset:64 lds
  s_add_u32 m0, m0, 8256
  s_nop 0
  buffer_load_dwordx4 v6, s[44:47], s9 offen lds
  ds_read_b128 v[64:67], v184 offset:49152
  v_mfma_f32_16x16x32_bf16 v[140:143], v[32:35], v[32:35], v[140:143]
  ds_read_b128 v[68:71], v185 offset:49152
  v_mfma_f32_16x16x32_bf16 v[144:147], v[152:155], v[32:35], v[144:147]
  ds_read_b64_tr_b16 v[72:73], v188 offset:49152
  v_mfma_f32_16x16x32_bf16 v[140:143], v[48:51], v[48:51], v[140:143]
  ds_read_b64_tr_b16 v[74:75], v188 offset:49408
  v_mfma_f32_16x16x32_bf16 v[144:147], v[152:155], v[48:51], v[144:147]
  ds_read_b64_tr_b16 v[76:77], v189 offset:49152
  v_mfma_f32_16x16x32_bf16 v[148:151], v[40:43], v[152:155], v[148:151]
  ds_read_b64_tr_b16 v[78:79], v189 offset:49408
  v_mfma_f32_16x16x32_bf16 v[96:99], v[40:43], v[32:35], v[96:99]
  ds_read_b128 v[80:83], v186 offset:49152
  v_mfma_f32_16x16x32_bf16 v[104:107], v[40:43], v[36:39], v[104:107]
  ds_read_b128 v[84:87], v187 offset:49152
  v_mfma_f32_16x16x32_bf16 v[100:103], v[44:47], v[32:35], v[100:103]
  ds_read_b64_tr_b16 v[88:89], v190 offset:49152
  v_mfma_f32_16x16x32_bf16 v[108:111], v[44:47], v[36:39], v[108:111]
  ds_read_b64_tr_b16 v[90:91], v190 offset:49408
  v_mfma_f32_16x16x32_bf16 v[96:99], v[56:59], v[48:51], v[96:99]
  ds_read_b64_tr_b16 v[92:93], v191 offset:49152
  v_mfma_f32_16x16x32_bf16 v[104:107], v[56:59], v[52:55], v[104:107]
  ds_read_b64_tr_b16 v[94:95], v191 offset:49408
  v_mfma_f32_16x16x32_bf16 v[100:103], v[60:63], v[48:51], v[100:103]
  v_mfma_f32_16x16x32_bf16 v[108:111], v[60:63], v[52:55], v[108:111]
  v_add_u32 v184, -74240, v184
  v_add_u32 v185, -74240, v185
  v_add_u32 v186, -74240, v186
  v_add_u32 v187, -74240, v187
  v_add_u32 v188, -74240, v188
  v_add_u32 v189, -74240, v189
  v_add_u32 v190, -74240, v190
  v_add_u32 v191, -74240, v191
  s_waitcnt vmcnt(3) lgkmcnt(0)
  s_barrier
  s_add_u32 s12, s12, s14
  s_sub_u32 s9, s12, 9
  s_cmp_ge_u32 s12, 9
  s_cselect_b32 s12, s9, s12
  s_lshl_b32 s15, s12, 7
  s_add_u32 s15, s15, s10
  s_add_u32 m0, s13, 76800
  s_mul_i32 s9, s12, 73728
  buffer_load_dwordx4 v6, s[48:51], s15 offen lds
  s_add_u32 m0, m0, 8128
  s_add_u32 s9, s9, s11
  buffer_load_dwordx4 v6, s[48:51], s15 offen offset:64 lds
  s_add_u32 m0, m0, 8256
  s_nop 0
  buffer_load_dwordx4 v6, s[44:47], s9 offen lds
  ds_read_b128 v[32:35], v184 offset:0
  v_mfma_f32_16x16x32_bf16 v[140:143], v[64:67], v[64:67], v[140:143]
  ds_read_b128 v[36:39], v185 offset:0
  v_mfma_f32_16x16x32_bf16 v[144:147], v[152:155], v[64:67], v[144:147]
  ds_read_b64_tr_b16 v[40:41], v188 offset:0
  v_mfma_f32_16x16x32_bf16 v[140:143], v[80:83], v[80:83], v[140:143]
  ds_read_b64_tr_b16 v[42:43], v188 offset:256
  v_mfma_f32_16x16x32_bf16 v[144:147], v[152:155], v[80:83], v[144:147]
  ds_read_b64_tr_b16 v[44:45], v189 offset:0
  v_mfma_f32_16x16x32_bf16 v[148:151], v[72:75], v[152:155], v[148:151]
  ds_read_b64_tr_b16 v[46:47], v189 offset:256
  v_mfma_f32_16x16x32_bf16 v[96:99], v[72:75], v[64:67], v[96:99]
  ds_read_b128 v[48:51], v186 offset:0
  v_mfma_f32_16x16x32_bf16 v[104:107], v[72:75], v[68:71], v[104:107]
  ds_read_b128 v[52:55], v187 offset:0
  v_mfma_f32_16x16x32_bf16 v[100:103], v[76:79], v[64:67], v[100:103]
  ds_read_b64_tr_b16 v[56:57], v190 offset:0
  v_mfma_f32_16x16x32_bf16 v[108:111], v[76:79], v[68:71], v[108:111]
  ds_read_b64_tr_b16 v[58:59], v190 offset:256
  v_mfma_f32_16x16x32_bf16 v[96:99], v[88:91], v[80:83], v[96:99]
  ds_read_b64_tr_b16 v[60:61], v191 offset:0
  v_mfma_f32_16x16x32_bf16 v[104:107], v[88:91], v[84:87], v[104:107]
  ds_read_b64_tr_b16 v[62:63], v191 offset:256
  v_mfma_f32_16x16x32_bf16 v[100:103], v[92:95], v[80:83], v[100:103]
  v_mfma_f32_16x16x32_bf16 v[108:111], v[92:95], v[84:87], v[108:111]
  s_add_u32 m0, s67, 49152
  s_add_u32 s9, s66, 442368
  buffer_load_dwordx4 v30, s[52:55], s9 offen lds
  s_add_u32 m0, s67, 57344
  s_add_u32 s9, s66, 516096
  buffer_load_dwordx4 v30, s[52:55], s9 offen lds
  s_add_u32 m0, s67, 65536
  s_add_u32 s9, s66, 589824
  buffer_load_dwordx4 v30, s[52:55], s9 offen lds
  s_waitcnt vmcnt(6) lgkmcnt(0)
  s_barrier
  ds_read_b128 v[64:67], v184 offset:24576
  v_mfma_f32_16x16x32_bf16 v[140:143], v[32:35], v[32:35], v[140:143]
  ds_read_b128 v[68:71], v185 offset:24576
  v_mfma_f32_16x16x32_bf16 v[144:147], v[152:155], v[32:35], v[144:147]
  ds_read_b64_tr_b16 v[72:73], v188 offset:24576
  v_mfma_f32_16x16x32_bf16 v[140:143], v[48:51], v[48:51], v[140:143]
  ds_read_b64_tr_b16 v[74:75], v188 offset:24832
  v_mfma_f32_16x16x32_bf16 v[144:147], v[152:155], v[48:51], v[144:147]
  ds_read_b64_tr_b16 v[76:77], v189 offset:24576
  v_mfma_f32_16x16x32_bf16 v[148:151], v[40:43], v[152:155], v[148:151]
  ds_read_b64_tr_b16 v[78:79], v189 offset:24832
  v_mfma_f32_16x16x32_bf16 v[96:99], v[40:43], v[32:35], v[96:99]
  ds_read_b128 v[80:83], v186 offset:24576
  v_mfma_f32_16x16x32_bf16 v[104:107], v[40:43], v[36:39], v[104:107]
  ds_read_b128 v[84:87], v187 offset:24576
  v_mfma_f32_16x16x32_bf16 v[100:103], v[44:47], v[32:35], v[100:103]
  ds_read_b64_tr_b16 v[88:89], v190 offset:24576
  v_mfma_f32_16x16x32_bf16 v[108:111], v[44:47], v[36:39], v[108:111]
  ds_read_b64_tr_b16 v[90:91], v190 offset:24832
  v_mfma_f32_16x16x32_bf16 v[96:99], v[56:59], v[48:51], v[96:99]
  ds_read_b64_tr_b16 v[92:93], v191 offset:24576
  v_mfma_f32_16x16x32_bf16 v[104:107], v[56:59], v[52:55], v[104:107]
  ds_read_b64_tr_b16 v[94:95], v191 offset:24832
  v_mfma_f32_16x16x32_bf16 v[100:103], v[60:63], v[48:51], v[100:103]
  v_mfma_f32_16x16x32_bf16 v[108:111], v[60:63], v[52:55], v[108:111]
  s_add_u32 m0, s67, 0
  s_add_u32 s9, s66, 0
  buffer_load_dwordx4 v30, s[52:55], s9 offen lds
  s_add_u32 m0, s67, 8192
  s_add_u32 s9, s66, 73728
  buffer_load_dwordx4 v30, s[52:55], s9 offen lds
  s_add_u32 m0, s67, 16384
  s_add_u32 s9, s66, 147456
  buffer_load_dwordx4 v30, s[52:55], s9 offen lds
  v_add_u32 v184, 74240, v184
  v_add_u32 v185, 74240, v185
  v_add_u32 v186, 74240, v186
  v_add_u32 v187, 74240, v187
  v_add_u32 v188, 74240, v188
  v_add_u32 v189, 74240, v189
  v_add_u32 v190, 74240, v190
  v_add_u32 v191, 74240, v191
  s_waitcnt vmcnt(6) lgkmcnt(0)
  s_barrier
  ds_read_b128 v[32:35], v184 offset:0
  v_mfma_f32_16x16x32_bf16 v[140:143], v[64:67], v[64:67], v[140:143]
  ds_read_b128 v[36:39], v185 offset:0
  v_mfma_f32_16x16x32_bf16 v[144:147], v[152:155], v[64:67], v[144:147]
  ds_read_b64_tr_b16 v[40:41], v188 offset:0
  v_mfma_f32_16x16x32_bf16 v[140:143], v[80:83], v[80:83], v[140:143]
  ds_read_b64_tr_b16 v[42:43], v188 offset:256
  v_mfma_f32_16x16x32_bf16 v[144:147], v[152:155], v[80:83], v[144:147]
  ds_read_b64_tr_b16 v[44:45], v189 offset:0
  v_mfma_f32_16x16x32_bf16 v[148:151], v[72:75], v[152:155], v[148:151]
  ds_read_b64_tr_b16 v[46:47], v189 offset:256
  v_mfma_f32_16x16x32_bf16 v[96:99], v[72:75], v[64:67], v[96:99]
  ds_read_b128 v[48:51], v186 offset:0
  v_mfma_f32_16x16x32_bf16 v[104:107], v[72:75], v[68:71], v[104:107]
  ds_read_b128 v[52:55], v187 offset:0
  v_mfma_f32_16x16x32_bf16 v[100:103], v[76:79], v[64:67], v[100:103]
  ds_read_b64_tr_b16 v[56:57], v190 offset:0
  v_mfma_f32_16x16x32_bf16 v[108:111], v[76:79], v[68:71], v[108:111]
  ds_read_b64_tr_b16 v[58:59], v190 offset:256
  v_mfma_f32_16x16x32_bf16 v[96:99], v[88:91], v[80:83], v[96:99]
  ds_read_b64_tr_b16 v[60:61], v191 offset:0
  v_mfma_f32_16x16x32_bf16 v[104:107], v[88:91], v[84:87], v[104:107]
  ds_read_b64_tr_b16 v[62:63], v191 offset:256
  v_mfma_f32_16x16x32_bf16 v[100:103], v[92:95], v[80:83], v[100:103]
  v_mfma_f32_16x16x32_bf16 v[108:111], v[92:95], v[84:87], v[108:111]
  s_add_u32 m0, s67, 24576
  s_add_u32 s9, s66, 221184
  buffer_load_dwordx4 v30, s[52:55], s9 offen lds
  s_add_u32 m0, s67, 32768
  s_add_u32 s9, s66, 294912
  buffer_load_dwordx4 v30, s[52:55], s9 offen lds
  s_add_u32 m0, s67, 40960
  s_add_u32 s9, s66, 368640
  buffer_load_dwordx4 v30, s[52:55], s9 offen lds
  s_load_dword s69, s[40:41], 0
  s_waitcnt lgkmcnt(0)
  v_mfma_f32_16x16x32_bf16 v[140:143], v[32:35], v[32:35], v[140:143]
  v_mfma_f32_16x16x32_bf16 v[144:147], v[152:155], v[32:35], v[144:147]
  v_mfma_f32_16x16x32_bf16 v[140:143], v[48:51], v[48:51], v[140:143]
  v_mfma_f32_16x16x32_bf16 v[144:147], v[152:155], v[48:51], v[144:147]
  v_mfma_f32_16x16x32_bf16 v[148:151], v[40:43], v[152:155], v[148:151]
  v_mfma_f32_16x16x32_bf16 v[96:99], v[40:43], v[32:35], v[96:99]
  s_nop 4
  v_cndmask_b32 v112, 0, v140, s[18:19]
  v_cndmask_b32 v112, v112, v141, s[20:21]
  v_cndmask_b32 v112, v112, v142, s[22:23]
  v_cndmask_b32 v112, v112, v143, s[28:29]
  v_mul_f32 v114, 0xbae38e39, v144
  v_mfma_f32_16x16x32_bf16 v[104:107], v[40:43], v[36:39], v[104:107]
  v_mov_b32 v7, v112
  s_nop 1
  v_permlane32_swap_b32 v112, v7
  v_add_f32 v112, v112, v7
  v_mov_b32 v7, v112
  v_mfma_f32_16x16x32_bf16 v[100:103], v[44:47], v[32:35], v[100:103]
  s_nop 1
  v_permlane16_swap_b32 v112, v7
  v_add_f32 v112, v112, v7
  v_mul_f32 v7, 0x3ae38e39, v112
  v_fma_f32 v7, -v114, v114, v7
  v_mfma_f32_16x16x32_bf16 v[108:111], v[44:47], v[36:39], v[108:111]
  v_max_f32 v7, 0, v7
  v_add_f32 v8, 0x3727c5ac, v7
  v_rsq_f32 v112, v8
  s_nop 0
  v_mul_f32 v8, v112, v112
  v_mfma_f32_16x16x32_bf16 v[96:99], v[56:59], v[48:51], v[96:99]
  v_fmaak_f32 v8, v8, v7, 0x3727c5ac
  v_rsq_f32 v8, v8
  v_mul_f32 v113, v114, v112
  v_mul_f32 v115, v8, v112
  v_mfma_f32_16x16x32_bf16 v[104:107], v[56:59], v[52:55], v[104:107]
  v_mfma_f32_16x16x32_bf16 v[100:103], v[60:63], v[48:51], v[100:103]
  v_mfma_f32_16x16x32_bf16 v[108:111], v[60:63], v[52:55], v[108:111]
  s_branch G_lj
G_lq:
  s_add_u32 s12, s12, s14
  s_sub_u32 s9, s12, 9
  s_cmp_ge_u32 s12, 9
  s_cselect_b32 s12, s9, s12
  s_lshl_b32 s15, s12, 7
  s_add_u32 s15, s15, s10
  s_add_u32 m0, s13, 51712
  s_mul_i32 s9, s12, 73728
  buffer_load_dwordx4 v6, s[48:51], s15 offen lds
  s_add_u32 m0, m0, 8128
  s_add_u32 s9, s9, s11
  buffer_load_dwordx4 v6, s[48:51], s15 offen offset:64 lds
  s_add_u32 m0, m0, 8256
  s_nop 0
  buffer_load_dwordx4 v6, s[44:47], s9 offen lds
  s_waitcnt vmcnt(6) lgkmcnt(0)
  s_barrier
  ds_read_b128 v[32:35], v184 offset:0
  ds_read_b128 v[36:39], v185 offset:0
  ds_read_b64_tr_b16 v[40:41], v188 offset:0
  ds_read_b64_tr_b16 v[42:43], v188 offset:256
  ds_read_b64_tr_b16 v[44:45], v189 offset:0
  ds_read_b64_tr_b16 v[46:47], v189 offset:256
  ds_read_b128 v[48:51], v186 offset:0
  ds_read_b128 v[52:55], v187 offset:0
  ds_read_b64_tr_b16 v[56:57], v190 offset:0
  ds_read_b64_tr_b16 v[58:59], v190 offset:256
  ds_read_b64_tr_b16 v[60:61], v191 offset:0
  ds_read_b64_tr_b16 v[62:63], v191 offset:256
  s_add_u32 s12, s12, s14
  s_sub_u32 s9, s12, 9
  s_cmp_ge_u32 s12, 9
  s_cselect_b32 s12, s9, s12
  s_lshl_b32 s15, s12, 7
  s_add_u32 s15, s15, s10
  s_add_u32 m0, s13, 76800
  s_mul_i32 s9, s12, 73728
  buffer_load_dwordx4 v6, s[48:51], s15 offen lds
  s_add_u32 m0, m0, 8128
  s_add_u32 s9, s9, s11
  buffer_load_dwordx4 v6, s[48:51], s15 offen offset:64 lds
  s_add_u32 m0, m0, 8256
  s_nop 0
  buffer_load_dwordx4 v6, s[44:47], s9 offen lds
  s_waitcnt vmcnt(6) lgkmcnt(0)
  s_barrier
  ds_read_b128 v[64:67], v184 offset:24576
  v_mfma_f32_16x16x32_bf16 v[140:143], v[32:35], v[32:35], 0
  ds_read_b128 v[68:71], v185 offset:24576
  v_mfma_f32_16x16x32_bf16 v[144:147], v[152:155], v[32:35], 0
  ds_read_b64_tr_b16 v[72:73], v188 offset:24576
  v_mfma_f32_16x16x32_bf16 v[140:143], v[48:51], v[48:51], v[140:143]
  ds_read_b64_tr_b16 v[74:75], v188 offset:24832
  v_mfma_f32_16x16x32_bf16 v[144:147], v[152:155], v[48:51], v[144:147]
  ds_read_b64_tr_b16 v[76:77], v189 offset:24576
  v_mfma_f32_16x16x32_bf16 v[148:151], v[40:43], v[152:155], 0
  ds_read_b64_tr_b16 v[78:79], v189 offset:24832
  v_mfma_f32_16x16x32_bf16 v[96:99], v[40:43], v[32:35], 0
  ds_read_b128 v[80:83], v186 offset:24576
  v_mfma_f32_16x16x32_bf16 v[104:107], v[40:43], v[36:39], 0
  ds_read_b128 v[84:87], v187 offset:24576
  v_mfma_f32_16x16x32_bf16 v[100:103], v[44:47], v[32:35], 0
  ds_read_b64_tr_b16 v[88:89], v190 offset:24576
  v_mfma_f32_16x16x32_bf16 v[108:111], v[44:47], v[36:39], 0
  ds_read_b64_tr_b16 v[90:91], v190 offset:24832
  v_mfma_f32_16x16x32_bf16 v[96:99], v[56:59], v[48:51], v[96:99]
  ds_read_b64_tr_b16 v[92:93], v191 offset:24576
  v_mfma_f32_16x16x32_bf16 v[104:107], v[56:59], v[52:55], v[104:107]
  ds_read_b64_tr_b16 v[94:95], v191 offset:24832
  v_mfma_f32_16x16x32_bf16 v[100:103], v[60:63], v[48:51], v[100:103]
  v_mfma_f32_16x16x32_bf16 v[108:111], v[60:63], v[52:55], v[108:111]
  s_add_u32 s12, s12, s14
  s_sub_u32 s9, s12, 9
  s_cmp_ge_u32 s12, 9
  s_cselect_b32 s12, s9, s12
  s_lshl_b32 s15, s12, 7
  s_add_u32 s15, s15, s10
  s_add_u32 m0, s13, 101376
  s_mul_i32 s9, s12, 73728
  buffer_load_dwordx4 v6, s[48:51], s15 offen lds
  s_add_u32 m0, m0, 8128
  s_add_u32 s9, s9, s11
  buffer_load_dwordx4 v6, s[48:51], s15 offen offset:64 lds
  s_add_u32 m0, m0, 8256
  s_nop 0
  buffer_load_dwordx4 v6, s[44:47], s9 offen lds
  s_waitcnt vmcnt(6) lgkmcnt(0)
  s_barrier
  ds_read_b128 v[32:35], v184 offset:49152
  v_mfma_f32_16x16x32_bf16 v[140:143], v[64:67], v[64:67], v[140:143]
  ds_read_b128 v[36:39], v185 offset:49152
  v_mfma_f32_16x16x32_bf16 v[144:147], v[152:155], v[64:67], v[144:147]
  ds_read_b64_tr_b16 v[40:41], v188 offset:49152
  v_mfma_f32_16x16x32_bf16 v[140:143], v[80:83], v[80:83], v[140:143]
  ds_read_b64_tr_b16 v[42:43], v188 offset:49408
  v_mfma_f32_16x16x32_bf16 v[144:147], v[152:155], v[80:83], v[144:147]
  ds_read_b64_tr_b16 v[44:45], v189 offset:49152
  v_mfma_f32_16x16x32_bf16 v[148:151], v[72:75], v[152:155], v[148:151]
  ds_read_b64_tr_b16 v[46:47], v189 offset:49408
  v_mfma_f32_16x16x32_bf16 v[96:99], v[72:75], v[64:67], v[96:99]
  ds_read_b128 v[48:51], v186 offset:49152
  v_mfma_f32_16x16x32_bf16 v[104:107], v[72:75], v[68:71], v[104:107]
  ds_read_b128 v[52:55], v187 offset:49152
  v_mfma_f32_16x16x32_bf16 v[100:103], v[76:79], v[64:67], v[100:103]
  ds_read_b64_tr_b16 v[56:57], v190 offset:49152
  v_mfma_f32_16x16x32_bf16 v[108:111], v[76:79], v[68:71], v[108:111]
  ds_read_b64_tr_b16 v[58:59], v190 offset:49408
  v_mfma_f32_16x16x32_bf16 v[96:99], v[88:91], v[80:83], v[96:99]
  ds_read_b64_tr_b16 v[60:61], v191 offset:49152
  v_mfma_f32_16x16x32_bf16 v[104:107], v[88:91], v[84:87], v[104:107]
  ds_read_b64_tr_b16 v[62:63], v191 offset:49408
  v_mfma_f32_16x16x32_bf16 v[100:103], v[92:95], v[80:83], v[100:103]
  v_mfma_f32_16x16x32_bf16 v[108:111], v[92:95], v[84:87], v[108:111]
  s_add_u32 s12, s12, s14
  s_sub_u32 s9, s12, 9
  s_cmp_ge_u32 s12, 9
  s_cselect_b32 s12, s9, s12
  s_lshl_b32 s15, s12, 7
  s_add_u32 s15, s15, s10
  s_add_u32 m0, s13, 125952
  s_mul_i32 s9, s12, 73728
  buffer_load_dwordx4 v6, s[48:51], s15 offen lds
  s_add_u32 m0, m0, 8128
  s_add_u32 s9, s9, s11
  buffer_load_dwordx4 v6, s[48:51], s15 offen offset:64 lds
  s_add_u32 m0, m0, 8256
  s_nop 0
  buffer_load_dwordx4 v6, s[44:47], s9 offen lds
  v_add_u32 v184, 74240, v184
  v_add_u32 v185, 74240, v185
  v_add_u32 v186, 74240, v186
  v_add_u32 v187, 74240, v187
  v_add_u32 v188, 74240, v188
  v_add_u32 v189, 74240, v189
  v_add_u32 v190, 74240, v190
  v_add_u32 v191, 74240, v191
  s_waitcnt vmcnt(6) lgkmcnt(0)
  s_barrier
  ds_read_b128 v[64:67], v184 offset:0
  v_mfma_f32_16x16x32_bf16 v[140:143], v[32:35], v[32:35], v[140:143]
  ds_read_b128 v[68:71], v185 offset:0
  v_mfma_f32_16x16x32_bf16 v[144:147], v[152:155], v[32:35], v[144:147]
  ds_read_b64_tr_b16 v[72:73], v188 offset:0
  v_mfma_f32_16x16x32_bf16 v[140:143], v[48:51], v[48:51], v[140:143]
  ds_read_b64_tr_b16 v[74:75], v188 offset:256
  v_mfma_f32_16x16x32_bf16 v[144:147], v[152:155], v[48:51], v[144:147]
  ds_read_b64_tr_b16 v[76:77], v189 offset:0
  v_mfma_f32_16x16x32_bf16 v[148:151], v[40:43], v[152:155], v[148:151]
  ds_read_b64_tr_b16 v[78:79], v189 offset:256
  v_mfma_f32_16x16x32_bf16 v[96:99], v[40:43], v[32:35], v[96:99]
  ds_read_b128 v[80:83], v186 offset:0
  v_mfma_f32_16x16x32_bf16 v[104:107], v[40:43], v[36:39], v[104:107]
  ds_read_b128 v[84:87], v187 offset:0
  v_mfma_f32_16x16x32_bf16 v[100:103], v[44:47], v[32:35], v[100:103]
  ds_read_b64_tr_b16 v[88:89], v190 offset:0
  v_mfma_f32_16x16x32_bf16 v[108:111], v[44:47], v[36:39], v[108:111]
  ds_read_b64_tr_b16 v[90:91], v190 offset:256
  v_mfma_f32_16x16x32_bf16 v[96:99], v[56:59], v[48:51], v[96:99]
  ds_read_b64_tr_b16 v[92:93], v191 offset:0
  v_mfma_f32_16x16x32_bf16 v[104:107], v[56:59], v[52:55], v[104:107]
  ds_read_b64_tr_b16 v[94:95], v191 offset:256
  v_mfma_f32_16x16x32_bf16 v[100:103], v[60:63], v[48:51], v[100:103]
  v_mfma_f32_16x16x32_bf16 v[108:111], v[60:63], v[52:55], v[108:111]
  s_add_u32 s12, s12, s14
  s_sub_u32 s9, s12, 9
  s_cmp_ge_u32 s12, 9
  s_cselect_b32 s12, s9, s12
  s_lshl_b32 s15, s12, 7
  s_add_u32 s15, s15, s10
  s_add_u32 m0, s13, 2560
  s_mul_i32 s9, s12, 73728
  buffer_load_dwordx4 v6, s[48:51], s15 offen lds
  s_add_u32 m0, m0, 8128
  s_add_u32 s9, s9, s11
  buffer_load_dwordx4 v6, s[48:51], s15 offen offset:64 lds
  s_add_u32 m0, m0, 8256
  s_nop 0
  buffer_load_dwordx4 v6, s[44:47], s9 offen lds
  s_waitcnt vmcnt(6) lgkmcnt(0)
  s_barrier
  ds_read_b128 v[32:35], v184 offset:24576
  v_mfma_f32_16x16x32_bf16 v[140:143], v[64:67], v[64:67], v[140:143]
  ds_read_b128 v[36:39], v185 offset:24576
  v_mfma_f32_16x16x32_bf16 v[144:147], v[152:155], v[64:67], v[144:147]
  ds_read_b64_tr_b16 v[40:41], v188 offset:24576
  v_mfma_f32_16x16x32_bf16 v[140:143], v[80:83], v[80:83], v[140:143]
  ds_read_b64_tr_b16 v[42:43], v188 offset:24832
  v_mfma_f32_16x16x32_bf16 v[144:147], v[152:155], v[80:83], v[144:147]
  ds_read_b64_tr_b16 v[44:45], v189 offset:24576
  v_mfma_f32_16x16x32_bf16 v[148:151], v[72:75], v[152:155], v[148:151]
  ds_read_b64_tr_b16 v[46:47], v189 offset:24832
  v_mfma_f32_16x16x32_bf16 v[96:99], v[72:75], v[64:67], v[96:99]
  ds_read_b128 v[48:51], v186 offset:24576
  v_mfma_f32_16x16x32_bf16 v[104:107], v[72:75], v[68:71], v[104:107]
  ds_read_b128 v[52:55], v187 offset:24576
  v_mfma_f32_16x16x32_bf16 v[100:103], v[76:79], v[64:67], v[100:103]
  ds_read_b64_tr_b16 v[56:57], v190 offset:24576
  v_mfma_f32_16x16x32_bf16 v[108:111], v[76:79], v[68:71], v[108:111]
  ds_read_b64_tr_b16 v[58:59], v190 offset:24832
  v_mfma_f32_16x16x32_bf16 v[96:99], v[88:91], v[80:83], v[96:99]
  ds_read_b64_tr_b16 v[60:61], v191 offset:24576
  v_mfma_f32_16x16x32_bf16 v[104:107], v[88:91], v[84:87], v[104:107]
  ds_read_b64_tr_b16 v[62:63], v191 offset:24832
  v_mfma_f32_16x16x32_bf16 v[100:103], v[92:95], v[80:83], v[100:103]
  v_mfma_f32_16x16x32_bf16 v[108:111], v[92:95], v[84:87], v[108:111]
  s_add_u32 s12, s12, s14
  s_sub_u32 s9, s12, 9
  s_cmp_ge_u32 s12, 9
  s_cselect_b32 s12, s9, s12
  s_lshl_b32 s15, s12, 7
  s_add_u32 s15, s15, s10
  s_add_u32 m0, s13, 27136
  s_mul_i32 s9, s12, 73728
  buffer_load_dwordx4 v6, s[48:51], s15 offen lds
  s_add_u32 m0, m0, 8128
  s_add_u32 s9, s9, s11
  buffer_load_dwordx4 v6, s[48:51], s15 offen offset:64 lds
  s_add_u32 m0, m0, 8256
  s_nop 0
  buffer_load_dwordx4 v6, s[44:47], s9 offen lds
  s_waitcnt vmcnt(6) lgkmcnt(0)
  s_barrier
  ds_read_b128 v[64:67], v184 offset:49152
  v_mfma_f32_16x16x32_bf16 v[140:143], v[32:35], v[32:35], v[140:143]
  ds_read_b128 v[68:71], v185 offset:49152
  v_mfma_f32_16x16x32_bf16 v[144:147], v[152:155], v[32:35], v[144:147]
  ds_read_b64_tr_b16 v[72:73], v188 offset:49152
  v_mfma_f32_16x16x32_bf16 v[140:143], v[48:51], v[48:51], v[140:143]
  ds_read_b64_tr_b16 v[74:75], v188 offset:49408
  v_mfma_f32_16x16x32_bf16 v[144:147], v[152:155], v[48:51], v[144:147]
  ds_read_b64_tr_b16 v[76:77], v189 offset:49152
  v_mfma_f32_16x16x32_bf16 v[148:151], v[40:43], v[152:155], v[148:151]
  ds_read_b64_tr_b16 v[78:79], v189 offset:49408
  v_mfma_f32_16x16x32_bf16 v[96:99], v[40:43], v[32:35], v[96:99]
  ds_read_b128 v[80:83], v186 offset:49152
  v_mfma_f32_16x16x32_bf16 v[104:107], v[40:43], v[36:39], v[104:107]
  ds_read_b128 v[84:87], v187 offset:49152
  v_mfma_f32_16x16x32_bf16 v[100:103], v[44:47], v[32:35], v[100:103]
  ds_read_b64_tr_b16 v[88:89], v190 offset:49152
  v_mfma_f32_16x16x32_bf16 v[108:111], v[44:47], v[36:39], v[108:111]
  ds_read_b64_tr_b16 v[90:91], v190 offset:49408
  v_mfma_f32_16x16x32_bf16 v[96:99], v[56:59], v[48:51], v[96:99]
  ds_read_b64_tr_b16 v[92:93], v191 offset:49152
  v_mfma_f32_16x16x32_bf16 v[104:107], v[56:59], v[52:55], v[104:107]
  ds_read_b64_tr_b16 v[94:95], v191 offset:49408
  v_mfma_f32_16x16x32_bf16 v[100:103], v[60:63], v[48:51], v[100:103]
  v_mfma_f32_16x16x32_bf16 v[108:111], v[60:63], v[52:55], v[108:111]
  s_add_u32 s12, s12, s14
  s_sub_u32 s9, s12, 9
  s_cmp_ge_u32 s12, 9
  s_cselect_b32 s12, s9, s12
  s_lshl_b32 s15, s12, 7
  s_add_u32 s15, s15, s10
  s_add_u32 m0, s13, 76800
  s_mul_i32 s9, s12, 73728
  buffer_load_dwordx4 v6, s[48:51], s15 offen lds
  s_add_u32 m0, m0, 8128
  s_add_u32 s9, s9, s11
  buffer_load_dwordx4 v6, s[48:51], s15 offen offset:64 lds
  s_add_u32 m0, m0, 8256
  s_nop 0
  buffer_load_dwordx4 v6, s[44:47], s9 offen lds
  v_add_u32 v184, -74240, v184
  v_add_u32 v185, -74240, v185
  v_add_u32 v186, -74240, v186
  v_add_u32 v187, -74240, v187
  v_add_u32 v188, -74240, v188
  v_add_u32 v189, -74240, v189
  v_add_u32 v190, -74240, v190
  v_add_u32 v191, -74240, v191
  s_waitcnt vmcnt(6) lgkmcnt(0)
  s_barrier
  ds_read_b128 v[32:35], v184 offset:0
  v_mfma_f32_16x16x32_bf16 v[140:143], v[64:67], v[64:67], v[140:143]
  ds_read_b128 v[36:39], v185 offset:0
  v_mfma_f32_16x16x32_bf16 v[144:147], v[152:155], v[64:67], v[144:147]
  ds_read_b64_tr_b16 v[40:41], v188 offset:0
  v_mfma_f32_16x16x32_bf16 v[140:143], v[80:83], v[80:83], v[140:143]
  ds_read_b64_tr_b16 v[42:43], v188 offset:256
  v_mfma_f32_16x16x32_bf16 v[144:147], v[152:155], v[80:83], v[144:147]
  ds_read_b64_tr_b16 v[44:45], v189 offset:0
  v_mfma_f32_16x16x32_bf16 v[148:151], v[72:75], v[152:155], v[148:151]
  ds_read_b64_tr_b16 v[46:47], v189 offset:256
  v_mfma_f32_16x16x32_bf16 v[96:99], v[72:75], v[64:67], v[96:99]
  ds_read_b128 v[48:51], v186 offset:0
  v_mfma_f32_16x16x32_bf16 v[104:107], v[72:75], v[68:71], v[104:107]
  ds_read_b128 v[52:55], v187 offset:0
  v_mfma_f32_16x16x32_bf16 v[100:103], v[76:79], v[64:67], v[100:103]
  ds_read_b64_tr_b16 v[56:57], v190 offset:0
  v_mfma_f32_16x16x32_bf16 v[108:111], v[76:79], v[68:71], v[108:111]
  ds_read_b64_tr_b16 v[58:59], v190 offset:256
  v_mfma_f32_16x16x32_bf16 v[96:99], v[88:91], v[80:83], v[96:99]
  ds_read_b64_tr_b16 v[60:61], v191 offset:0
  v_mfma_f32_16x16x32_bf16 v[104:107], v[88:91], v[84:87], v[104:107]
  ds_read_b64_tr_b16 v[62:63], v191 offset:256
  v_mfma_f32_16x16x32_bf16 v[100:103], v[92:95], v[80:83], v[100:103]
  v_mfma_f32_16x16x32_bf16 v[108:111], v[92:95], v[84:87], v[108:111]
  s_add_u32 m0, s67, 49152
  s_add_u32 s9, s66, 442368
  buffer_load_dwordx4 v30, s[52:55], s9 offen lds
  s_add_u32 m0, s67, 57344
  s_add_u32 s9, s66, 516096
  buffer_load_dwordx4 v30, s[52:55], s9 offen lds
  s_add_u32 m0, s67, 65536
  s_add_u32 s9, s66, 589824
  buffer_load_dwordx4 v30, s[52:55], s9 offen lds
  s_waitcnt vmcnt(6) lgkmcnt(0)
  s_barrier
  ds_read_b128 v[64:67], v184 offset:24576
  v_mfma_f32_16x16x32_bf16 v[140:143], v[32:35], v[32:35], v[140:143]
  ds_read_b128 v[68:71], v185 offset:24576
  v_mfma_f32_16x16x32_bf16 v[144:147], v[152:155], v[32:35], v[144:147]
  ds_read_b64_tr_b16 v[72:73], v188 offset:24576
  v_mfma_f32_16x16x32_bf16 v[140:143], v[48:51], v[48:51], v[140:143]
  ds_read_b64_tr_b16 v[74:75], v188 offset:24832
  v_mfma_f32_16x16x32_bf16 v[144:147], v[152:155], v[48:51], v[144:147]
  ds_read_b64_tr_b16 v[76:77], v189 offset:24576
  v_mfma_f32_16x16x32_bf16 v[148:151], v[40:43], v[152:155], v[148:151]
  ds_read_b64_tr_b16 v[78:79], v189 offset:24832
  v_mfma_f32_16x16x32_bf16 v[96:99], v[40:43], v[32:35], v[96:99]
  ds_read_b128 v[80:83], v186 offset:24576
  v_mfma_f32_16x16x32_bf16 v[104:107], v[40:43], v[36:39], v[104:107]
  ds_read_b128 v[84:87], v187 offset:24576
  v_mfma_f32_16x16x32_bf16 v[100:103], v[44:47], v[32:35], v[100:103]
  ds_read_b64_tr_b16 v[88:89], v190 offset:24576
  v_mfma_f32_16x16x32_bf16 v[108:111], v[44:47], v[36:39], v[108:111]
  ds_read_b64_tr_b16 v[90:91], v190 offset:24832
  v_mfma_f32_16x16x32_bf16 v[96:99], v[56:59], v[48:51], v[96:99]
  ds_read_b64_tr_b16 v[92:93], v191 offset:24576
  v_mfma_f32_16x16x32_bf16 v[104:107], v[56:59], v[52:55], v[104:107]
  ds_read_b64_tr_b16 v[94:95], v191 offset:24832
  v_mfma_f32_16x16x32_bf16 v[100:103], v[60:63], v[48:51], v[100:103]
  v_mfma_f32_16x16x32_bf16 v[108:111], v[60:63], v[52:55], v[108:111]
  s_add_u32 m0, s67, 0
  s_add_u32 s9, s66, 0
  buffer_load_dwordx4 v30, s[52:55], s9 offen lds
  s_add_u32 m0, s67, 8192
  s_add_u32 s9, s66, 73728
  buffer_load_dwordx4 v30, s[52:55], s9 offen lds
  s_add_u32 m0, s67, 16384
  s_add_u32 s9, s66, 147456
  buffer_load_dwordx4 v30, s[52:55], s9 offen lds
  v_add_u32 v184, 74240, v184
  v_add_u32 v185, 74240, v185
  v_add_u32 v186, 74240, v186
  v_add_u32 v187, 74240, v187
  v_add_u32 v188, 74240, v188
  v_add_u32 v189, 74240, v189
  v_add_u32 v190, 74240, v190
  v_add_u32 v191, 74240, v191
  s_waitcnt vmcnt(6) lgkmcnt(0)
  s_barrier
  ds_read_b128 v[32:35], v184 offset:0
  v_mfma_f32_16x16x32_bf16 v[140:143], v[64:67], v[64:67], v[140:143]
  ds_read_b128 v[36:39], v185 offset:0
  v_mfma_f32_16x16x32_bf16 v[144:147], v[152:155], v[64:67], v[144:147]
  ds_read_b64_tr_b16 v[40:41], v188 offset:0
  v_mfma_f32_16x16x32_bf16 v[140:143], v[80:83], v[80:83], v[140:143]
  ds_read_b64_tr_b16 v[42:43], v188 offset:256
  v_mfma_f32_16x16x32_bf16 v[144:147], v[152:155], v[80:83], v[144:147]
  ds_read_b64_tr_b16 v[44:45], v189 offset:0
  v_mfma_f32_16x16x32_bf16 v[148:151], v[72:75], v[152:155], v[148:151]
  ds_read_b64_tr_b16 v[46:47], v189 offset:256
  v_mfma_f32_16x16x32_bf16 v[96:99], v[72:75], v[64:67], v[96:99]
  ds_read_b128 v[48:51], v186 offset:0
  v_mfma_f32_16x16x32_bf16 v[104:107], v[72:75], v[68:71], v[104:107]
  ds_read_b128 v[52:55], v187 offset:0
  v_mfma_f32_16x16x32_bf16 v[100:103], v[76:79], v[64:67], v[100:103]
  ds_read_b64_tr_b16 v[56:57], v190 offset:0
  v_mfma_f32_16x16x32_bf16 v[108:111], v[76:79], v[68:71], v[108:111]
  ds_read_b64_tr_b16 v[58:59], v190 offset:256
  v_mfma_f32_16x16x32_bf16 v[96:99], v[88:91], v[80:83], v[96:99]
  ds_read_b64_tr_b16 v[60:61], v191 offset:0
  v_mfma_f32_16x16x32_bf16 v[104:107], v[88:91], v[84:87], v[104:107]
  ds_read_b64_tr_b16 v[62:63], v191 offset:256
  v_mfma_f32_16x16x32_bf16 v[100:103], v[92:95], v[80:83], v[100:103]
  v_mfma_f32_16x16x32_bf16 v[108:111], v[92:95], v[84:87], v[108:111]
  s_add_u32 m0, s67, 24576
  s_add_u32 s9, s66, 221184
  buffer_load_dwordx4 v30, s[52:55], s9 offen lds
  s_add_u32 m0, s67, 32768
  s_add_u32 s9, s66, 294912
  buffer_load_dwordx4 v30, s[52:55], s9 offen lds
  s_add_u32 m0, s67, 40960
  s_add_u32 s9, s66, 368640
  buffer_load_dwordx4 v30, s[52:55], s9 offen lds
  s_load_dword s69, s[40:41], 0
  s_waitcnt lgkmcnt(0)
  v_mfma_f32_16x16x32_bf16 v[140:143], v[32:35], v[32:35], v[140:143]
  v_mfma_f32_16x16x32_bf16 v[144:147], v[152:155], v[32:35], v[144:147]
  v_mfma_f32_16x16x32_bf16 v[140:143], v[48:51], v[48:51], v[140:143]
  v_mfma_f32_16x16x32_bf16 v[144:147], v[152:155], v[48:51], v[144:147]
  v_mfma_f32_16x16x32_bf16 v[148:151], v[40:43], v[152:155], v[148:151]
  v_mfma_f32_16x16x32_bf16 v[96:99], v[40:43], v[32:35], v[96:99]
  s_nop 4
  v_cndmask_b32 v112, 0, v140, s[18:19]
  v_cndmask_b32 v112, v112, v141, s[20:21]
  v_cndmask_b32 v112, v112, v142, s[22:23]
  v_cndmask_b32 v112, v112, v143, s[28:29]
  v_mul_f32 v114, 0xbae38e39, v144
  v_mfma_f32_16x16x32_bf16 v[104:107], v[40:43], v[36:39], v[104:107]
  v_mov_b32 v7, v112
  s_nop 1
  v_permlane32_swap_b32 v112, v7
  v_add_f32 v112, v112, v7
  v_mov_b32 v7, v112
  v_mfma_f32_16x16x32_bf16 v[100:103], v[44:47], v[32:35], v[100:103]
  s_nop 1
  v_permlane16_swap_b32 v112, v7
  v_add_f32 v112, v112, v7
  v_mul_f32 v7, 0x3ae38e39, v112
  v_fma_f32 v7, -v114, v114, v7
  v_mfma_f32_16x16x32_bf16 v[108:111], v[44:47], v[36:39], v[108:111]
  v_max_f32 v7, 0, v7
  v_add_f32 v8, 0x3727c5ac, v7
  v_rsq_f32 v112, v8
  s_nop 0
  v_mul_f32 v8, v112, v112
  v_mfma_f32_16x16x32_bf16 v[96:99], v[56:59], v[48:51], v[96:99]
  v_fmaak_f32 v8, v8, v7, 0x3727c5ac
  v_rsq_f32 v8, v8
  v_mul_f32 v113, v114, v112
  v_mul_f32 v115, v8, v112
  v_mfma_f32_16x16x32_bf16 v[104:107], v[56:59], v[52:55], v[104:107]
  v_mfma_f32_16x16x32_bf16 v[100:103], v[60:63], v[48:51], v[100:103]
  v_mfma_f32_16x16x32_bf16 v[108:111], v[60:63], v[52:55], v[108:111]
G_lj:
  ds_write_b128 v24, v[148:151]
  ds_write_b128 v26, v[112:115]
  s_waitcnt lgkmcnt(0)
  s_barrier
  ds_read_b128 v[124:127], v28 offset:0
  ds_read_b128 v[128:131], v28 offset:64
  ds_read_b128 v[132:135], v29 offset:0
  ds_read_b128 v[136:139], v29 offset:64
  ds_read_b128 v[116:119], v27
  s_mov_b32 s63, 9699328
  v_min_u32 v31, 240, v25
  v_mov_b32 v192, 0
  s_cmp_eq_u32 s69, 0
  s_cselect_b32 s9, 0, s3
  s_cmp_lg_u32 s9, 7
  s_cbranch_scc1 G_w0
  buffer_load_dwordx4 v[192:195], v25, s[56:59], s63 offen sc1
  buffer_load_dwordx4 v[196:199], v25, s[56:59], s63 offen offset:1024 sc1
  buffer_load_dwordx4 v[200:203], v31, s[56:59], s63 offen offset:2048 sc1
G_w0:
  s_mov_b32 s100, 2
  s_cmp_lt_u32 s3, 4
  s_cbranch_scc1 G_t0
  s_cmp_ge_u32 s2, 128
  s_cbranch_scc1 G_t0
  s_mov_b32 s100, 0
  s_mov_b32 s44, s24
  s_mov_b32 s45, s25
  s_mov_b32 s46, 2359296
  s_mov_b32 s47, 0x20000
  s_add_u32 s9, s2, 448
  s_lshl_b32 s9, s9, 12
  s_sub_u32 s15, s3, 4
  s_lshl_b32 s15, s15, 10
  s_add_u32 s9, s9, s15
  s_add_u32 m0, s15, 118528
  s_nop 0
  buffer_load_dwordx4 v25, s[44:47], s9 offen nt lds
G_t0:
  s_cmp_lg_u32 s61, 0
  s_cbranch_scc1 G_ns
  s_mov_b64 exec, 0xffff
  buffer_store_dwordx4 v[112:115], v13, s[56:59], s68 offen sc1
  s_mov_b64 exec, -1
G_ns:
  v_mov_b32 v120, v114
  v_mov_b32 v121, v114
  v_mov_b32 v122, v115
  v_mov_b32 v123, v115
  s_waitcnt lgkmcnt(0)
  v_pk_add_f32 v[124:125], v[124:125], v[128:129]
  v_pk_add_f32 v[126:127], v[126:127], v[130:131]
  v_pk_add_f32 v[132:133], v[132:133], v[136:137]
  v_pk_add_f32 v[134:135], v[134:135], v[138:139]
  v_mov_b32 v116, v118
  v_mov_b32 v117, v118
  v_mov_b32 v118, v119
  v_pk_fma_f32 v[96:97], v[120:121], v[124:125], v[96:97]
  v_pk_fma_f32 v[98:99], v[120:121], v[126:127], v[98:99]
  v_pk_fma_f32 v[100:101], v[120:121], v[132:133], v[100:101]
  v_pk_fma_f32 v[102:103], v[120:121], v[134:135], v[102:103]
  v_pk_mul_f32 v[96:97], v[96:97], v[122:123]
  v_pk_mul_f32 v[98:99], v[98:99], v[122:123]
  v_pk_mul_f32 v[100:101], v[100:101], v[122:123]
  v_pk_mul_f32 v[102:103], v[102:103], v[122:123]
  v_pk_mul_f32 v[168:169], v[96:97], v[96:97]
  v_pk_mul_f32 v[170:171], v[98:99], v[98:99]
  v_pk_mul_f32 v[172:173], v[100:101], v[100:101]
  v_pk_mul_f32 v[174:175], v[102:103], v[102:103]
  v_pk_fma_f32 v[168:169], v[168:169], v[162:163], v[160:161]
  v_pk_fma_f32 v[170:171], v[170:171], v[162:163], v[160:161]
  v_pk_fma_f32 v[172:173], v[172:173], v[162:163], v[160:161]
  v_pk_fma_f32 v[174:175], v[174:175], v[162:163], v[160:161]
  v_pk_mul_f32 v[168:169], v[168:169], v[96:97]
  v_pk_mul_f32 v[170:171], v[170:171], v[98:99]
  v_pk_mul_f32 v[172:173], v[172:173], v[100:101]
  v_pk_mul_f32 v[174:175], v[174:175], v[102:103]
  v_exp_f32 v168, v168
  v_exp_f32 v169, v169
  v_exp_f32 v170, v170
  v_exp_f32 v171, v171
  v_exp_f32 v172, v172
  v_exp_f32 v173, v173
  v_exp_f32 v174, v174
  v_exp_f32 v175, v175
  v_pk_add_f32 v[168:169], v[168:169], v[164:165]
  v_pk_add_f32 v[170:171], v[170:171], v[164:165]
  v_pk_add_f32 v[172:173], v[172:173], v[164:165]
  v_pk_add_f32 v[174:175], v[174:175], v[164:165]
  v_rcp_f32 v168, v168
  v_rcp_f32 v169, v169
  v_rcp_f32 v170, v170
  v_rcp_f32 v171, v171
  v_rcp_f32 v172, v172
  v_rcp_f32 v173, v173
  v_rcp_f32 v174, v174
  v_rcp_f32 v175, v175
  v_pk_mul_f32 v[96:97], v[168:169], v[96:97]
  v_pk_mul_f32 v[98:99], v[170:171], v[98:99]
  v_pk_mul_f32 v[100:101], v[172:173], v[100:101]
  v_pk_mul_f32 v[102:103], v[174:175], v[102:103]
  s_cmp_lg_u32 s70, 0
  s_cbranch_scc1 GS_1
  v_cvt_pk_bf16_f32 v176, v96, v97
  v_cvt_pk_bf16_f32 v177, v98, v99
  v_cvt_pk_bf16_f32 v178, v100, v101
  v_cvt_pk_bf16_f32 v179, v102, v103
  s_branch GT_2
GS_1:
  v_cvt_pk_bf16_f32 v178, v96, v97
  v_cvt_pk_bf16_f32 v179, v98, v99
  v_cvt_pk_bf16_f32 v176, v100, v101
  v_cvt_pk_bf16_f32 v177, v102, v103
GT_2:
  buffer_store_dwordx4 v[176:179], v25, s[56:59], s65 offen sc1
  v_pk_fma_f32 v[104:105], v[116:117], v[124:125], v[104:105]
  v_pk_fma_f32 v[106:107], v[116:117], v[126:127], v[106:107]
  v_pk_fma_f32 v[108:109], v[116:117], v[132:133], v[108:109]
  v_pk_fma_f32 v[110:111], v[116:117], v[134:135], v[110:111]
  v_pk_mul_f32 v[104:105], v[104:105], v[118:119]
  v_pk_mul_f32 v[106:107], v[106:107], v[118:119]
  v_pk_mul_f32 v[108:109], v[108:109], v[118:119]
  v_pk_mul_f32 v[110:111], v[110:111], v[118:119]
  v_pk_mul_f32 v[168:169], v[104:105], v[104:105]
  v_pk_mul_f32 v[170:171], v[106:107], v[106:107]
  v_pk_mul_f32 v[172:173], v[108:109], v[108:109]
  v_pk_mul_f32 v[174:175], v[110:111], v[110:111]
  v_pk_fma_f32 v[168:169], v[168:169], v[162:163], v[160:161]
  v_pk_fma_f32 v[170:171], v[170:171], v[162:163], v[160:161]
  v_pk_fma_f32 v[172:173], v[172:173], v[162:163], v[160:161]
  v_pk_fma_f32 v[174:175], v[174:175], v[162:163], v[160:161]
  v_pk_mul_f32 v[168:169], v[168:169], v[104:105]
  v_pk_mul_f32 v[170:171], v[170:171], v[106:107]
  v_pk_mul_f32 v[172:173], v[172:173], v[108:109]
  v_pk_mul_f32 v[174:175], v[174:175], v[110:111]
  v_exp_f32 v168, v168
  v_exp_f32 v169, v169
  v_exp_f32 v170, v170
  v_exp_f32 v171, v171
  v_exp_f32 v172, v172
  v_exp_f32 v173, v173
  v_exp_f32 v174, v174
  v_exp_f32 v175, v175
  v_pk_add_f32 v[168:169], v[168:169], v[164:165]
  v_pk_add_f32 v[170:171], v[170:171], v[164:165]
  v_pk_add_f32 v[172:173], v[172:173], v[164:165]
  v_pk_add_f32 v[174:175], v[174:175], v[164:165]
  v_rcp_f32 v168, v168
  v_rcp_f32 v169, v169
  v_rcp_f32 v170, v170
  v_rcp_f32 v171, v171
  v_rcp_f32 v172, v172
  v_rcp_f32 v173, v173
  v_rcp_f32 v174, v174
  v_rcp_f32 v175, v175
  v_pk_mul_f32 v[104:105], v[168:169], v[104:105]
  v_pk_mul_f32 v[106:107], v[170:171], v[106:107]
  v_pk_mul_f32 v[108:109], v[172:173], v[108:109]
  v_pk_mul_f32 v[110:111], v[174:175], v[110:111]
  s_cmp_lg_u32 s70, 0
  s_cbranch_scc1 GS_3
  v_cvt_pk_bf16_f32 v180, v104, v105
  v_cvt_pk_bf16_f32 v181, v106, v107
  v_cvt_pk_bf16_f32 v182, v108, v109
  v_cvt_pk_bf16_f32 v183, v110, v111
  s_branch GT_4
GS_3:
  v_cvt_pk_bf16_f32 v182, v104, v105
  v_cvt_pk_bf16_f32 v183, v106, v107
  v_cvt_pk_bf16_f32 v180, v108, v109
  v_cvt_pk_bf16_f32 v181, v110, v111
GT_4:
  buffer_store_dwordx4 v[180:183], v25, s[56:59], s98 offen sc1
  v_lshlrev_b32 v2, 4, v1
  v_add_u32 v3, 4096, v2
  v_lshlrev_b32 v4, 2, v1
  s_lshl_b32 s8, s60, 3
  s_add_u32 s8, s8, s3
  v_and_b32 v11, 1, v1
  v_lshlrev_b32 v11, 6, v11
  v_add_u32 v11, v11, v18
  v_add_u32 v28, 36864, v22
  v_add_u32 v29, 36864, v23
  v_and_b32 v8, 15, v1
  s_lshl_b32 s10, s8, 4
  v_add_u32 v8, s10, v8
  v_lshlrev_b32 v9, 4, v18
  s_movk_i32 s13, 18432
  v_mov_b32 v10, 0x80000000
  v_add_u32 v5, -1, v8
  v_cmp_gt_u32 vcc, 2048, v5
  v_lshrrev_b32 v6, 4, v5
  v_mad_u32_u24 v6, v6, s13, v9
  v_and_b32 v5, 15, v5
  v_lshl_add_u32 v6, v5, 4, v6
  v_cndmask_b32 v24, v10, v6, vcc
  v_add_u32 v5, 1, v8
  v_cmp_gt_u32 vcc, 2048, v5
  v_lshrrev_b32 v6, 4, v5
  v_mad_u32_u24 v6, v6, s13, v9
  v_and_b32 v5, 15, v5
  v_lshl_add_u32 v6, v5, 4, v6
  v_cndmask_b32 v25, v10, v6, vcc
  v_add_u32 v5, -2, v8
  v_cmp_gt_u32 vcc, 2048, v5
  v_lshrrev_b32 v6, 4, v5
  v_mad_u32_u24 v6, v6, s13, v9
  v_and_b32 v5, 15, v5
  v_lshl_add_u32 v6, v5, 4, v6
  v_cndmask_b32 v26, v10, v6, vcc
  v_add_u32 v5, 2, v8
  v_cmp_gt_u32 vcc, 2048, v5
  v_lshrrev_b32 v6, 4, v5
  v_mad_u32_u24 v6, v6, s13, v9
  v_and_b32 v5, 15, v5
  v_lshl_add_u32 v6, v5, 4, v6
  v_cndmask_b32 v27, v10, v6, vcc
  s_mul_i32 s11, s8, 18432
  s_lshl_b32 s9, s61, 11
  s_add_u32 s11, s11, s9
  s_add_u32 s11, s11, 2359296
  s_mul_i32 s6, s60, 4352
  s_add_u32 s6, s6, 9965568
  s_lshl_b32 s10, s3, 8
  s_add_u32 s10, s10, 150528
  v_add_u32 v13, s10, v13
  s_mov_b32 s14, 0
  ds_read_b64 v[18:19], v13
  s_cmp_lg_u32 s69, 0
  s_cbranch_scc1 G_zk
  s_load_dword s9, s[40:41], 0
  s_waitcnt lgkmcnt(0)
  s_cmp_lg_u32 s9, 0
  s_cbranch_scc1 ZD_6
  s_mov_b32 s9, 0x20000
  v_mov_b32 v14, 0
ZP_5:
  global_load_dword v15, v14, s[40:41] sc1
  s_waitcnt vmcnt(0)
  v_cmp_eq_u32 vcc, 0, v15
  s_cbranch_vccz ZD_6
  s_sleep 4
  s_sub_u32 s9, s9, 1
  s_cbranch_scc0 ZP_5
ZD_6:
G_zk:
  s_waitcnt vmcnt(2)
  s_cmp_lg_u32 s3, 7
  s_cbranch_scc1 G_wm
  s_mov_b32 s13, 0x20000
W2_m:
  v_min3_u32 v6, v192, v196, v200
  v_cmp_eq_u32 vcc, 0, v6
  s_cbranch_vccz W2_n
  buffer_load_dwordx4 v[192:195], v2, s[56:59], s63 offen sc1
  buffer_load_dwordx4 v[196:199], v2, s[56:59], s63 offen offset:1024 sc1
  buffer_load_dwordx4 v[200:203], v31, s[56:59], s63 offen offset:2048 sc1
  s_waitcnt vmcnt(0)
  s_sleep 2
  s_sub_u32 s13, s13, 1
  s_cbranch_scc0 W2_m
W2_n:
  ds_write_b128 v2, v[192:195] offset:0
  ds_write_b128 v2, v[196:199] offset:1024
  ds_write_b128 v31, v[200:203] offset:2048
  s_waitcnt lgkmcnt(0)
G_wm:
  s_waitcnt vmcnt(0)
  s_mov_b64 exec, 1
  ds_add_rtn_u32 v5, v16, v17 offset:52
  s_mov_b64 exec, -1
  s_waitcnt lgkmcnt(0)
  v_readfirstlane_b32 s7, v5
  s_cmp_lg_u32 s7, 7
  s_cbranch_scc1 G_hs
  s_atomic_add s101, s[42:43], s6
G_hs:
  s_barrier
  ds_read_b128 v[104:107], v11 offset:0
  ds_read_b64_tr_b16 v[108:109], v22 offset:0
  ds_read_b64_tr_b16 v[110:111], v22 offset:2048
  ds_read_b64_tr_b16 v[112:113], v23 offset:0
  ds_read_b64_tr_b16 v[114:115], v23 offset:2048
  ds_read_b64_tr_b16 v[116:117], v22 offset:1024
  ds_read_b64_tr_b16 v[118:119], v22 offset:3072
  ds_read_b64_tr_b16 v[120:121], v23 offset:1024
  ds_read_b64_tr_b16 v[122:123], v23 offset:3072
  ds_read_b128 v[124:127], v11 offset:128
  ds_read_b64_tr_b16 v[128:129], v22 offset:4096
  ds_read_b64_tr_b16 v[130:131], v22 offset:6144
  ds_read_b64_tr_b16 v[132:133], v23 offset:4096
  ds_read_b64_tr_b16 v[134:135], v23 offset:6144
  ds_read_b64_tr_b16 v[136:137], v22 offset:5120
  ds_read_b64_tr_b16 v[138:139], v22 offset:7168
  ds_read_b64_tr_b16 v[140:141], v23 offset:5120
  ds_read_b64_tr_b16 v[142:143], v23 offset:7168
  ds_read_b128 v[144:147], v11 offset:256
  ds_read_b64_tr_b16 v[148:149], v22 offset:8192
  ds_read_b64_tr_b16 v[150:151], v22 offset:10240
  ds_read_b64_tr_b16 v[152:153], v23 offset:8192
  ds_read_b64_tr_b16 v[154:155], v23 offset:10240
  ds_read_b64_tr_b16 v[156:157], v22 offset:9216
  ds_read_b64_tr_b16 v[158:159], v22 offset:11264
  ds_read_b64_tr_b16 v[160:161], v23 offset:9216
  ds_read_b64_tr_b16 v[162:163], v23 offset:11264
  ds_read_b128 v[164:167], v11 offset:384
  ds_read_b64_tr_b16 v[168:169], v22 offset:12288
  ds_read_b64_tr_b16 v[170:171], v22 offset:14336
  ds_read_b64_tr_b16 v[172:173], v23 offset:12288
  ds_read_b64_tr_b16 v[174:175], v23 offset:14336
  ds_read_b64_tr_b16 v[176:177], v22 offset:13312
  ds_read_b64_tr_b16 v[178:179], v22 offset:15360
  ds_read_b64_tr_b16 v[180:181], v23 offset:13312
  ds_read_b64_tr_b16 v[182:183], v23 offset:15360
  ds_read_b128 v[184:187], v11 offset:512
  ds_read_b64_tr_b16 v[188:189], v22 offset:16384
  ds_read_b64_tr_b16 v[190:191], v22 offset:18432
  ds_read_b64_tr_b16 v[192:193], v23 offset:16384
  ds_read_b64_tr_b16 v[194:195], v23 offset:18432
  ds_read_b64_tr_b16 v[196:197], v22 offset:17408
  ds_read_b64_tr_b16 v[198:199], v22 offset:19456
  ds_read_b64_tr_b16 v[200:201], v23 offset:17408
  ds_read_b64_tr_b16 v[202:203], v23 offset:19456
  ds_read_b128 v[204:207], v11 offset:640
  ds_read_b64_tr_b16 v[208:209], v22 offset:20480
  ds_read_b64_tr_b16 v[210:211], v22 offset:22528
  ds_read_b64_tr_b16 v[212:213], v23 offset:20480
  ds_read_b64_tr_b16 v[214:215], v23 offset:22528
  ds_read_b64_tr_b16 v[216:217], v22 offset:21504
  ds_read_b64_tr_b16 v[218:219], v22 offset:23552
  ds_read_b64_tr_b16 v[220:221], v23 offset:21504
  ds_read_b64_tr_b16 v[222:223], v23 offset:23552
  ds_read_b64 v[244:245], v20 offset:0
  ds_read_b64 v[246:247], v21 offset:0
  ds_read_b64 v[248:249], v20 offset:8192
  ds_read_b64 v[250:251], v21 offset:8192
  s_cmp_lg_u32 s3, 1
  s_cbranch_scc1 G2_hw
  s_mov_b32 s13, 0x40000
CP_7:
  s_load_dword s48, s[42:43], s6 glc
  s_waitcnt lgkmcnt(0)
  s_cmp_ge_u32 s48, 9
  s_cbranch_scc1 CD_8
  s_sleep 1
  s_sub_u32 s13, s13, 1
  s_cbranch_scc0 CP_7
CD_8:
G2_hw:
  s_cmp_lg_u32 s100, 0
  s_cbranch_scc1 G_t1
  s_add_u32 s7, s2, 448
  s_lshr_b32 s7, s7, 6
  s_lshl_b32 s7, s7, 7
  s_add_u32 s99, s7, 10078080
G_t1:
  s_sub_u32 s7, s6, 4352
  s_add_u32 s12, s6, 4352
  s_cmp_eq_u32 s3, 0
  s_cselect_b32 s12, s7, s12
  s_waitcnt lgkmcnt(0)
  s_barrier
  s_add_u32 s7, s8, 1
  s_and_b32 s9, s7, 7
  s_cmp_ge_u32 s9, 2
  s_cbranch_scc1 G2_hg
  s_and_b32 s7, s7, 127
  s_cmp_lt_u32 s7, 2
  s_cbranch_scc1 G2_hg
  s_mov_b32 s13, 0x40000
CP_9:
  s_load_dword s48, s[42:43], s12 glc
  s_waitcnt lgkmcnt(0)
  s_cmp_ge_u32 s48, 9
  s_cbranch_scc1 CD_10
  s_sleep 1
  s_sub_u32 s13, s13, 1
  s_cbranch_scc0 CP_9
CD_10:
G2_hg:
  s_cmp_lg_u32 s100, 0
  s_cbranch_scc1 G_t3
  s_load_dword s49, s[42:43], s99
G_t3:
  buffer_load_dwordx4 v[32:35], v24, s[56:59], s14 offen offset:0 sc1
  buffer_load_dwordx4 v[36:39], v24, s[56:59], s14 offen offset:1024 sc1
  buffer_load_dwordx4 v[40:43], v24, s[56:59], s14 offen offset:2048 sc1
  buffer_load_dwordx4 v[44:47], v24, s[56:59], s14 offen offset:3072 sc1
  s_add_u32 s14, s14, 4096
  buffer_load_dwordx2 v[48:49], v24, s[56:59], s14 offen offset:0 sc1
  buffer_load_dwordx2 v[50:51], v25, s[56:59], s14 offen offset:8 sc1
  s_waitcnt vmcnt(5)
  buffer_load_dwordx4 v[52:55], v25, s[56:59], s14 offen offset:1024 sc1
  v_mfma_f32_16x16x32_bf16 v[224:227], v[104:107], v[32:35], 0
  ds_read_b128 v[104:107], v11 offset:768
  v_mfma_f32_16x16x32_bf16 v[228:231], v[108:111], v[32:35], 0
  ds_read_b64_tr_b16 v[108:109], v22 offset:24576
  ds_read_b64_tr_b16 v[110:111], v22 offset:26624
  v_mfma_f32_16x16x32_bf16 v[232:235], v[112:115], v[32:35], 0
  ds_read_b64_tr_b16 v[112:113], v23 offset:24576
  ds_read_b64_tr_b16 v[114:115], v23 offset:26624
  v_mfma_f32_16x16x32_bf16 v[236:239], v[116:119], v[32:35], 0
  ds_read_b64_tr_b16 v[116:117], v22 offset:25600
  ds_read_b64_tr_b16 v[118:119], v22 offset:27648
  v_mfma_f32_16x16x32_bf16 v[240:243], v[120:123], v[32:35], 0
  ds_read_b64_tr_b16 v[120:121], v23 offset:25600
  ds_read_b64_tr_b16 v[122:123], v23 offset:27648
  s_waitcnt vmcnt(5)
  buffer_load_dwordx4 v[56:59], v25, s[56:59], s14 offen offset:2048 sc1
  s_cmp_lg_u32 s100, 0
  s_cbranch_scc1 G_t2
  s_waitcnt lgkmcnt(0)
  s_cmp_eq_u32 s49, 0
  s_cbranch_scc1 G_t2
  s_mov_b32 s100, 1
  s_add_u32 s9, s2, 448
  s_mul_i32 s9, s9, 4224
  s_add_u32 s9, s9, 4718592
  s_sub_u32 s15, s3, 4
  s_lshl_b32 s15, s15, 10
  v_add_u32 v5, s15, v2
  s_add_u32 m0, s15, 101376
  s_add_u32 s7, s9, 4
  buffer_load_dwordx4 v5, s[56:59], s9 offen sc1 lds
  s_add_u32 m0, s15, 109696
  s_nop 0
  buffer_load_dwordx4 v5, s[56:59], s7 offen sc1 lds
  s_mov_b64 exec, 7
  s_mov_b32 m0, 105472
  s_nop 0
  buffer_load_dwordx4 v3, s[56:59], s9 offen sc1 lds
  s_mov_b32 m0, 113792
  s_nop 0
  buffer_load_dwordx4 v3, s[56:59], s7 offen sc1 lds
  s_mov_b64 exec, -1
G_t2:
  v_mfma_f32_16x16x32_bf16 v[224:227], v[124:127], v[36:39], v[224:227]
  ds_read_b128 v[124:127], v11 offset:896
  v_mfma_f32_16x16x32_bf16 v[228:231], v[128:131], v[36:39], v[228:231]
  ds_read_b64_tr_b16 v[128:129], v22 offset:28672
  ds_read_b64_tr_b16 v[130:131], v22 offset:30720
  v_mfma_f32_16x16x32_bf16 v[232:235], v[132:135], v[36:39], v[232:235]
  ds_read_b64_tr_b16 v[132:133], v23 offset:28672
  ds_read_b64_tr_b16 v[134:135], v23 offset:30720
  v_mfma_f32_16x16x32_bf16 v[236:239], v[136:139], v[36:39], v[236:239]
  ds_read_b64_tr_b16 v[136:137], v22 offset:29696
  ds_read_b64_tr_b16 v[138:139], v22 offset:31744
  v_mfma_f32_16x16x32_bf16 v[240:243], v[140:143], v[36:39], v[240:243]
  ds_read_b64_tr_b16 v[140:141], v23 offset:29696
  ds_read_b64_tr_b16 v[142:143], v23 offset:31744
  s_waitcnt vmcnt(5)
  buffer_load_dwordx4 v[60:63], v25, s[56:59], s14 offen offset:3072 sc1
  v_mfma_f32_16x16x32_bf16 v[224:227], v[144:147], v[40:43], v[224:227]
  ds_read_b128 v[144:147], v11 offset:1024
  v_mfma_f32_16x16x32_bf16 v[228:231], v[148:151], v[40:43], v[228:231]
  ds_read_b64_tr_b16 v[148:149], v22 offset:32768
  ds_read_b64_tr_b16 v[150:151], v22 offset:34816
  v_mfma_f32_16x16x32_bf16 v[232:235], v[152:155], v[40:43], v[232:235]
  ds_read_b64_tr_b16 v[152:153], v23 offset:32768
  ds_read_b64_tr_b16 v[154:155], v23 offset:34816
  v_mfma_f32_16x16x32_bf16 v[236:239], v[156:159], v[40:43], v[236:239]
  ds_read_b64_tr_b16 v[156:157], v22 offset:33792
  ds_read_b64_tr_b16 v[158:159], v22 offset:35840
  v_mfma_f32_16x16x32_bf16 v[240:243], v[160:163], v[40:43], v[240:243]
  ds_read_b64_tr_b16 v[160:161], v23 offset:33792
  ds_read_b64_tr_b16 v[162:163], v23 offset:35840
  s_waitcnt vmcnt(5)
  s_add_u32 s14, s14, 4096
  buffer_load_dwordx4 v[64:67], v25, s[56:59], s14 offen offset:0 sc1
  v_mfma_f32_16x16x32_bf16 v[224:227], v[164:167], v[44:47], v[224:227]
  ds_read_b128 v[164:167], v11 offset:1152
  v_mfma_f32_16x16x32_bf16 v[228:231], v[168:171], v[44:47], v[228:231]
  ds_read_b64_tr_b16 v[168:169], v28 offset:0
  ds_read_b64_tr_b16 v[170:171], v28 offset:2048
  v_mfma_f32_16x16x32_bf16 v[232:235], v[172:175], v[44:47], v[232:235]
  ds_read_b64_tr_b16 v[172:173], v29 offset:0
  ds_read_b64_tr_b16 v[174:175], v29 offset:2048
  v_mfma_f32_16x16x32_bf16 v[236:239], v[176:179], v[44:47], v[236:239]
  ds_read_b64_tr_b16 v[176:177], v28 offset:1024
  ds_read_b64_tr_b16 v[178:179], v28 offset:3072
  v_mfma_f32_16x16x32_bf16 v[240:243], v[180:183], v[44:47], v[240:243]
  ds_read_b64_tr_b16 v[180:181], v29 offset:1024
  ds_read_b64_tr_b16 v[182:183], v29 offset:3072
  s_waitcnt vmcnt(4)
  buffer_load_dwordx4 v[68:71], v26, s[56:59], s14 offen offset:1024 sc1
  v_mfma_f32_16x16x32_bf16 v[224:227], v[184:187], v[48:51], v[224:227]
  ds_read_b128 v[184:187], v11 offset:1280
  v_mfma_f32_16x16x32_bf16 v[228:231], v[188:191], v[48:51], v[228:231]
  ds_read_b64_tr_b16 v[188:189], v28 offset:4096
  ds_read_b64_tr_b16 v[190:191], v28 offset:6144
  v_mfma_f32_16x16x32_bf16 v[232:235], v[192:195], v[48:51], v[232:235]
  ds_read_b64_tr_b16 v[192:193], v29 offset:4096
  ds_read_b64_tr_b16 v[194:195], v29 offset:6144
  v_mfma_f32_16x16x32_bf16 v[236:239], v[196:199], v[48:51], v[236:239]
  ds_read_b64_tr_b16 v[196:197], v28 offset:5120
  ds_read_b64_tr_b16 v[198:199], v28 offset:7168
  v_mfma_f32_16x16x32_bf16 v[240:243], v[200:203], v[48:51], v[240:243]
  ds_read_b64_tr_b16 v[200:201], v29 offset:5120
  ds_read_b64_tr_b16 v[202:203], v29 offset:7168
  s_waitcnt vmcnt(4)
  buffer_load_dwordx4 v[72:75], v26, s[56:59], s14 offen offset:2048 sc1
  v_mfma_f32_16x16x32_bf16 v[224:227], v[204:207], v[52:55], v[224:227]
  ds_read_b128 v[204:207], v11 offset:1408
  v_mfma_f32_16x16x32_bf16 v[228:231], v[208:211], v[52:55], v[228:231]
  ds_read_b64_tr_b16 v[208:209], v28 offset:8192
  ds_read_b64_tr_b16 v[210:211], v28 offset:10240
  v_mfma_f32_16x16x32_bf16 v[232:235], v[212:215], v[52:55], v[232:235]
  ds_read_b64_tr_b16 v[212:213], v29 offset:8192
  ds_read_b64_tr_b16 v[214:215], v29 offset:10240
  v_mfma_f32_16x16x32_bf16 v[236:239], v[216:219], v[52:55], v[236:239]
  ds_read_b64_tr_b16 v[216:217], v28 offset:9216
  ds_read_b64_tr_b16 v[218:219], v28 offset:11264
  v_mfma_f32_16x16x32_bf16 v[240:243], v[220:223], v[52:55], v[240:243]
  ds_read_b64_tr_b16 v[220:221], v29 offset:9216
  ds_read_b64_tr_b16 v[222:223], v29 offset:11264
  s_waitcnt vmcnt(4) lgkmcnt(15)
  buffer_load_dwordx4 v[76:79], v26, s[56:59], s14 offen offset:3072 sc1
  v_mfma_f32_16x16x32_bf16 v[224:227], v[104:107], v[56:59], v[224:227]
  ds_read_b128 v[104:107], v11 offset:1536
  v_mfma_f32_16x16x32_bf16 v[228:231], v[108:111], v[56:59], v[228:231]
  ds_read_b64_tr_b16 v[108:109], v28 offset:12288
  ds_read_b64_tr_b16 v[110:111], v28 offset:14336
  v_mfma_f32_16x16x32_bf16 v[232:235], v[112:115], v[56:59], v[232:235]
  ds_read_b64_tr_b16 v[112:113], v29 offset:12288
  ds_read_b64_tr_b16 v[114:115], v29 offset:14336
  v_mfma_f32_16x16x32_bf16 v[236:239], v[116:119], v[56:59], v[236:239]
  ds_read_b64_tr_b16 v[116:117], v28 offset:13312
  ds_read_b64_tr_b16 v[118:119], v28 offset:15360
  v_mfma_f32_16x16x32_bf16 v[240:243], v[120:123], v[56:59], v[240:243]
  ds_read_b64_tr_b16 v[120:121], v29 offset:13312
  ds_read_b64_tr_b16 v[122:123], v29 offset:15360
  s_waitcnt vmcnt(4) lgkmcnt(15)
  s_add_u32 s14, s14, 4096
  buffer_load_dwordx4 v[80:83], v26, s[56:59], s14 offen offset:0 sc1
  v_mfma_f32_16x16x32_bf16 v[224:227], v[124:127], v[60:63], v[224:227]
  ds_read_b128 v[124:127], v11 offset:1664
  v_mfma_f32_16x16x32_bf16 v[228:231], v[128:131], v[60:63], v[228:231]
  ds_read_b64_tr_b16 v[128:129], v28 offset:16384
  ds_read_b64_tr_b16 v[130:131], v28 offset:18432
  v_mfma_f32_16x16x32_bf16 v[232:235], v[132:135], v[60:63], v[232:235]
  ds_read_b64_tr_b16 v[132:133], v29 offset:16384
  ds_read_b64_tr_b16 v[134:135], v29 offset:18432
  v_mfma_f32_16x16x32_bf16 v[236:239], v[136:139], v[60:63], v[236:239]
  ds_read_b64_tr_b16 v[136:137], v28 offset:17408
  ds_read_b64_tr_b16 v[138:139], v28 offset:19456
  v_mfma_f32_16x16x32_bf16 v[240:243], v[140:143], v[60:63], v[240:243]
  ds_read_b64_tr_b16 v[140:141], v29 offset:17408
  ds_read_b64_tr_b16 v[142:143], v29 offset:19456
  s_waitcnt vmcnt(4) lgkmcnt(15)
  buffer_load_dwordx2 v[84:85], v26, s[56:59], s14 offen offset:1024 sc1
  buffer_load_dwordx2 v[86:87], v27, s[56:59], s14 offen offset:1032 sc1
  v_mfma_f32_16x16x32_bf16 v[224:227], v[144:147], v[64:67], v[224:227]
  ds_read_b128 v[144:147], v11 offset:1792
  v_mfma_f32_16x16x32_bf16 v[228:231], v[148:151], v[64:67], v[228:231]
  ds_read_b64_tr_b16 v[148:149], v28 offset:20480
  ds_read_b64_tr_b16 v[150:151], v28 offset:22528
  v_mfma_f32_16x16x32_bf16 v[232:235], v[152:155], v[64:67], v[232:235]
  ds_read_b64_tr_b16 v[152:153], v29 offset:20480
  ds_read_b64_tr_b16 v[154:155], v29 offset:22528
  v_mfma_f32_16x16x32_bf16 v[236:239], v[156:159], v[64:67], v[236:239]
  ds_read_b64_tr_b16 v[156:157], v28 offset:21504
  ds_read_b64_tr_b16 v[158:159], v28 offset:23552
  v_mfma_f32_16x16x32_bf16 v[240:243], v[160:163], v[64:67], v[240:243]
  ds_read_b64_tr_b16 v[160:161], v29 offset:21504
  ds_read_b64_tr_b16 v[162:163], v29 offset:23552
  s_waitcnt vmcnt(5) lgkmcnt(15)
  buffer_load_dwordx4 v[88:91], v27, s[56:59], s14 offen offset:2048 sc1
  v_mfma_f32_16x16x32_bf16 v[224:227], v[164:167], v[68:71], v[224:227]
  ds_read_b128 v[164:167], v11 offset:1920
  v_mfma_f32_16x16x32_bf16 v[228:231], v[168:171], v[68:71], v[228:231]
  ds_read_b64_tr_b16 v[168:169], v28 offset:24576
  ds_read_b64_tr_b16 v[170:171], v28 offset:26624
  v_mfma_f32_16x16x32_bf16 v[232:235], v[172:175], v[68:71], v[232:235]
  ds_read_b64_tr_b16 v[172:173], v29 offset:24576
  ds_read_b64_tr_b16 v[174:175], v29 offset:26624
  v_mfma_f32_16x16x32_bf16 v[236:239], v[176:179], v[68:71], v[236:239]
  ds_read_b64_tr_b16 v[176:177], v28 offset:25600
  ds_read_b64_tr_b16 v[178:179], v28 offset:27648
  v_mfma_f32_16x16x32_bf16 v[240:243], v[180:183], v[68:71], v[240:243]
  ds_read_b64_tr_b16 v[180:181], v29 offset:25600
  ds_read_b64_tr_b16 v[182:183], v29 offset:27648
  s_waitcnt vmcnt(5) lgkmcnt(15)
  buffer_load_dwordx4 v[92:95], v27, s[56:59], s14 offen offset:3072 sc1
  v_mfma_f32_16x16x32_bf16 v[224:227], v[184:187], v[72:75], v[224:227]
  ds_read_b128 v[184:187], v11 offset:2048
  v_mfma_f32_16x16x32_bf16 v[228:231], v[188:191], v[72:75], v[228:231]
  ds_read_b64_tr_b16 v[188:189], v28 offset:28672
  ds_read_b64_tr_b16 v[190:191], v28 offset:30720
  v_mfma_f32_16x16x32_bf16 v[232:235], v[192:195], v[72:75], v[232:235]
  ds_read_b64_tr_b16 v[192:193], v29 offset:28672
  ds_read_b64_tr_b16 v[194:195], v29 offset:30720
  v_mfma_f32_16x16x32_bf16 v[236:239], v[196:199], v[72:75], v[236:239]
  ds_read_b64_tr_b16 v[196:197], v28 offset:29696
  ds_read_b64_tr_b16 v[198:199], v28 offset:31744
  v_mfma_f32_16x16x32_bf16 v[240:243], v[200:203], v[72:75], v[240:243]
  ds_read_b64_tr_b16 v[200:201], v29 offset:29696
  ds_read_b64_tr_b16 v[202:203], v29 offset:31744
  s_waitcnt vmcnt(5) lgkmcnt(15)
  s_add_u32 s14, s14, 4096
  buffer_load_dwordx4 v[96:99], v27, s[56:59], s14 offen offset:0 sc1
  v_mfma_f32_16x16x32_bf16 v[224:227], v[204:207], v[76:79], v[224:227]
  ds_read_b128 v[204:207], v11 offset:2176
  v_mfma_f32_16x16x32_bf16 v[228:231], v[208:211], v[76:79], v[228:231]
  ds_read_b64_tr_b16 v[208:209], v28 offset:32768
  ds_read_b64_tr_b16 v[210:211], v28 offset:34816
  v_mfma_f32_16x16x32_bf16 v[232:235], v[212:215], v[76:79], v[232:235]
  ds_read_b64_tr_b16 v[212:213], v29 offset:32768
  ds_read_b64_tr_b16 v[214:215], v29 offset:34816
  v_mfma_f32_16x16x32_bf16 v[236:239], v[216:219], v[76:79], v[236:239]
  ds_read_b64_tr_b16 v[216:217], v28 offset:33792
  ds_read_b64_tr_b16 v[218:219], v28 offset:35840
  v_mfma_f32_16x16x32_bf16 v[240:243], v[220:223], v[76:79], v[240:243]
  ds_read_b64_tr_b16 v[220:221], v29 offset:33792
  ds_read_b64_tr_b16 v[222:223], v29 offset:35840
  s_waitcnt vmcnt(5) lgkmcnt(15)
  buffer_load_dwordx4 v[100:103], v27, s[56:59], s14 offen offset:1024 sc1
  v_mfma_f32_16x16x32_bf16 v[224:227], v[104:107], v[80:83], v[224:227]
  v_mfma_f32_16x16x32_bf16 v[228:231], v[108:111], v[80:83], v[228:231]
  v_mfma_f32_16x16x32_bf16 v[232:235], v[112:115], v[80:83], v[232:235]
  v_mfma_f32_16x16x32_bf16 v[236:239], v[116:119], v[80:83], v[236:239]
  v_mfma_f32_16x16x32_bf16 v[240:243], v[120:123], v[80:83], v[240:243]
  s_waitcnt vmcnt(4) lgkmcnt(15)
  v_mfma_f32_16x16x32_bf16 v[224:227], v[124:127], v[84:87], v[224:227]
  v_mfma_f32_16x16x32_bf16 v[228:231], v[128:131], v[84:87], v[228:231]
  v_mfma_f32_16x16x32_bf16 v[232:235], v[132:135], v[84:87], v[232:235]
  v_mfma_f32_16x16x32_bf16 v[236:239], v[136:139], v[84:87], v[236:239]
  v_mfma_f32_16x16x32_bf16 v[240:243], v[140:143], v[84:87], v[240:243]
  s_waitcnt vmcnt(3) lgkmcnt(15)
  v_mfma_f32_16x16x32_bf16 v[224:227], v[144:147], v[88:91], v[224:227]
  v_mfma_f32_16x16x32_bf16 v[228:231], v[148:151], v[88:91], v[228:231]
  v_mfma_f32_16x16x32_bf16 v[232:235], v[152:155], v[88:91], v[232:235]
  v_mfma_f32_16x16x32_bf16 v[236:239], v[156:159], v[88:91], v[236:239]
  v_mfma_f32_16x16x32_bf16 v[240:243], v[160:163], v[88:91], v[240:243]
  s_waitcnt vmcnt(2) lgkmcnt(15)
  v_mfma_f32_16x16x32_bf16 v[224:227], v[164:167], v[92:95], v[224:227]
  v_mfma_f32_16x16x32_bf16 v[228:231], v[168:171], v[92:95], v[228:231]
  v_mfma_f32_16x16x32_bf16 v[232:235], v[172:175], v[92:95], v[232:235]
  v_mfma_f32_16x16x32_bf16 v[236:239], v[176:179], v[92:95], v[236:239]
  v_mfma_f32_16x16x32_bf16 v[240:243], v[180:183], v[92:95], v[240:243]
  s_waitcnt vmcnt(1) lgkmcnt(9)
  v_mfma_f32_16x16x32_bf16 v[224:227], v[184:187], v[96:99], v[224:227]
  v_mfma_f32_16x16x32_bf16 v[228:231], v[188:191], v[96:99], v[228:231]
  v_mfma_f32_16x16x32_bf16 v[232:235], v[192:195], v[96:99], v[232:235]
  v_mfma_f32_16x16x32_bf16 v[236:239], v[196:199], v[96:99], v[236:239]
  v_mfma_f32_16x16x32_bf16 v[240:243], v[200:203], v[96:99], v[240:243]
  s_waitcnt vmcnt(0) lgkmcnt(0)
  v_mfma_f32_16x16x32_bf16 v[224:227], v[204:207], v[100:103], v[224:227]
  v_mfma_f32_16x16x32_bf16 v[228:231], v[208:211], v[100:103], v[228:231]
  v_mfma_f32_16x16x32_bf16 v[232:235], v[212:215], v[100:103], v[232:235]
  v_mfma_f32_16x16x32_bf16 v[236:239], v[216:219], v[100:103], v[236:239]
  v_mfma_f32_16x16x32_bf16 v[240:243], v[220:223], v[100:103], v[240:243]
  v_lshlrev_b32 v32, 16, v244
  v_and_b32 v33, 0xffff0000, v244
  v_lshlrev_b32 v34, 16, v245
  v_and_b32 v35, 0xffff0000, v245
  v_lshlrev_b32 v36, 16, v246
  v_and_b32 v37, 0xffff0000, v246
  v_lshlrev_b32 v38, 16, v247
  v_and_b32 v39, 0xffff0000, v247
  v_lshlrev_b32 v40, 16, v248
  v_and_b32 v41, 0xffff0000, v248
  v_lshlrev_b32 v42, 16, v249
  v_and_b32 v43, 0xffff0000, v249
  v_lshlrev_b32 v44, 16, v250
  v_and_b32 v45, 0xffff0000, v250
  v_lshlrev_b32 v46, 16, v251
  v_and_b32 v47, 0xffff0000, v251
  v_add_f32 v9, v224, v225
  v_sub_f32 v28, v19, v9
  v_sub_f32 v29, v19, v9
  v_mov_b32 v19, v18
  v_mov_b32 v10, 0
  v_mov_b32 v11, 0
  v_pk_fma_f32 v[32:33], v[32:33], v[18:19], v[28:29]
  v_pk_fma_f32 v[34:35], v[34:35], v[18:19], v[28:29]
  v_pk_fma_f32 v[36:37], v[36:37], v[18:19], v[28:29]
  v_pk_fma_f32 v[38:39], v[38:39], v[18:19], v[28:29]
  v_pk_add_f32 v[32:33], v[32:33], v[228:229]
  v_pk_add_f32 v[34:35], v[34:35], v[230:231]
  v_pk_add_f32 v[36:37], v[36:37], v[232:233]
  v_pk_add_f32 v[38:39], v[38:39], v[234:235]
  v_cvt_pk_bf16_f32 v104, v32, v33
  v_cvt_pk_bf16_f32 v105, v34, v35
  v_cvt_pk_bf16_f32 v106, v36, v37
  v_cvt_pk_bf16_f32 v107, v38, v39
  buffer_store_dwordx4 v[104:107], v2, s[56:59], s11 offen offset:0 sc1
  v_pk_fma_f32 v[40:41], v[40:41], v[18:19], v[28:29]
  v_pk_fma_f32 v[42:43], v[42:43], v[18:19], v[28:29]
  v_pk_fma_f32 v[44:45], v[44:45], v[18:19], v[28:29]
  v_pk_fma_f32 v[46:47], v[46:47], v[18:19], v[28:29]
  v_pk_add_f32 v[40:41], v[40:41], v[236:237]
  v_pk_add_f32 v[42:43], v[42:43], v[238:239]
  v_pk_add_f32 v[44:45], v[44:45], v[240:241]
  v_pk_add_f32 v[46:47], v[46:47], v[242:243]
  v_cvt_pk_bf16_f32 v108, v40, v41
  v_cvt_pk_bf16_f32 v109, v42, v43
  v_cvt_pk_bf16_f32 v110, v44, v45
  v_cvt_pk_bf16_f32 v111, v46, v47
  buffer_store_dwordx4 v[108:111], v2, s[56:59], s11 offen offset:1024 sc1
  v_pk_fma_f32 v[10:11], v[32:33], v[32:33], v[10:11]
  v_pk_fma_f32 v[10:11], v[34:35], v[34:35], v[10:11]
  v_pk_fma_f32 v[10:11], v[36:37], v[36:37], v[10:11]
  v_pk_fma_f32 v[10:11], v[38:39], v[38:39], v[10:11]
  v_pk_fma_f32 v[10:11], v[40:41], v[40:41], v[10:11]
  v_pk_fma_f32 v[10:11], v[42:43], v[42:43], v[10:11]
  v_pk_fma_f32 v[10:11], v[44:45], v[44:45], v[10:11]
  v_pk_fma_f32 v[10:11], v[46:47], v[46:47], v[10:11]
  v_add_f32 v10, v10, v11
  v_mov_b32 v11, v10
  s_nop 1
  v_permlane32_swap_b32 v10, v11
  v_add_f32 v10, v10, v11
  v_mov_b32 v11, v10
  s_nop 1
  v_permlane16_swap_b32 v10, v11
  v_add_f32 v10, v10, v11
  s_mul_i32 s10, s60, 9
  s_add_u32 s10, s10, s61
  s_lshl_b32 s10, s10, 9
  s_lshl_b32 s12, s3, 6
  s_add_u32 s10, s10, s12
  s_add_u32 s10, s10, 9764864
  s_lshl_b32 s12, s8, 6
  s_add_u32 s12, s12, 9863168
  s_mov_b64 exec, 0xffff
  buffer_store_dword v10, v4, s[56:59], s10 offen sc1
  s_cmp_lg_u32 s61, 0
  s_cbranch_scc1 G2_m
  buffer_store_dword v9, v4, s[56:59], s12 offen sc1
G2_m:
  s_mov_b64 exec, -1
  s_sub_u32 s6, s6, 69632
  s_and_b32 s4, s96, 1
  s_lshl_b32 s4, s4, 2
  s_and_b32 s7, s97, 3
  s_add_u32 s4, s4, s7
  s_lshr_b32 s5, s96, 1
  s_lshl_b32 s5, s5, 3
  s_lshr_b32 s7, s97, 2
  s_add_u32 s5, s5, s7
  s_mul_i32 s8, s4, 663552
  s_mul_i32 s71, s3, 3
  s_lshl_b32 s64, s71, 10
  s_add_u32 s64, s64, s8
  s_add_u32 s64, s64, 10485760
  s_add_u32 s65, s64, 24576
  s_and_b32 s9, s3, 3
  s_mul_i32 s9, s9, 9
  s_lshr_b32 s10, s3, 2
  s_lshl_b32 s10, s10, 1
  s_add_u32 s9, s9, s10
  s_lshl_b32 s66, s9, 10
  s_add_u32 s66, s66, s8
  s_add_u32 s66, s66, 15794176
  s_add_u32 s68, s66, 1024
  s_lshl_b32 s10, s4, 5
  s_add_u32 s10, s10, s5
  s_mul_i32 s67, s10, 73728
  s_lshl_b32 s9, s9, 11
  s_add_u32 s67, s67, s9
  s_add_u32 s67, s67, 21102592
  s_and_b32 s69, s3, 3
  s_lshl_b32 s69, s69, 3
  s_add_u32 s69, s69, s4
  s_lshl_b32 s69, s69, 2
  s_mul_i32 s10, s5, 4352
  s_add_u32 s69, s69, s10
  s_add_u32 s69, s69, 9896064
  s_mul_i32 s70, s4, 4352
  s_add_u32 s70, s70, 10035200
  s_waitcnt vmcnt(0)
  s_mov_b64 exec, 1
  ds_add_rtn_u32 v5, v16, v17 offset:0
  s_mov_b64 exec, -1
  s_waitcnt lgkmcnt(0)
  v_readfirstlane_b32 s7, v5
  s_cmp_lg_u32 s7, 7
  s_cbranch_scc1 G_xs
  s_atomic_add s101, s[42:43], s6
G_xs:
  s_cmp_lt_u32 s3, 4
  s_cbranch_scc1 K6_p
  s_cmp_ge_u32 s2, 128
  s_cbranch_scc1 K6_q
  s_setprio 3
  s_cmp_lg_u32 s100, 0
  s_cbranch_scc1 G_kw
  s_mov_b32 s13, 0x40000
CP_11:
  s_load_dword s44, s[42:43], s99 glc
  s_waitcnt lgkmcnt(0)
  s_cmp_ge_u32 s44, 1
  s_cbranch_scc1 CD_12
  s_sleep 8
  s_sub_u32 s13, s13, 1
  s_cbranch_scc0 CP_11
CD_12:
  s_add_u32 s9, s2, 448
  s_mul_i32 s9, s9, 4224
  s_add_u32 s9, s9, 4718592
  s_sub_u32 s15, s3, 4
  s_lshl_b32 s15, s15, 10
  v_add_u32 v5, s15, v2
  s_add_u32 m0, s15, 101376
  s_add_u32 s7, s9, 4
  buffer_load_dwordx4 v5, s[56:59], s9 offen sc1 lds
  s_add_u32 m0, s15, 109696
  s_nop 0
  buffer_load_dwordx4 v5, s[56:59], s7 offen sc1 lds
  s_mov_b64 exec, 7
  s_mov_b32 m0, 105472
  s_nop 0
  buffer_load_dwordx4 v3, s[56:59], s9 offen sc1 lds
  s_mov_b32 m0, 113792
  s_nop 0
  buffer_load_dwordx4 v3, s[56:59], s7 offen sc1 lds
  s_mov_b64 exec, -1
G_kw:
  s_add_u32 s6, s2, 448
  s_add_u32 s52, s70, 256
  s_load_dword s53, s[42:43], s52
  s_mov_b32 s7, 101376
  s_sub_u32 s55, s3, 4
  s_lshl_b32 s12, s55, 10
  s_lshl_b32 s10, s6, 12
  s_lshl_b32 s8, s6, 1
  s_and_b32 s8, s8, 0xfffffffc
  s_load_dword s15, s[26:27], s8
  v_lshlrev_b32 v5, 3, v1
  v_add_u32 v5, s7, v5
  v_mov_b32 v18, 0
  v_mov_b32 v19, 0
  ds_write_b64 v5, v[18:19] offset:16640
  v_and_b32 v6, 15, v1
  v_lshrrev_b32 v7, 4, v1
  v_sub_u32 v8, 3, v6
  v_and_b32 v8, 3, v8
  v_mul_u32_u24 v8, 4160, v8
  v_and_b32 v9, 12, v6
  v_lshlrev_b32 v9, 1, v9
  v_sub_u32 v8, v8, v9
  v_lshlrev_b32 v9, 4, v7
  v_sub_u32 v8, v8, v9
  v_add_u32 v8, 520, v8
  v_add_u32 v8, s7, v8
  v_lshlrev_b32 v10, 5, v6
  v_sub_u32 v10, v10, v9
  v_add_u32 v10, 17168, v10
  v_add_u32 v10, s7, v10
  v_add_u32 v11, s7, v2
  v_min_u32 v12, 16, v2
  v_add_u32 v12, s7, v12
  v_add_u32 v12, 4096, v12
  v_lshlrev_b32 v20, 5, v6
  v_lshl_add_u32 v20, v7, 3, v20
  v_sub_u32 v21, 504, v20
  v_add_u32 v21, s7, v21
  v_mov_b32 v224, 0
  v_mov_b32 v225, 0
  v_mov_b32 v226, 0
  v_mov_b32 v227, 0
  v_mov_b32 v228, 0
  v_mov_b32 v229, 0
  v_mov_b32 v230, 0
  v_mov_b32 v231, 0
  v_mov_b32 v232, 0
  v_mov_b32 v233, 0
  v_mov_b32 v234, 0
  v_mov_b32 v235, 0
  v_mov_b32 v236, 0
  v_mov_b32 v237, 0
  v_mov_b32 v238, 0
  v_mov_b32 v239, 0
  v_mov_b32 v240, 0
  v_mov_b32 v241, 0
  v_mov_b32 v242, 0
  v_mov_b32 v243, 0
  v_mov_b32 v244, 0
  v_mov_b32 v245, 0
  v_mov_b32 v246, 0
  v_mov_b32 v247, 0
  v_mov_b32 v248, 0
  v_mov_b32 v249, 0
  v_mov_b32 v250, 0
  v_mov_b32 v251, 0
  v_mov_b32 v252, 0
  v_mov_b32 v253, 0
  v_mov_b32 v254, 0
  v_mov_b32 v255, 0
  v_add_u32 v11, s12, v11
  s_lshl_b32 s8, s55, 7
  v_subrev_u32 v8, s8, v8
  v_subrev_u32 v10, s8, v10
  v_subrev_u32 v21, s12, v21
  v_add_u32 v20, s12, v20
  s_lshl_b32 s8, s55, 13
  s_add_u32 s8, s8, 122880
  v_add_u32 v26, s8, v2
  s_lshl_b32 s8, s55, 11
  s_add_u32 s8, s8, 122880
  v_add_u32 v27, s8, v2
  s_waitcnt vmcnt(0)
  s_mov_b64 exec, 1
  v_mov_b32 v5, 1
  ds_add_u32 v16, v5 offset:68
  s_mov_b64 exec, -1
LW_13:
  ds_read_b32 v5, v16 offset:68
  s_waitcnt lgkmcnt(0)
  v_readfirstlane_b32 s8, v5
  s_cmp_ge_u32 s8, 4
  s_cbranch_scc1 LD_14
  s_sleep 1
  s_branch LW_13
LD_14:
  ds_read_b128 v[96:99], v11 offset:0
  ds_read_b128 v[100:103], v11 offset:8320
  ds_read_b64 v[104:105], v11 offset:16
  ds_read_b128 v[108:111], v12 offset:0
  ds_read_b128 v[112:115], v12 offset:8320
  ds_read_b64 v[116:117], v12 offset:16
  s_waitcnt lgkmcnt(3)
  v_alignbit_b32 v160, v100, v96, 16
  v_alignbit_b32 v161, v101, v97, 16
  v_alignbit_b32 v162, v102, v98, 16
  v_alignbit_b32 v163, v103, v99, 16
  v_alignbit_b32 v164, v98, v100, 16
  v_alignbit_b32 v165, v99, v101, 16
  v_alignbit_b32 v166, v104, v102, 16
  v_alignbit_b32 v167, v105, v103, 16
  ds_write_b128 v11, v[160:163] offset:4160
  ds_write_b128 v11, v[164:167] offset:12480
  s_waitcnt lgkmcnt(2)
  v_alignbit_b32 v168, v112, v108, 16
  v_alignbit_b32 v169, v113, v109, 16
  v_alignbit_b32 v170, v114, v110, 16
  v_alignbit_b32 v171, v115, v111, 16
  v_alignbit_b32 v172, v110, v112, 16
  v_alignbit_b32 v173, v111, v113, 16
  v_alignbit_b32 v174, v116, v114, 16
  v_alignbit_b32 v175, v117, v115, 16
  ds_write_b128 v12, v[168:171] offset:4160
  ds_write_b128 v12, v[172:175] offset:12480
  s_mov_b64 exec, 1
  v_mov_b32 v5, 1
  ds_add_u32 v16, v5 offset:72
  s_mov_b64 exec, -1
LW_15:
  ds_read_b32 v5, v16 offset:72
  s_waitcnt lgkmcnt(0)
  v_readfirstlane_b32 s8, v5
  s_cmp_ge_u32 s8, 4
  s_cbranch_scc1 LD_16
  s_sleep 1
  s_branch LW_15
LD_16:
  s_cmp_lg_u32 s53, 0
  s_cbranch_scc1 G_k2
  s_mov_b32 s13, 0x40000
CP_17:
  s_load_dword s53, s[42:43], s52 glc
  s_waitcnt lgkmcnt(0)
  s_cmp_ge_u32 s53, 1
  s_cbranch_scc1 CD_18
  s_sleep 8
  s_sub_u32 s13, s13, 1
  s_cbranch_scc0 CP_17
CD_18:
G_k2:
  ds_read_b128 v[160:163], v10 offset:0
  ds_read_b64 v[96:97], v8 offset:3584
  ds_read_b64 v[98:99], v8 offset:3592
  ds_read_b128 v[164:167], v10 offset:512
  ds_read_b64 v[100:101], v8 offset:3072
  ds_read_b64 v[102:103], v8 offset:3080
  ds_read_b128 v[168:171], v10 offset:1024
  ds_read_b64 v[104:105], v8 offset:2560
  ds_read_b64 v[106:107], v8 offset:2568
  ds_read_b128 v[172:175], v10 offset:1536
  ds_read_b64 v[108:109], v8 offset:2048
  ds_read_b64 v[110:111], v8 offset:2056
  ds_read_b128 v[176:179], v10 offset:2048
  ds_read_b64 v[112:113], v8 offset:1536
  ds_read_b64 v[114:115], v8 offset:1544
  ds_read_b128 v[180:183], v10 offset:2560
  ds_read_b64 v[116:117], v8 offset:1024
  ds_read_b64 v[118:119], v8 offset:1032
  ds_read_b128 v[184:187], v10 offset:3072
  ds_read_b64 v[120:121], v8 offset:512
  ds_read_b64 v[122:123], v8 offset:520
  ds_read_b128 v[188:191], v10 offset:3584
  ds_read_b64 v[124:125], v8 offset:0
  ds_read_b64 v[126:127], v8 offset:8
  v_subrev_u32 v8, 64, v8
  v_subrev_u32 v10, 64, v10
  s_waitcnt lgkmcnt(0)
  v_mfma_f32_16x16x32_bf16 v[224:227], v[96:99], v[160:163], v[224:227]
  ds_read_b128 v[192:195], v10 offset:0
  v_mfma_f32_16x16x32_bf16 v[228:231], v[96:99], v[164:167], v[228:231]
  ds_read_b64 v[128:129], v8 offset:3584
  v_mfma_f32_16x16x32_bf16 v[228:231], v[100:103], v[160:163], v[228:231]
  ds_read_b64 v[130:131], v8 offset:3592
  v_mfma_f32_16x16x32_bf16 v[232:235], v[100:103], v[164:167], v[232:235]
  ds_read_b128 v[196:199], v10 offset:512
  v_mfma_f32_16x16x32_bf16 v[232:235], v[96:99], v[168:171], v[232:235]
  ds_read_b64 v[132:133], v8 offset:3072
  v_mfma_f32_16x16x32_bf16 v[236:239], v[100:103], v[168:171], v[236:239]
  ds_read_b64 v[134:135], v8 offset:3080
  v_mfma_f32_16x16x32_bf16 v[232:235], v[104:107], v[160:163], v[232:235]
  ds_read_b128 v[200:203], v10 offset:1024
  v_mfma_f32_16x16x32_bf16 v[236:239], v[104:107], v[164:167], v[236:239]
  ds_read_b64 v[136:137], v8 offset:2560
  v_mfma_f32_16x16x32_bf16 v[240:243], v[104:107], v[168:171], v[240:243]
  ds_read_b64 v[138:139], v8 offset:2568
  v_mfma_f32_16x16x32_bf16 v[236:239], v[96:99], v[172:175], v[236:239]
  ds_read_b128 v[204:207], v10 offset:1536
  v_mfma_f32_16x16x32_bf16 v[240:243], v[100:103], v[172:175], v[240:243]
  ds_read_b64 v[140:141], v8 offset:2048
  v_mfma_f32_16x16x32_bf16 v[244:247], v[104:107], v[172:175], v[244:247]
  ds_read_b64 v[142:143], v8 offset:2056
  v_mfma_f32_16x16x32_bf16 v[236:239], v[108:111], v[160:163], v[236:239]
  ds_read_b128 v[208:211], v10 offset:2048
  v_mfma_f32_16x16x32_bf16 v[240:243], v[108:111], v[164:167], v[240:243]
  ds_read_b64 v[144:145], v8 offset:1536
  v_mfma_f32_16x16x32_bf16 v[244:247], v[108:111], v[168:171], v[244:247]
  ds_read_b64 v[146:147], v8 offset:1544
  v_mfma_f32_16x16x32_bf16 v[248:251], v[108:111], v[172:175], v[248:251]
  ds_read_b128 v[212:215], v10 offset:2560
  v_mfma_f32_16x16x32_bf16 v[240:243], v[96:99], v[176:179], v[240:243]
  ds_read_b64 v[148:149], v8 offset:1024
  v_mfma_f32_16x16x32_bf16 v[244:247], v[100:103], v[176:179], v[244:247]
  ds_read_b64 v[150:151], v8 offset:1032
  v_mfma_f32_16x16x32_bf16 v[248:251], v[104:107], v[176:179], v[248:251]
  ds_read_b128 v[216:219], v10 offset:3072
  v_mfma_f32_16x16x32_bf16 v[252:255], v[108:111], v[176:179], v[252:255]
  ds_read_b64 v[152:153], v8 offset:512
  v_mfma_f32_16x16x32_bf16 v[240:243], v[112:115], v[160:163], v[240:243]
  ds_read_b64 v[154:155], v8 offset:520
  v_mfma_f32_16x16x32_bf16 v[244:247], v[112:115], v[164:167], v[244:247]
  ds_read_b128 v[220:223], v10 offset:3584
  v_mfma_f32_16x16x32_bf16 v[248:251], v[112:115], v[168:171], v[248:251]
  ds_read_b64 v[156:157], v8 offset:0
  v_mfma_f32_16x16x32_bf16 v[252:255], v[112:115], v[172:175], v[252:255]
  ds_read_b64 v[158:159], v8 offset:8
  v_mfma_f32_16x16x32_bf16 v[244:247], v[96:99], v[180:183], v[244:247]
  buffer_load_dwordx4 v[32:35], v2, s[56:59], s64 offen offset:0 sc1
  v_mfma_f32_16x16x32_bf16 v[248:251], v[100:103], v[180:183], v[248:251]
  buffer_load_dwordx4 v[36:39], v2, s[56:59], s64 offen offset:1024 sc1
  v_mfma_f32_16x16x32_bf16 v[252:255], v[104:107], v[180:183], v[252:255]
  buffer_load_dwordx4 v[40:43], v2, s[56:59], s64 offen offset:2048 sc1
  v_mfma_f32_16x16x32_bf16 v[244:247], v[116:119], v[160:163], v[244:247]
  s_add_u32 s64, s64, 36864
  buffer_load_dwordx4 v[44:47], v2, s[56:59], s64 offen offset:0 sc1
  v_mfma_f32_16x16x32_bf16 v[248:251], v[116:119], v[164:167], v[248:251]
  buffer_load_dwordx4 v[48:51], v2, s[56:59], s64 offen offset:1024 sc1
  v_mfma_f32_16x16x32_bf16 v[252:255], v[116:119], v[168:171], v[252:255]
  buffer_load_dwordx4 v[52:55], v2, s[56:59], s64 offen offset:2048 sc1
  v_mfma_f32_16x16x32_bf16 v[248:251], v[96:99], v[184:187], v[248:251]
  s_add_u32 s64, s64, 36864
  buffer_load_dwordx4 v[56:59], v2, s[56:59], s64 offen offset:0 sc1
  v_mfma_f32_16x16x32_bf16 v[252:255], v[100:103], v[184:187], v[252:255]
  buffer_load_dwordx4 v[60:63], v2, s[56:59], s64 offen offset:1024 sc1
  v_mfma_f32_16x16x32_bf16 v[248:251], v[120:123], v[160:163], v[248:251]
  v_mfma_f32_16x16x32_bf16 v[252:255], v[120:123], v[164:167], v[252:255]
  v_mfma_f32_16x16x32_bf16 v[252:255], v[96:99], v[188:191], v[252:255]
  v_mfma_f32_16x16x32_bf16 v[252:255], v[124:127], v[160:163], v[252:255]
  v_subrev_u32 v8, 64, v8
  v_subrev_u32 v10, 64, v10
  s_waitcnt lgkmcnt(0)
  v_mfma_f32_16x16x32_bf16 v[224:227], v[128:131], v[192:195], v[224:227]
  v_mfma_f32_16x16x32_bf16 v[228:231], v[128:131], v[196:199], v[228:231]
  v_mfma_f32_16x16x32_bf16 v[228:231], v[132:135], v[192:195], v[228:231]
  v_mfma_f32_16x16x32_bf16 v[232:235], v[132:135], v[196:199], v[232:235]
  v_mfma_f32_16x16x32_bf16 v[232:235], v[128:131], v[200:203], v[232:235]
  v_mfma_f32_16x16x32_bf16 v[236:239], v[132:135], v[200:203], v[236:239]
  v_mfma_f32_16x16x32_bf16 v[232:235], v[136:139], v[192:195], v[232:235]
  v_mfma_f32_16x16x32_bf16 v[236:239], v[136:139], v[196:199], v[236:239]
  v_mfma_f32_16x16x32_bf16 v[240:243], v[136:139], v[200:203], v[240:243]
  v_mfma_f32_16x16x32_bf16 v[236:239], v[128:131], v[204:207], v[236:239]
  v_mfma_f32_16x16x32_bf16 v[240:243], v[132:135], v[204:207], v[240:243]
  v_mfma_f32_16x16x32_bf16 v[244:247], v[136:139], v[204:207], v[244:247]
  v_mfma_f32_16x16x32_bf16 v[236:239], v[140:143], v[192:195], v[236:239]
  v_mfma_f32_16x16x32_bf16 v[240:243], v[140:143], v[196:199], v[240:243]
  v_mfma_f32_16x16x32_bf16 v[244:247], v[140:143], v[200:203], v[244:247]
  v_mfma_f32_16x16x32_bf16 v[248:251], v[140:143], v[204:207], v[248:251]
  v_mfma_f32_16x16x32_bf16 v[240:243], v[128:131], v[208:211], v[240:243]
  v_mfma_f32_16x16x32_bf16 v[244:247], v[132:135], v[208:211], v[244:247]
  v_mfma_f32_16x16x32_bf16 v[248:251], v[136:139], v[208:211], v[248:251]
  v_mfma_f32_16x16x32_bf16 v[252:255], v[140:143], v[208:211], v[252:255]
  v_mfma_f32_16x16x32_bf16 v[240:243], v[144:147], v[192:195], v[240:243]
  v_mfma_f32_16x16x32_bf16 v[244:247], v[144:147], v[196:199], v[244:247]
  v_mfma_f32_16x16x32_bf16 v[248:251], v[144:147], v[200:203], v[248:251]
  v_mfma_f32_16x16x32_bf16 v[252:255], v[144:147], v[204:207], v[252:255]
  v_mfma_f32_16x16x32_bf16 v[244:247], v[128:131], v[212:215], v[244:247]
  buffer_load_dwordx4 v[64:67], v2, s[56:59], s64 offen offset:2048 sc1
  v_mfma_f32_16x16x32_bf16 v[248:251], v[132:135], v[212:215], v[248:251]
  s_add_u32 s64, s64, 36864
  buffer_load_dwordx4 v[68:71], v2, s[56:59], s64 offen offset:0 sc1
  v_mfma_f32_16x16x32_bf16 v[252:255], v[136:139], v[212:215], v[252:255]
  buffer_load_dwordx4 v[72:75], v2, s[56:59], s64 offen offset:1024 sc1
  v_mfma_f32_16x16x32_bf16 v[244:247], v[148:151], v[192:195], v[244:247]
  buffer_load_dwordx4 v[76:79], v2, s[56:59], s64 offen offset:2048 sc1
  v_mfma_f32_16x16x32_bf16 v[248:251], v[148:151], v[196:199], v[248:251]
  s_add_u32 s64, s64, 36864
  buffer_load_dwordx4 v[80:83], v2, s[56:59], s64 offen offset:0 sc1
  v_mfma_f32_16x16x32_bf16 v[252:255], v[148:151], v[200:203], v[252:255]
  buffer_load_dwordx4 v[84:87], v2, s[56:59], s64 offen offset:1024 sc1
  v_mfma_f32_16x16x32_bf16 v[248:251], v[128:131], v[216:219], v[248:251]
  buffer_load_dwordx4 v[88:91], v2, s[56:59], s64 offen offset:2048 sc1
  v_mfma_f32_16x16x32_bf16 v[252:255], v[132:135], v[216:219], v[252:255]
  s_add_u32 s64, s64, 36864
  buffer_load_dwordx4 v[92:95], v2, s[56:59], s64 offen offset:0 sc1
  v_mfma_f32_16x16x32_bf16 v[248:251], v[152:155], v[192:195], v[248:251]
  v_mfma_f32_16x16x32_bf16 v[252:255], v[152:155], v[196:199], v[252:255]
  v_mfma_f32_16x16x32_bf16 v[252:255], v[128:131], v[220:223], v[252:255]
  v_mfma_f32_16x16x32_bf16 v[252:255], v[156:159], v[192:195], v[252:255]
  ds_read_b64 v[96:97], v21 offset:3584
  ds_read_b64 v[98:99], v21 offset:3072
  s_lshl_b32 s13, s15, 16
  s_and_b32 s14, s15, 0xffff0000
  s_bitcmp1_b32 s6, 0
  s_cselect_b32 s13, s14, s13
  s_mul_i32 s10, s6, 4224
  s_add_u32 s10, s10, 4718592
  s_nop 3
  ds_write_b128 v26, v[224:227] offset:0
  ds_write_b128 v26, v[228:231] offset:1024
  ds_write_b128 v26, v[232:235] offset:2048
  ds_write_b128 v26, v[236:239] offset:3072
  ds_write_b128 v26, v[240:243] offset:4096
  ds_write_b128 v26, v[244:247] offset:5120
  ds_write_b128 v26, v[248:251] offset:6144
  ds_write_b128 v26, v[252:255] offset:7168
  s_mov_b64 exec, 1
  v_mov_b32 v5, 1
  ds_add_u32 v16, v5 offset:76
  s_mov_b64 exec, -1
LW_19:
  ds_read_b32 v5, v16 offset:76
  s_waitcnt lgkmcnt(0)
  v_readfirstlane_b32 s8, v5
  s_cmp_ge_u32 s8, 4
  s_cbranch_scc1 LD_20
  s_sleep 1
  s_branch LW_19
LD_20:
  ds_read_b128 v[160:163], v27 offset:0
  ds_read_b128 v[164:167], v27 offset:8192
  ds_read_b128 v[168:171], v27 offset:16384
  ds_read_b128 v[172:175], v27 offset:24576
  ds_read_b128 v[176:179], v27 offset:1024
  ds_read_b128 v[180:183], v27 offset:9216
  ds_read_b128 v[184:187], v27 offset:17408
  ds_read_b128 v[188:191], v27 offset:25600
  s_waitcnt lgkmcnt(0)
  v_add_f32 v160, v160, v164
  v_add_f32 v168, v168, v172
  v_add_f32 v161, v161, v165
  v_add_f32 v169, v169, v173
  v_add_f32 v162, v162, v166
  v_add_f32 v170, v170, v174
  v_add_f32 v163, v163, v167
  v_add_f32 v171, v171, v175
  v_add_f32 v160, v160, v168
  v_add_f32 v161, v161, v169
  v_add_f32 v162, v162, v170
  v_add_f32 v163, v163, v171
  v_and_b32 v22, 0xffff0000, v97
  v_lshlrev_b32 v23, 16, v97
  v_and_b32 v24, 0xffff0000, v96
  v_lshlrev_b32 v25, 16, v96
  v_fmac_f32 v160, s13, v22
  v_fmac_f32 v161, s13, v23
  v_fmac_f32 v162, s13, v24
  v_fmac_f32 v163, s13, v25
  v_cvt_pk_bf16_f32 v192, v160, v161
  v_cvt_pk_bf16_f32 v193, v162, v163
  buffer_store_dwordx2 v[192:193], v20, s[56:59], s10 offen offset:0 sc1
  v_add_f32 v176, v176, v180
  v_add_f32 v184, v184, v188
  v_add_f32 v177, v177, v181
  v_add_f32 v185, v185, v189
  v_add_f32 v178, v178, v182
  v_add_f32 v186, v186, v190
  v_add_f32 v179, v179, v183
  v_add_f32 v187, v187, v191
  v_add_f32 v176, v176, v184
  v_add_f32 v177, v177, v185
  v_add_f32 v178, v178, v186
  v_add_f32 v179, v179, v187
  v_and_b32 v22, 0xffff0000, v99
  v_lshlrev_b32 v23, 16, v99
  v_and_b32 v24, 0xffff0000, v98
  v_lshlrev_b32 v25, 16, v98
  v_fmac_f32 v176, s13, v22
  v_fmac_f32 v177, s13, v23
  v_fmac_f32 v178, s13, v24
  v_fmac_f32 v179, s13, v25
  v_cvt_pk_bf16_f32 v194, v176, v177
  v_cvt_pk_bf16_f32 v195, v178, v179
  buffer_store_dwordx2 v[194:195], v20, s[56:59], s10 offen offset:512 sc1
  s_lshl_b32 s6, s6, 5
  s_add_u32 s6, s6, 9739264
  s_mov_b64 exec, 1
  ds_add_u32 v16, v17 offset:16
  s_mov_b64 exec, -1
  s_waitcnt vmcnt(0)
  s_mov_b64 exec, 1
  ds_add_rtn_u32 v5, v16, v17 offset:44
  s_mov_b64 exec, -1
  s_waitcnt lgkmcnt(0)
  v_readfirstlane_b32 s7, v5
  s_cmp_lg_u32 s7, 3
  s_cbranch_scc1 K6_q2
  s_mov_b64 exec, 1
  v_mov_b32 v14, 0
  v_mov_b32 v15, 1
  buffer_store_dword v15, v14, s[56:59], s6 offen sc1
  s_mov_b64 exec, -1
  s_branch K6_q2
K6_f:
  s_cmp_lg_u32 s3, 0
  s_cbranch_scc1 F_pf
  s_mov_b64 exec, 0xffff
  v_lshl_add_u32 v7, v1, 2, v16
  v_mov_b32 v8, 0
  ds_write2_b32 v7, v8, v8 offset0:0 offset1:16
  s_mov_b64 exec, -1
F_pf:
  s_mul_i32 s61, s3, 21248
  s_lshl_b32 s7, s3, 12
  s_add_u32 s7, s7, 68608
  s_cmp_ge_u32 s3, 4
  s_cselect_b32 s61, s7, s61
  s_mov_b32 s65, s60
  s_mul_i32 s12, s3, 112
  s_add_u32 s12, s12, s65
  s_mov_b32 s13, s61
  s_waitcnt lgkmcnt(0)
  s_mov_b32 s56, s42
  s_mov_b32 s57, s43
  s_mov_b32 s58, 40894464
  s_mov_b32 s59, 0x20000
  s_cmp_eq_u32 s99, 1
  s_cbranch_scc1 F_pt
  s_barrier
  s_cmp_ge_u32 s12, 306
  s_cbranch_scc1 F_pt
  s_setprio 2
  s_cmp_lt_u32 s12, 288
  s_cbranch_scc1 F_kv
  s_sub_u32 s6, s12, 288
  v_lshrrev_b32 v2, 2, v1
  v_and_b32 v3, 3, v1
  v_mul_u32_u24 v4, 1152, v2
  v_lshl_add_u32 v4, v3, 4, v4
  s_mul_i32 s7, s6, 36864
  s_add_u32 s8, s7, 18432
  s_mov_b32 s44, s32
  s_mov_b32 s45, s33
  s_mov_b32 s46, 663552
  s_mov_b32 s47, 0x20000
  buffer_load_dwordx4 v[32:35], v4, s[44:47], s7 offen offset:0
  buffer_load_dwordx4 v[36:39], v4, s[44:47], s7 offen offset:64
  buffer_load_dwordx4 v[40:43], v4, s[44:47], s7 offen offset:128
  buffer_load_dwordx4 v[44:47], v4, s[44:47], s7 offen offset:192
  buffer_load_dwordx4 v[48:51], v4, s[44:47], s7 offen offset:256
  buffer_load_dwordx4 v[52:55], v4, s[44:47], s7 offen offset:320
  buffer_load_dwordx4 v[56:59], v4, s[44:47], s7 offen offset:384
  buffer_load_dwordx4 v[60:63], v4, s[44:47], s7 offen offset:448
  buffer_load_dwordx4 v[64:67], v4, s[44:47], s7 offen offset:512
  buffer_load_dwordx4 v[68:71], v4, s[44:47], s7 offen offset:576
  buffer_load_dwordx4 v[72:75], v4, s[44:47], s7 offen offset:640
  buffer_load_dwordx4 v[76:79], v4, s[44:47], s7 offen offset:704
  buffer_load_dwordx4 v[80:83], v4, s[44:47], s7 offen offset:768
  buffer_load_dwordx4 v[84:87], v4, s[44:47], s7 offen offset:832
  buffer_load_dwordx4 v[88:91], v4, s[44:47], s7 offen offset:896
  buffer_load_dwordx4 v[92:95], v4, s[44:47], s7 offen offset:960
  buffer_load_dwordx4 v[96:99], v4, s[44:47], s7 offen offset:1024
  buffer_load_dwordx4 v[100:103], v4, s[44:47], s7 offen offset:1088
  buffer_load_dwordx4 v[104:107], v4, s[44:47], s8 offen offset:0
  buffer_load_dwordx4 v[108:111], v4, s[44:47], s8 offen offset:64
  buffer_load_dwordx4 v[112:115], v4, s[44:47], s8 offen offset:128
  buffer_load_dwordx4 v[116:119], v4, s[44:47], s8 offen offset:192
  buffer_load_dwordx4 v[120:123], v4, s[44:47], s8 offen offset:256
  buffer_load_dwordx4 v[124:127], v4, s[44:47], s8 offen offset:320
  buffer_load_dwordx4 v[128:131], v4, s[44:47], s8 offen offset:384
  buffer_load_dwordx4 v[132:135], v4, s[44:47], s8 offen offset:448
  buffer_load_dwordx4 v[136:139], v4, s[44:47], s8 offen offset:512
  buffer_load_dwordx4 v[140:143], v4, s[44:47], s8 offen offset:576
  buffer_load_dwordx4 v[144:147], v4, s[44:47], s8 offen offset:640
  buffer_load_dwordx4 v[148:151], v4, s[44:47], s8 offen offset:704
  buffer_load_dwordx4 v[152:155], v4, s[44:47], s8 offen offset:768
  buffer_load_dwordx4 v[156:159], v4, s[44:47], s8 offen offset:832
  buffer_load_dwordx4 v[160:163], v4, s[44:47], s8 offen offset:896
  buffer_load_dwordx4 v[164:167], v4, s[44:47], s8 offen offset:960
  buffer_load_dwordx4 v[168:171], v4, s[44:47], s8 offen offset:1024
  buffer_load_dwordx4 v[172:175], v4, s[44:47], s8 offen offset:1088
  v_mov_b32 v8, 0x3f803f80
  v_mov_b32 v20, 0
  v_mov_b32 v21, 0
  v_mov_b32 v22, 0
  v_mov_b32 v23, 0
  v_lshrrev_b32 v5, 2, v2
  v_and_b32 v6, 3, v2
  v_lshlrev_b32 v5, 4, v5
  v_lshl_add_u32 v5, v6, 1, v5
  v_add_u32 v5, s13, v5
  v_lshlrev_b32 v6, 4, v1
  v_add_u32 v7, s13, v6
  s_waitcnt vmcnt(18)
  v_dot2c_f32_bf16 v20, v32, v8
  v_dot2c_f32_bf16 v21, v33, v8
  v_dot2c_f32_bf16 v20, v34, v8
  v_dot2c_f32_bf16 v21, v35, v8
  v_dot2c_f32_bf16 v20, v36, v8
  v_dot2c_f32_bf16 v21, v37, v8
  v_dot2c_f32_bf16 v20, v38, v8
  v_dot2c_f32_bf16 v21, v39, v8
  v_dot2c_f32_bf16 v20, v40, v8
  v_dot2c_f32_bf16 v21, v41, v8
  v_dot2c_f32_bf16 v20, v42, v8
  v_dot2c_f32_bf16 v21, v43, v8
  v_dot2c_f32_bf16 v20, v44, v8
  v_dot2c_f32_bf16 v21, v45, v8
  v_dot2c_f32_bf16 v20, v46, v8
  v_dot2c_f32_bf16 v21, v47, v8
  v_dot2c_f32_bf16 v20, v48, v8
  v_dot2c_f32_bf16 v21, v49, v8
  v_dot2c_f32_bf16 v20, v50, v8
  v_dot2c_f32_bf16 v21, v51, v8
  v_dot2c_f32_bf16 v20, v52, v8
  v_dot2c_f32_bf16 v21, v53, v8
  v_dot2c_f32_bf16 v20, v54, v8
  v_dot2c_f32_bf16 v21, v55, v8
  v_dot2c_f32_bf16 v20, v56, v8
  v_dot2c_f32_bf16 v21, v57, v8
  v_dot2c_f32_bf16 v20, v58, v8
  v_dot2c_f32_bf16 v21, v59, v8
  v_dot2c_f32_bf16 v20, v60, v8
  v_dot2c_f32_bf16 v21, v61, v8
  v_dot2c_f32_bf16 v20, v62, v8
  v_dot2c_f32_bf16 v21, v63, v8
  v_dot2c_f32_bf16 v20, v64, v8
  v_dot2c_f32_bf16 v21, v65, v8
  v_dot2c_f32_bf16 v20, v66, v8
  v_dot2c_f32_bf16 v21, v67, v8
  v_dot2c_f32_bf16 v20, v68, v8
  v_dot2c_f32_bf16 v21, v69, v8
  v_dot2c_f32_bf16 v20, v70, v8
  v_dot2c_f32_bf16 v21, v71, v8
  v_dot2c_f32_bf16 v20, v72, v8
  v_dot2c_f32_bf16 v21, v73, v8
  v_dot2c_f32_bf16 v20, v74, v8
  v_dot2c_f32_bf16 v21, v75, v8
  v_dot2c_f32_bf16 v20, v76, v8
  v_dot2c_f32_bf16 v21, v77, v8
  v_dot2c_f32_bf16 v20, v78, v8
  v_dot2c_f32_bf16 v21, v79, v8
  v_dot2c_f32_bf16 v20, v80, v8
  v_dot2c_f32_bf16 v21, v81, v8
  v_dot2c_f32_bf16 v20, v82, v8
  v_dot2c_f32_bf16 v21, v83, v8
  v_dot2c_f32_bf16 v20, v84, v8
  v_dot2c_f32_bf16 v21, v85, v8
  v_dot2c_f32_bf16 v20, v86, v8
  v_dot2c_f32_bf16 v21, v87, v8
  v_dot2c_f32_bf16 v20, v88, v8
  v_dot2c_f32_bf16 v21, v89, v8
  v_dot2c_f32_bf16 v20, v90, v8
  v_dot2c_f32_bf16 v21, v91, v8
  v_dot2c_f32_bf16 v20, v92, v8
  v_dot2c_f32_bf16 v21, v93, v8
  v_dot2c_f32_bf16 v20, v94, v8
  v_dot2c_f32_bf16 v21, v95, v8
  v_dot2c_f32_bf16 v20, v96, v8
  v_dot2c_f32_bf16 v21, v97, v8
  v_dot2c_f32_bf16 v20, v98, v8
  v_dot2c_f32_bf16 v21, v99, v8
  v_dot2c_f32_bf16 v20, v100, v8
  v_dot2c_f32_bf16 v21, v101, v8
  v_dot2c_f32_bf16 v20, v102, v8
  v_dot2c_f32_bf16 v21, v103, v8
  s_load_dword s9, s[40:41], 0
  s_waitcnt vmcnt(0) lgkmcnt(0)
  s_cmp_lg_u32 s9, 0
  s_cbranch_scc1 ZD_22
  s_mov_b32 s9, 0x20000
  v_mov_b32 v14, 0
ZP_21:
  global_load_dword v15, v14, s[40:41] sc1
  s_waitcnt vmcnt(0)
  v_cmp_eq_u32 vcc, 0, v15
  s_cbranch_vccz ZD_22
  s_sleep 4
  s_sub_u32 s9, s9, 1
  s_cbranch_scc0 ZP_21
ZD_22:
  v_dot2c_f32_bf16 v22, v104, v8
  v_dot2c_f32_bf16 v23, v105, v8
  v_dot2c_f32_bf16 v22, v106, v8
  v_dot2c_f32_bf16 v23, v107, v8
  v_dot2c_f32_bf16 v22, v108, v8
  v_dot2c_f32_bf16 v23, v109, v8
  v_dot2c_f32_bf16 v22, v110, v8
  v_dot2c_f32_bf16 v23, v111, v8
  v_dot2c_f32_bf16 v22, v112, v8
  v_dot2c_f32_bf16 v23, v113, v8
  v_dot2c_f32_bf16 v22, v114, v8
  v_dot2c_f32_bf16 v23, v115, v8
  v_dot2c_f32_bf16 v22, v116, v8
  v_dot2c_f32_bf16 v23, v117, v8
  v_dot2c_f32_bf16 v22, v118, v8
  v_dot2c_f32_bf16 v23, v119, v8
  v_dot2c_f32_bf16 v22, v120, v8
  v_dot2c_f32_bf16 v23, v121, v8
  v_dot2c_f32_bf16 v22, v122, v8
  v_dot2c_f32_bf16 v23, v123, v8
  v_dot2c_f32_bf16 v22, v124, v8
  v_dot2c_f32_bf16 v23, v125, v8
  v_dot2c_f32_bf16 v22, v126, v8
  v_dot2c_f32_bf16 v23, v127, v8
  v_dot2c_f32_bf16 v22, v128, v8
  v_dot2c_f32_bf16 v23, v129, v8
  v_dot2c_f32_bf16 v22, v130, v8
  v_dot2c_f32_bf16 v23, v131, v8
  v_dot2c_f32_bf16 v22, v132, v8
  v_dot2c_f32_bf16 v23, v133, v8
  v_dot2c_f32_bf16 v22, v134, v8
  v_dot2c_f32_bf16 v23, v135, v8
  v_dot2c_f32_bf16 v22, v136, v8
  v_dot2c_f32_bf16 v23, v137, v8
  v_dot2c_f32_bf16 v22, v138, v8
  v_dot2c_f32_bf16 v23, v139, v8
  v_dot2c_f32_bf16 v22, v140, v8
  v_dot2c_f32_bf16 v23, v141, v8
  v_dot2c_f32_bf16 v22, v142, v8
  v_dot2c_f32_bf16 v23, v143, v8
  v_dot2c_f32_bf16 v22, v144, v8
  v_dot2c_f32_bf16 v23, v145, v8
  v_dot2c_f32_bf16 v22, v146, v8
  v_dot2c_f32_bf16 v23, v147, v8
  v_dot2c_f32_bf16 v22, v148, v8
  v_dot2c_f32_bf16 v23, v149, v8
  v_dot2c_f32_bf16 v22, v150, v8
  v_dot2c_f32_bf16 v23, v151, v8
  v_dot2c_f32_bf16 v22, v152, v8
  v_dot2c_f32_bf16 v23, v153, v8
  v_dot2c_f32_bf16 v22, v154, v8
  v_dot2c_f32_bf16 v23, v155, v8
  v_dot2c_f32_bf16 v22, v156, v8
  v_dot2c_f32_bf16 v23, v157, v8
  v_dot2c_f32_bf16 v22, v158, v8
  v_dot2c_f32_bf16 v23, v159, v8
  v_dot2c_f32_bf16 v22, v160, v8
  v_dot2c_f32_bf16 v23, v161, v8
  v_dot2c_f32_bf16 v22, v162, v8
  v_dot2c_f32_bf16 v23, v163, v8
  v_dot2c_f32_bf16 v22, v164, v8
  v_dot2c_f32_bf16 v23, v165, v8
  v_dot2c_f32_bf16 v22, v166, v8
  v_dot2c_f32_bf16 v23, v167, v8
  v_dot2c_f32_bf16 v22, v168, v8
  v_dot2c_f32_bf16 v23, v169, v8
  v_dot2c_f32_bf16 v22, v170, v8
  v_dot2c_f32_bf16 v23, v171, v8
  v_dot2c_f32_bf16 v22, v172, v8
  v_dot2c_f32_bf16 v23, v173, v8
  v_dot2c_f32_bf16 v22, v174, v8
  v_dot2c_f32_bf16 v23, v175, v8
  s_nop 2
  v_add_f32 v20, v20, v21
  v_add_f32 v22, v22, v23
  s_nop 1
  v_add_f32_dpp v20, v20, v20 quad_perm:[1,0,3,2] row_mask:0xf bank_mask:0xf
  v_add_f32_dpp v22, v22, v22 quad_perm:[1,0,3,2] row_mask:0xf bank_mask:0xf
  s_nop 1
  v_add_f32_dpp v20, v20, v20 quad_perm:[2,3,0,1] row_mask:0xf bank_mask:0xf
  v_add_f32_dpp v22, v22, v22 quad_perm:[2,3,0,1] row_mask:0xf bank_mask:0xf
  s_nop 1
  v_mul_f32 v20, 0x3ae38e39, v20
  v_mul_f32 v22, 0x3ae38e39, v22
  v_cvt_pk_bf16_f32 v24, v20, v22
  v_or_b32 v24, 0x10001, v24
  v_lshlrev_b32 v21, 16, v24
  v_and_b32 v23, 0xffff0000, v24
  v_sub_f32 v20, v20, v21
  v_sub_f32 v22, v22, v23
  v_cvt_pk_bf16_f32 v25, v20, v22
  v_or_b32 v25, 0x10001, v25
  ds_write_b16 v5, v24
  ds_write_b16_d16_hi v5, v24 offset:8
  ds_write_b16 v5, v25 offset:64
  ds_write_b16_d16_hi v5, v25 offset:72
  ds_read_b128 v[20:23], v7
  s_lshl_b32 s7, s6, 7
  s_add_u32 s7, s7, 9699328
  s_waitcnt lgkmcnt(0)
  s_mov_b64 exec, 0xff
  buffer_store_dwordx4 v[20:23], v6, s[56:59], s7 offen sc1
  s_mov_b64 exec, -1
  s_mov_b64 exec, 1
  ds_add_u32 v16, v17 offset:60
  s_mov_b64 exec, -1
  s_branch F_done
F_kv:
  s_mov_b32 s6, s12
  s_mul_i32 s7, s6, 7282
  s_lshr_b32 s7, s7, 16
  s_mul_i32 s8, s7, 9
  s_sub_u32 s8, s6, s8
  v_and_b32 v2, 7, v1
  v_lshrrev_b32 v3, 3, v1
  s_lshl_b32 s9, s7, 6
  v_lshl_add_u32 v4, v3, 3, s9
  v_mul_u32_u24 v5, 1152, v4
  s_lshl_b32 s10, s8, 7
  v_lshl_add_u32 v5, v2, 4, v5
  v_add_u32 v5, s10, v5
  v_subrev_u32 v6, 3456, v5
  v_cmp_eq_u32 vcc, 0, v4
  v_mov_b32 v7, 0x80000000
  s_lshl_b32 s11, s8, 9
  v_cndmask_b32 v6, v6, v7, vcc
  v_lshlrev_b32 v7, 6, v2
  s_movk_i32 s12, 4608
  s_mov_b32 s44, s18
  s_mov_b32 s45, s19
  s_mov_b32 s46, 2359296
  s_mov_b32 s47, 0x20000
  s_mov_b32 s48, s20
  s_mov_b32 s49, s21
  s_mov_b32 s50, 2359296
  s_mov_b32 s51, 0x20000
  s_mov_b32 s52, s22
  s_mov_b32 s53, s23
  s_mov_b32 s54, 4608
  s_mov_b32 s55, 0x20000
  buffer_load_dwordx4 v[108:111], v7, s[52:55], s11 offen offset:0
  buffer_load_dwordx4 v[112:115], v7, s[52:55], s11 offen offset:16
  buffer_load_dwordx4 v[116:119], v7, s[52:55], s11 offen offset:32
  buffer_load_dwordx4 v[120:123], v7, s[52:55], s11 offen offset:48
  buffer_load_dwordx4 v[44:47], v5, s[44:47], 0 offen offset:0 nt
  buffer_load_dwordx4 v[48:51], v5, s[44:47], 0 offen offset:1152 nt
  buffer_load_dwordx4 v[52:55], v5, s[44:47], 0 offen offset:2304 nt
  buffer_load_dwordx4 v[56:59], v5, s[44:47], 0 offen offset:3456 nt
  buffer_load_dwordx4 v[60:63], v5, s[44:47], s12 offen offset:0 nt
  buffer_load_dwordx4 v[64:67], v5, s[44:47], s12 offen offset:1152 nt
  buffer_load_dwordx4 v[68:71], v5, s[44:47], s12 offen offset:2304 nt
  buffer_load_dwordx4 v[72:75], v5, s[44:47], s12 offen offset:3456 nt
  s_mov_b64 exec, 0xff
  buffer_load_dwordx4 v[32:35], v6, s[44:47], 0 offen offset:0 nt
  buffer_load_dwordx4 v[36:39], v6, s[44:47], 0 offen offset:1152 nt
  buffer_load_dwordx4 v[40:43], v6, s[44:47], 0 offen offset:2304 nt
  s_mov_b64 exec, -1
  v_lshlrev_b32 v18, 2, v1
  v_subrev_u32 v18, 32, v18
  buffer_load_dwordx4 v[76:79], v5, s[48:51], 0 offen offset:0 nt
  buffer_load_dwordx4 v[80:83], v5, s[48:51], 0 offen offset:1152 nt
  buffer_load_dwordx4 v[84:87], v5, s[48:51], 0 offen offset:2304 nt
  buffer_load_dwordx4 v[88:91], v5, s[48:51], 0 offen offset:3456 nt
  buffer_load_dwordx4 v[92:95], v5, s[48:51], s12 offen offset:0 nt
  buffer_load_dwordx4 v[96:99], v5, s[48:51], s12 offen offset:1152 nt
  buffer_load_dwordx4 v[100:103], v5, s[48:51], s12 offen offset:2304 nt
  buffer_load_dwordx4 v[104:107], v5, s[48:51], s12 offen offset:3456 nt
  v_sub_u32 v8, 7, v3
  v_xor_b32 v8, v8, v2
  v_lshlrev_b32 v8, 4, v8
  v_lshl_add_u32 v8, v2, 9, v8
  v_add_u32 v8, s13, v8
  v_lshrrev_b32 v11, 5, v1
  v_xor_b32 v9, v11, v1
  v_lshlrev_b32 v9, 4, v9
  v_and_b32 v10, 3, v3
  v_lshl_add_u32 v10, v11, 3, v10
  v_mul_u32_u24 v10, 4224, v10
  v_lshl_add_u32 v10, v2, 4, v10
  s_mul_i32 s14, s8, 270336
  s_lshl_b32 s15, s7, 7
  s_sub_u32 s14, s14, s15
  s_add_u32 s14, s14, 4722560
  v_xor_b32 v12, 0, v9
  v_add_u32 v12, s13, v12
  v_xor_b32 v13, 32, v9
  v_add_u32 v13, s13, v13
  v_xor_b32 v14, 64, v9
  v_add_u32 v14, s13, v14
  v_xor_b32 v15, 96, v9
  v_add_u32 v15, s13, v15
  s_waitcnt vmcnt(8)
  ds_bpermute_b32 v156, v18, v64
  ds_bpermute_b32 v157, v18, v65
  ds_bpermute_b32 v158, v18, v66
  ds_bpermute_b32 v159, v18, v67
  ds_bpermute_b32 v160, v18, v68
  ds_bpermute_b32 v161, v18, v69
  ds_bpermute_b32 v162, v18, v70
  ds_bpermute_b32 v163, v18, v71
  ds_bpermute_b32 v164, v18, v72
  ds_bpermute_b32 v165, v18, v73
  ds_bpermute_b32 v166, v18, v74
  ds_bpermute_b32 v167, v18, v75
  s_mov_b32 exec_lo, 0xffffff00
  s_waitcnt lgkmcnt(0)
  v_mov_b32 v32, v156
  v_mov_b32 v33, v157
  v_mov_b32 v34, v158
  v_mov_b32 v35, v159
  v_mov_b32 v36, v160
  v_mov_b32 v37, v161
  v_mov_b32 v38, v162
  v_mov_b32 v39, v163
  v_mov_b32 v40, v164
  v_mov_b32 v41, v165
  v_mov_b32 v42, v166
  v_mov_b32 v43, v167
  s_mov_b64 exec, -1
  v_lshlrev_b32 v124, 16, v108
  v_lshlrev_b32 v125, 16, v110
  v_and_b32 v126, 0xffff0000, v108
  v_and_b32 v127, 0xffff0000, v110
  v_lshlrev_b32 v128, 16, v109
  v_lshlrev_b32 v129, 16, v111
  v_and_b32 v130, 0xffff0000, v109
  v_and_b32 v131, 0xffff0000, v111
  v_lshlrev_b32 v132, 16, v32
  v_and_b32 v133, 0xffff0000, v32
  v_lshlrev_b32 v134, 16, v36
  v_and_b32 v135, 0xffff0000, v36
  v_lshlrev_b32 v136, 16, v40
  v_and_b32 v137, 0xffff0000, v40
  v_lshlrev_b32 v138, 16, v44
  v_and_b32 v139, 0xffff0000, v44
  v_lshlrev_b32 v140, 16, v48
  v_and_b32 v141, 0xffff0000, v48
  v_lshlrev_b32 v142, 16, v52
  v_and_b32 v143, 0xffff0000, v52
  v_lshlrev_b32 v144, 16, v56
  v_and_b32 v145, 0xffff0000, v56
  v_lshlrev_b32 v146, 16, v60
  v_and_b32 v147, 0xffff0000, v60
  v_lshlrev_b32 v148, 16, v64
  v_and_b32 v149, 0xffff0000, v64
  v_lshlrev_b32 v150, 16, v68
  v_and_b32 v151, 0xffff0000, v68
  v_lshlrev_b32 v152, 16, v72
  v_and_b32 v153, 0xffff0000, v72
  v_pk_mul_f32 v[156:157], v[138:139], v[124:125]
  v_pk_mul_f32 v[158:159], v[140:141], v[124:125]
  v_pk_mul_f32 v[160:161], v[142:143], v[124:125]
  v_pk_mul_f32 v[162:163], v[144:145], v[124:125]
  v_pk_mul_f32 v[164:165], v[146:147], v[124:125]
  v_pk_mul_f32 v[166:167], v[148:149], v[124:125]
  v_pk_mul_f32 v[168:169], v[150:151], v[124:125]
  v_pk_mul_f32 v[170:171], v[152:153], v[124:125]
  v_pk_fma_f32 v[156:157], v[136:137], v[126:127], v[156:157]
  v_pk_fma_f32 v[158:159], v[138:139], v[126:127], v[158:159]
  v_pk_fma_f32 v[160:161], v[140:141], v[126:127], v[160:161]
  v_pk_fma_f32 v[162:163], v[142:143], v[126:127], v[162:163]
  v_pk_fma_f32 v[164:165], v[144:145], v[126:127], v[164:165]
  v_pk_fma_f32 v[166:167], v[146:147], v[126:127], v[166:167]
  v_pk_fma_f32 v[168:169], v[148:149], v[126:127], v[168:169]
  v_pk_fma_f32 v[170:171], v[150:151], v[126:127], v[170:171]
  v_pk_fma_f32 v[156:157], v[134:135], v[128:129], v[156:157]
  v_pk_fma_f32 v[158:159], v[136:137], v[128:129], v[158:159]
  v_pk_fma_f32 v[160:161], v[138:139], v[128:129], v[160:161]
  v_pk_fma_f32 v[162:163], v[140:141], v[128:129], v[162:163]
  v_pk_fma_f32 v[164:165], v[142:143], v[128:129], v[164:165]
  v_pk_fma_f32 v[166:167], v[144:145], v[128:129], v[166:167]
  v_pk_fma_f32 v[168:169], v[146:147], v[128:129], v[168:169]
  v_pk_fma_f32 v[170:171], v[148:149], v[128:129], v[170:171]
  v_pk_fma_f32 v[156:157], v[132:133], v[130:131], v[156:157]
  v_pk_fma_f32 v[158:159], v[134:135], v[130:131], v[158:159]
  v_pk_fma_f32 v[160:161], v[136:137], v[130:131], v[160:161]
  v_pk_fma_f32 v[162:163], v[138:139], v[130:131], v[162:163]
  v_pk_fma_f32 v[164:165], v[140:141], v[130:131], v[164:165]
  v_pk_fma_f32 v[166:167], v[142:143], v[130:131], v[166:167]
  v_pk_fma_f32 v[168:169], v[144:145], v[130:131], v[168:169]
  v_pk_fma_f32 v[170:171], v[146:147], v[130:131], v[170:171]
  s_waitcnt vmcnt(0)
  s_mov_b64 exec, 1
  ds_add_u32 v16, v17 offset:36
  s_mov_b64 exec, -1
  v_lshlrev_b32 v132, 16, v76
  v_and_b32 v133, 0xffff0000, v76
  v_lshlrev_b32 v134, 16, v80
  v_and_b32 v135, 0xffff0000, v80
  v_lshlrev_b32 v136, 16, v84
  v_and_b32 v137, 0xffff0000, v84
  v_lshlrev_b32 v138, 16, v88
  v_and_b32 v139, 0xffff0000, v88
  v_lshlrev_b32 v140, 16, v92
  v_and_b32 v141, 0xffff0000, v92
  v_lshlrev_b32 v142, 16, v96
  v_and_b32 v143, 0xffff0000, v96
  v_lshlrev_b32 v144, 16, v100
  v_and_b32 v145, 0xffff0000, v100
  v_lshlrev_b32 v146, 16, v104
  v_and_b32 v147, 0xffff0000, v104
  v_pk_mul_f32 v[156:157], v[156:157], v[132:133]
  v_pk_mul_f32 v[158:159], v[158:159], v[134:135]
  v_pk_mul_f32 v[160:161], v[160:161], v[136:137]
  v_pk_mul_f32 v[162:163], v[162:163], v[138:139]
  v_pk_mul_f32 v[164:165], v[164:165], v[140:141]
  v_pk_mul_f32 v[166:167], v[166:167], v[142:143]
  v_pk_mul_f32 v[168:169], v[168:169], v[144:145]
  v_pk_mul_f32 v[170:171], v[170:171], v[146:147]
  v_cvt_pk_bf16_f32 v172, v170, v168
  v_cvt_pk_bf16_f32 v173, v166, v164
  v_cvt_pk_bf16_f32 v174, v162, v160
  v_cvt_pk_bf16_f32 v175, v158, v156
  ds_write_b128 v8, v[172:175] offset:0
  v_cvt_pk_bf16_f32 v176, v171, v169
  v_cvt_pk_bf16_f32 v177, v167, v165
  v_cvt_pk_bf16_f32 v178, v163, v161
  v_cvt_pk_bf16_f32 v179, v159, v157
  ds_write_b128 v8, v[176:179] offset:128
  v_lshlrev_b32 v124, 16, v112
  v_lshlrev_b32 v125, 16, v114
  v_and_b32 v126, 0xffff0000, v112
  v_and_b32 v127, 0xffff0000, v114
  v_lshlrev_b32 v128, 16, v113
  v_lshlrev_b32 v129, 16, v115
  v_and_b32 v130, 0xffff0000, v113
  v_and_b32 v131, 0xffff0000, v115
  v_lshlrev_b32 v132, 16, v33
  v_and_b32 v133, 0xffff0000, v33
  v_lshlrev_b32 v134, 16, v37
  v_and_b32 v135, 0xffff0000, v37
  v_lshlrev_b32 v136, 16, v41
  v_and_b32 v137, 0xffff0000, v41
  v_lshlrev_b32 v138, 16, v45
  v_and_b32 v139, 0xffff0000, v45
  v_lshlrev_b32 v140, 16, v49
  v_and_b32 v141, 0xffff0000, v49
  v_lshlrev_b32 v142, 16, v53
  v_and_b32 v143, 0xffff0000, v53
  v_lshlrev_b32 v144, 16, v57
  v_and_b32 v145, 0xffff0000, v57
  v_lshlrev_b32 v146, 16, v61
  v_and_b32 v147, 0xffff0000, v61
  v_lshlrev_b32 v148, 16, v65
  v_and_b32 v149, 0xffff0000, v65
  v_lshlrev_b32 v150, 16, v69
  v_and_b32 v151, 0xffff0000, v69
  v_lshlrev_b32 v152, 16, v73
  v_and_b32 v153, 0xffff0000, v73
  v_pk_mul_f32 v[156:157], v[138:139], v[124:125]
  v_pk_mul_f32 v[158:159], v[140:141], v[124:125]
  v_pk_mul_f32 v[160:161], v[142:143], v[124:125]
  v_pk_mul_f32 v[162:163], v[144:145], v[124:125]
  v_pk_mul_f32 v[164:165], v[146:147], v[124:125]
  v_pk_mul_f32 v[166:167], v[148:149], v[124:125]
  v_pk_mul_f32 v[168:169], v[150:151], v[124:125]
  v_pk_mul_f32 v[170:171], v[152:153], v[124:125]
  v_pk_fma_f32 v[156:157], v[136:137], v[126:127], v[156:157]
  v_pk_fma_f32 v[158:159], v[138:139], v[126:127], v[158:159]
  v_pk_fma_f32 v[160:161], v[140:141], v[126:127], v[160:161]
  v_pk_fma_f32 v[162:163], v[142:143], v[126:127], v[162:163]
  v_pk_fma_f32 v[164:165], v[144:145], v[126:127], v[164:165]
  v_pk_fma_f32 v[166:167], v[146:147], v[126:127], v[166:167]
  v_pk_fma_f32 v[168:169], v[148:149], v[126:127], v[168:169]
  v_pk_fma_f32 v[170:171], v[150:151], v[126:127], v[170:171]
  v_pk_fma_f32 v[156:157], v[134:135], v[128:129], v[156:157]
  v_pk_fma_f32 v[158:159], v[136:137], v[128:129], v[158:159]
  v_pk_fma_f32 v[160:161], v[138:139], v[128:129], v[160:161]
  v_pk_fma_f32 v[162:163], v[140:141], v[128:129], v[162:163]
  v_pk_fma_f32 v[164:165], v[142:143], v[128:129], v[164:165]
  v_pk_fma_f32 v[166:167], v[144:145], v[128:129], v[166:167]
  v_pk_fma_f32 v[168:169], v[146:147], v[128:129], v[168:169]
  v_pk_fma_f32 v[170:171], v[148:149], v[128:129], v[170:171]
  v_pk_fma_f32 v[156:157], v[132:133], v[130:131], v[156:157]
  v_pk_fma_f32 v[158:159], v[134:135], v[130:131], v[158:159]
  v_pk_fma_f32 v[160:161], v[136:137], v[130:131], v[160:161]
  v_pk_fma_f32 v[162:163], v[138:139], v[130:131], v[162:163]
  v_pk_fma_f32 v[164:165], v[140:141], v[130:131], v[164:165]
  v_pk_fma_f32 v[166:167], v[142:143], v[130:131], v[166:167]
  v_pk_fma_f32 v[168:169], v[144:145], v[130:131], v[168:169]
  v_pk_fma_f32 v[170:171], v[146:147], v[130:131], v[170:171]
  v_lshlrev_b32 v132, 16, v77
  v_and_b32 v133, 0xffff0000, v77
  v_lshlrev_b32 v134, 16, v81
  v_and_b32 v135, 0xffff0000, v81
  v_lshlrev_b32 v136, 16, v85
  v_and_b32 v137, 0xffff0000, v85
  v_lshlrev_b32 v138, 16, v89
  v_and_b32 v139, 0xffff0000, v89
  v_lshlrev_b32 v140, 16, v93
  v_and_b32 v141, 0xffff0000, v93
  v_lshlrev_b32 v142, 16, v97
  v_and_b32 v143, 0xffff0000, v97
  v_lshlrev_b32 v144, 16, v101
  v_and_b32 v145, 0xffff0000, v101
  v_lshlrev_b32 v146, 16, v105
  v_and_b32 v147, 0xffff0000, v105
  v_pk_mul_f32 v[156:157], v[156:157], v[132:133]
  v_pk_mul_f32 v[158:159], v[158:159], v[134:135]
  v_pk_mul_f32 v[160:161], v[160:161], v[136:137]
  v_pk_mul_f32 v[162:163], v[162:163], v[138:139]
  v_pk_mul_f32 v[164:165], v[164:165], v[140:141]
  v_pk_mul_f32 v[166:167], v[166:167], v[142:143]
  v_pk_mul_f32 v[168:169], v[168:169], v[144:145]
  v_pk_mul_f32 v[170:171], v[170:171], v[146:147]
  v_cvt_pk_bf16_f32 v180, v170, v168
  v_cvt_pk_bf16_f32 v181, v166, v164
  v_cvt_pk_bf16_f32 v182, v162, v160
  v_cvt_pk_bf16_f32 v183, v158, v156
  ds_write_b128 v8, v[180:183] offset:256
  v_cvt_pk_bf16_f32 v184, v171, v169
  v_cvt_pk_bf16_f32 v185, v167, v165
  v_cvt_pk_bf16_f32 v186, v163, v161
  v_cvt_pk_bf16_f32 v187, v159, v157
  ds_write_b128 v8, v[184:187] offset:384
  ds_read_b128 v[188:191], v12 offset:0
  ds_read_b128 v[192:195], v13 offset:1024
  ds_read_b128 v[196:199], v14 offset:2048
  ds_read_b128 v[200:203], v15 offset:3072
  s_add_u32 s15, s14, 0
  s_waitcnt lgkmcnt(3)
  buffer_store_dwordx4 v[188:191], v10, s[56:59], s15 offen sc1
  s_add_u32 s15, s15, 67584
  s_waitcnt lgkmcnt(2)
  buffer_store_dwordx4 v[192:195], v10, s[56:59], s15 offen sc1
  s_add_u32 s15, s15, 67584
  s_waitcnt lgkmcnt(1)
  buffer_store_dwordx4 v[196:199], v10, s[56:59], s15 offen sc1
  s_add_u32 s15, s15, 67584
  s_waitcnt lgkmcnt(0)
  buffer_store_dwordx4 v[200:203], v10, s[56:59], s15 offen sc1
  s_add_u32 s15, s15, 67584
  v_lshlrev_b32 v124, 16, v116
  v_lshlrev_b32 v125, 16, v118
  v_and_b32 v126, 0xffff0000, v116
  v_and_b32 v127, 0xffff0000, v118
  v_lshlrev_b32 v128, 16, v117
  v_lshlrev_b32 v129, 16, v119
  v_and_b32 v130, 0xffff0000, v117
  v_and_b32 v131, 0xffff0000, v119
  v_lshlrev_b32 v132, 16, v34
  v_and_b32 v133, 0xffff0000, v34
  v_lshlrev_b32 v134, 16, v38
  v_and_b32 v135, 0xffff0000, v38
  v_lshlrev_b32 v136, 16, v42
  v_and_b32 v137, 0xffff0000, v42
  v_lshlrev_b32 v138, 16, v46
  v_and_b32 v139, 0xffff0000, v46
  v_lshlrev_b32 v140, 16, v50
  v_and_b32 v141, 0xffff0000, v50
  v_lshlrev_b32 v142, 16, v54
  v_and_b32 v143, 0xffff0000, v54
  v_lshlrev_b32 v144, 16, v58
  v_and_b32 v145, 0xffff0000, v58
  v_lshlrev_b32 v146, 16, v62
  v_and_b32 v147, 0xffff0000, v62
  v_lshlrev_b32 v148, 16, v66
  v_and_b32 v149, 0xffff0000, v66
  v_lshlrev_b32 v150, 16, v70
  v_and_b32 v151, 0xffff0000, v70
  v_lshlrev_b32 v152, 16, v74
  v_and_b32 v153, 0xffff0000, v74
  v_pk_mul_f32 v[156:157], v[138:139], v[124:125]
  v_pk_mul_f32 v[158:159], v[140:141], v[124:125]
  v_pk_mul_f32 v[160:161], v[142:143], v[124:125]
  v_pk_mul_f32 v[162:163], v[144:145], v[124:125]
  v_pk_mul_f32 v[164:165], v[146:147], v[124:125]
  v_pk_mul_f32 v[166:167], v[148:149], v[124:125]
  v_pk_mul_f32 v[168:169], v[150:151], v[124:125]
  v_pk_mul_f32 v[170:171], v[152:153], v[124:125]
  v_pk_fma_f32 v[156:157], v[136:137], v[126:127], v[156:157]
  v_pk_fma_f32 v[158:159], v[138:139], v[126:127], v[158:159]
  v_pk_fma_f32 v[160:161], v[140:141], v[126:127], v[160:161]
  v_pk_fma_f32 v[162:163], v[142:143], v[126:127], v[162:163]
  v_pk_fma_f32 v[164:165], v[144:145], v[126:127], v[164:165]
  v_pk_fma_f32 v[166:167], v[146:147], v[126:127], v[166:167]
  v_pk_fma_f32 v[168:169], v[148:149], v[126:127], v[168:169]
  v_pk_fma_f32 v[170:171], v[150:151], v[126:127], v[170:171]
  v_pk_fma_f32 v[156:157], v[134:135], v[128:129], v[156:157]
  v_pk_fma_f32 v[158:159], v[136:137], v[128:129], v[158:159]
  v_pk_fma_f32 v[160:161], v[138:139], v[128:129], v[160:161]
  v_pk_fma_f32 v[162:163], v[140:141], v[128:129], v[162:163]
  v_pk_fma_f32 v[164:165], v[142:143], v[128:129], v[164:165]
  v_pk_fma_f32 v[166:167], v[144:145], v[128:129], v[166:167]
  v_pk_fma_f32 v[168:169], v[146:147], v[128:129], v[168:169]
  v_pk_fma_f32 v[170:171], v[148:149], v[128:129], v[170:171]
  v_pk_fma_f32 v[156:157], v[132:133], v[130:131], v[156:157]
  v_pk_fma_f32 v[158:159], v[134:135], v[130:131], v[158:159]
  v_pk_fma_f32 v[160:161], v[136:137], v[130:131], v[160:161]
  v_pk_fma_f32 v[162:163], v[138:139], v[130:131], v[162:163]
  v_pk_fma_f32 v[164:165], v[140:141], v[130:131], v[164:165]
  v_pk_fma_f32 v[166:167], v[142:143], v[130:131], v[166:167]
  v_pk_fma_f32 v[168:169], v[144:145], v[130:131], v[168:169]
  v_pk_fma_f32 v[170:171], v[146:147], v[130:131], v[170:171]
  v_lshlrev_b32 v132, 16, v78
  v_and_b32 v133, 0xffff0000, v78
  v_lshlrev_b32 v134, 16, v82
  v_and_b32 v135, 0xffff0000, v82
  v_lshlrev_b32 v136, 16, v86
  v_and_b32 v137, 0xffff0000, v86
  v_lshlrev_b32 v138, 16, v90
  v_and_b32 v139, 0xffff0000, v90
  v_lshlrev_b32 v140, 16, v94
  v_and_b32 v141, 0xffff0000, v94
  v_lshlrev_b32 v142, 16, v98
  v_and_b32 v143, 0xffff0000, v98
  v_lshlrev_b32 v144, 16, v102
  v_and_b32 v145, 0xffff0000, v102
  v_lshlrev_b32 v146, 16, v106
  v_and_b32 v147, 0xffff0000, v106
  v_pk_mul_f32 v[156:157], v[156:157], v[132:133]
  v_pk_mul_f32 v[158:159], v[158:159], v[134:135]
  v_pk_mul_f32 v[160:161], v[160:161], v[136:137]
  v_pk_mul_f32 v[162:163], v[162:163], v[138:139]
  v_pk_mul_f32 v[164:165], v[164:165], v[140:141]
  v_pk_mul_f32 v[166:167], v[166:167], v[142:143]
  v_pk_mul_f32 v[168:169], v[168:169], v[144:145]
  v_pk_mul_f32 v[170:171], v[170:171], v[146:147]
  v_cvt_pk_bf16_f32 v172, v170, v168
  v_cvt_pk_bf16_f32 v173, v166, v164
  v_cvt_pk_bf16_f32 v174, v162, v160
  v_cvt_pk_bf16_f32 v175, v158, v156
  ds_write_b128 v8, v[172:175] offset:0
  v_cvt_pk_bf16_f32 v176, v171, v169
  v_cvt_pk_bf16_f32 v177, v167, v165
  v_cvt_pk_bf16_f32 v178, v163, v161
  v_cvt_pk_bf16_f32 v179, v159, v157
  ds_write_b128 v8, v[176:179] offset:128
  v_lshlrev_b32 v124, 16, v120
  v_lshlrev_b32 v125, 16, v122
  v_and_b32 v126, 0xffff0000, v120
  v_and_b32 v127, 0xffff0000, v122
  v_lshlrev_b32 v128, 16, v121
  v_lshlrev_b32 v129, 16, v123
  v_and_b32 v130, 0xffff0000, v121
  v_and_b32 v131, 0xffff0000, v123
  v_lshlrev_b32 v132, 16, v35
  v_and_b32 v133, 0xffff0000, v35
  v_lshlrev_b32 v134, 16, v39
  v_and_b32 v135, 0xffff0000, v39
  v_lshlrev_b32 v136, 16, v43
  v_and_b32 v137, 0xffff0000, v43
  v_lshlrev_b32 v138, 16, v47
  v_and_b32 v139, 0xffff0000, v47
  v_lshlrev_b32 v140, 16, v51
  v_and_b32 v141, 0xffff0000, v51
  v_lshlrev_b32 v142, 16, v55
  v_and_b32 v143, 0xffff0000, v55
  v_lshlrev_b32 v144, 16, v59
  v_and_b32 v145, 0xffff0000, v59
  v_lshlrev_b32 v146, 16, v63
  v_and_b32 v147, 0xffff0000, v63
  v_lshlrev_b32 v148, 16, v67
  v_and_b32 v149, 0xffff0000, v67
  v_lshlrev_b32 v150, 16, v71
  v_and_b32 v151, 0xffff0000, v71
  v_lshlrev_b32 v152, 16, v75
  v_and_b32 v153, 0xffff0000, v75
  v_pk_mul_f32 v[156:157], v[138:139], v[124:125]
  v_pk_mul_f32 v[158:159], v[140:141], v[124:125]
  v_pk_mul_f32 v[160:161], v[142:143], v[124:125]
  v_pk_mul_f32 v[162:163], v[144:145], v[124:125]
  v_pk_mul_f32 v[164:165], v[146:147], v[124:125]
  v_pk_mul_f32 v[166:167], v[148:149], v[124:125]
  v_pk_mul_f32 v[168:169], v[150:151], v[124:125]
  v_pk_mul_f32 v[170:171], v[152:153], v[124:125]
  v_pk_fma_f32 v[156:157], v[136:137], v[126:127], v[156:157]
  v_pk_fma_f32 v[158:159], v[138:139], v[126:127], v[158:159]
  v_pk_fma_f32 v[160:161], v[140:141], v[126:127], v[160:161]
  v_pk_fma_f32 v[162:163], v[142:143], v[126:127], v[162:163]
  v_pk_fma_f32 v[164:165], v[144:145], v[126:127], v[164:165]
  v_pk_fma_f32 v[166:167], v[146:147], v[126:127], v[166:167]
  v_pk_fma_f32 v[168:169], v[148:149], v[126:127], v[168:169]
  v_pk_fma_f32 v[170:171], v[150:151], v[126:127], v[170:171]
  v_pk_fma_f32 v[156:157], v[134:135], v[128:129], v[156:157]
  v_pk_fma_f32 v[158:159], v[136:137], v[128:129], v[158:159]
  v_pk_fma_f32 v[160:161], v[138:139], v[128:129], v[160:161]
  v_pk_fma_f32 v[162:163], v[140:141], v[128:129], v[162:163]
  v_pk_fma_f32 v[164:165], v[142:143], v[128:129], v[164:165]
  v_pk_fma_f32 v[166:167], v[144:145], v[128:129], v[166:167]
  v_pk_fma_f32 v[168:169], v[146:147], v[128:129], v[168:169]
  v_pk_fma_f32 v[170:171], v[148:149], v[128:129], v[170:171]
  v_pk_fma_f32 v[156:157], v[132:133], v[130:131], v[156:157]
  v_pk_fma_f32 v[158:159], v[134:135], v[130:131], v[158:159]
  v_pk_fma_f32 v[160:161], v[136:137], v[130:131], v[160:161]
  v_pk_fma_f32 v[162:163], v[138:139], v[130:131], v[162:163]
  v_pk_fma_f32 v[164:165], v[140:141], v[130:131], v[164:165]
  v_pk_fma_f32 v[166:167], v[142:143], v[130:131], v[166:167]
  v_pk_fma_f32 v[168:169], v[144:145], v[130:131], v[168:169]
  v_pk_fma_f32 v[170:171], v[146:147], v[130:131], v[170:171]
  v_lshlrev_b32 v132, 16, v79
  v_and_b32 v133, 0xffff0000, v79
  v_lshlrev_b32 v134, 16, v83
  v_and_b32 v135, 0xffff0000, v83
  v_lshlrev_b32 v136, 16, v87
  v_and_b32 v137, 0xffff0000, v87
  v_lshlrev_b32 v138, 16, v91
  v_and_b32 v139, 0xffff0000, v91
  v_lshlrev_b32 v140, 16, v95
  v_and_b32 v141, 0xffff0000, v95
  v_lshlrev_b32 v142, 16, v99
  v_and_b32 v143, 0xffff0000, v99
  v_lshlrev_b32 v144, 16, v103
  v_and_b32 v145, 0xffff0000, v103
  v_lshlrev_b32 v146, 16, v107
  v_and_b32 v147, 0xffff0000, v107
  v_pk_mul_f32 v[156:157], v[156:157], v[132:133]
  v_pk_mul_f32 v[158:159], v[158:159], v[134:135]
  v_pk_mul_f32 v[160:161], v[160:161], v[136:137]
  v_pk_mul_f32 v[162:163], v[162:163], v[138:139]
  v_pk_mul_f32 v[164:165], v[164:165], v[140:141]
  v_pk_mul_f32 v[166:167], v[166:167], v[142:143]
  v_pk_mul_f32 v[168:169], v[168:169], v[144:145]
  v_pk_mul_f32 v[170:171], v[170:171], v[146:147]
  v_cvt_pk_bf16_f32 v180, v170, v168
  v_cvt_pk_bf16_f32 v181, v166, v164
  v_cvt_pk_bf16_f32 v182, v162, v160
  v_cvt_pk_bf16_f32 v183, v158, v156
  ds_write_b128 v8, v[180:183] offset:256
  v_cvt_pk_bf16_f32 v184, v171, v169
  v_cvt_pk_bf16_f32 v185, v167, v165
  v_cvt_pk_bf16_f32 v186, v163, v161
  v_cvt_pk_bf16_f32 v187, v159, v157
  ds_write_b128 v8, v[184:187] offset:384
  ds_read_b128 v[204:207], v12 offset:0
  ds_read_b128 v[208:211], v13 offset:1024
  ds_read_b128 v[212:215], v14 offset:2048
  ds_read_b128 v[216:219], v15 offset:3072
  s_add_u32 s15, s14, 16896
  s_waitcnt lgkmcnt(3)
  buffer_store_dwordx4 v[204:207], v10, s[56:59], s15 offen sc1
  s_add_u32 s15, s15, 67584
  s_waitcnt lgkmcnt(2)
  buffer_store_dwordx4 v[208:211], v10, s[56:59], s15 offen sc1
  s_add_u32 s15, s15, 67584
  s_waitcnt lgkmcnt(1)
  buffer_store_dwordx4 v[212:215], v10, s[56:59], s15 offen sc1
  s_add_u32 s15, s15, 67584
  s_waitcnt lgkmcnt(0)
  buffer_store_dwordx4 v[216:219], v10, s[56:59], s15 offen sc1
  s_add_u32 s15, s15, 67584
  s_cmp_lg_u32 s7, 0
  s_cbranch_scc1 KV_z
  v_mov_b32 v132, 0
  v_mov_b32 v133, 0
  v_mov_b32 v134, 0
  v_mov_b32 v135, 0
  buffer_store_dwordx4 v[132:135], v10, s[56:59], s14 offen offset:128 sc1
  s_add_u32 s14, s14, 16896
  buffer_store_dwordx4 v[132:135], v10, s[56:59], s14 offen offset:128 sc1
  s_add_u32 s14, s14, 50688
  buffer_store_dwordx4 v[132:135], v10, s[56:59], s14 offen offset:128 sc1
  s_add_u32 s14, s14, 16896
  buffer_store_dwordx4 v[132:135], v10, s[56:59], s14 offen offset:128 sc1
  s_add_u32 s14, s14, 50688
  buffer_store_dwordx4 v[132:135], v10, s[56:59], s14 offen offset:128 sc1
  s_add_u32 s14, s14, 16896
  buffer_store_dwordx4 v[132:135], v10, s[56:59], s14 offen offset:128 sc1
  s_add_u32 s14, s14, 50688
  buffer_store_dwordx4 v[132:135], v10, s[56:59], s14 offen offset:128 sc1
  s_add_u32 s14, s14, 16896
  buffer_store_dwordx4 v[132:135], v10, s[56:59], s14 offen offset:128 sc1
  s_add_u32 s14, s14, 50688
KV_z:
  s_mul_i32 s9, s8, 86
  s_lshr_b32 s9, s9, 8
  s_mul_i32 s10, s9, 3968
  s_lshl_b32 s6, s8, 7
  s_add_u32 s6, s6, s10
  s_add_u32 s6, s6, 10070144
  s_mov_b32 s100, 32
  s_mul_i32 s11, s8, 4352
  s_add_u32 s11, s11, 10139648
  s_branch F_sig
F_pt:
  s_mov_b32 s64, 0
  s_cmp_lt_u32 s12, 450
  s_cbranch_scc1 F_job
  s_cmp_ge_u32 s12, 738
  s_cbranch_scc1 F_r2
LW_23:
  ds_read_b32 v5, v16 offset:60
  s_waitcnt lgkmcnt(0)
  v_readfirstlane_b32 s7, v5
  s_cmp_ge_u32 s7, 4
  s_cbranch_scc1 LD_24
  s_sleep 4
  s_branch LW_23
LD_24:
F_job:
  s_setprio 1
  s_sub_u32 s12, s12, 306
  s_and_b32 s62, s12, 7
  s_lshr_b32 s12, s12, 3
  s_mov_b32 s9, s61
  s_mul_i32 s15, s62, 663552
  s_mul_i32 s98, s62, 4352
  s_cmp_ge_u32 s12, 54
  s_cbranch_scc1 JS_4
  s_mov_b32 s44, s34
  s_mov_b32 s45, s35
  s_mov_b32 s46, 5308416
  s_mov_b32 s47, 0x20000
  s_mul_i32 s14, s12, 57
  s_lshr_b32 s14, s14, 10
  s_mul_i32 s13, s14, 18
  s_sub_u32 s13, s12, s13
  s_mul_i32 s6, s13, 294912
  s_mul_i32 s7, s62, 1152
  s_add_u32 s6, s6, s7
  s_movk_i32 s7, 9216
  s_add_u32 s8, s15, 10485760
  s_add_u32 s15, s14, 1
  s_mov_b32 s100, 18
  s_lshl_b32 s15, s15, 7
  s_add_u32 s98, s98, s15
  s_branch JS_j
JS_4:
  s_mov_b32 s44, s36
  s_mov_b32 s45, s37
  s_mov_b32 s46, 5308416
  s_mov_b32 s47, 0x20000
  s_sub_u32 s6, s12, 54
  s_mul_i32 s13, s6, 86
  s_lshr_b32 s13, s13, 8
  s_mul_i32 s14, s13, 3
  s_sub_u32 s14, s6, s14
  s_mul_i32 s6, s13, 36864
  s_add_u32 s6, s6, s15
  s_movk_i32 s7, 1152
  s_mov_b32 s100, 54
  s_add_u32 s8, s15, 15794176
JS_j:
  s_mul_i32 s15, s14, 384
  s_add_u32 s6, s6, s15
  s_mul_i32 s15, s13, 36864
  s_add_u32 s8, s8, s15
  s_mul_i32 s15, s14, 12288
  s_add_u32 s8, s8, s15
  s_add_u32 s98, s98, 10035200
  v_lshrrev_b32 v18, 3, v1
  v_and_b32 v19, 7, v1
  v_mul_lo_u32 v20, v18, s7
  v_lshl_add_u32 v20, v19, 4, v20
  s_lshl_b32 s10, s7, 3
  buffer_load_dwordx4 v[128:131], v20, s[44:47], s6 offen offset:0 nt
  s_add_u32 s6, s6, s10
  buffer_load_dwordx4 v[132:135], v20, s[44:47], s6 offen offset:0 nt
  s_add_u32 s6, s6, s10
  buffer_load_dwordx4 v[136:139], v20, s[44:47], s6 offen offset:0 nt
  s_add_u32 s6, s6, s10
  buffer_load_dwordx4 v[140:143], v20, s[44:47], s6 offen offset:0 nt
  s_mul_i32 s11, s10, 3
  s_sub_u32 s6, s6, s11
  buffer_load_dwordx4 v[144:147], v20, s[44:47], s6 offen offset:128 nt
  s_add_u32 s6, s6, s10
  buffer_load_dwordx4 v[148:151], v20, s[44:47], s6 offen offset:128 nt
  s_add_u32 s6, s6, s10
  buffer_load_dwordx4 v[152:155], v20, s[44:47], s6 offen offset:128 nt
  s_add_u32 s6, s6, s10
  buffer_load_dwordx4 v[156:159], v20, s[44:47], s6 offen offset:128 nt
  s_sub_u32 s6, s6, s11
  buffer_load_dwordx4 v[160:163], v20, s[44:47], s6 offen offset:256 nt
  s_add_u32 s6, s6, s10
  buffer_load_dwordx4 v[164:167], v20, s[44:47], s6 offen offset:256 nt
  s_add_u32 s6, s6, s10
  buffer_load_dwordx4 v[168:171], v20, s[44:47], s6 offen offset:256 nt
  s_add_u32 s6, s6, s10
  buffer_load_dwordx4 v[172:175], v20, s[44:47], s6 offen offset:256 nt
  v_lshlrev_b32 v21, 4, v1
  v_add_u32 v22, s9, v21
  v_lshrrev_b32 v23, 2, v1
  v_lshlrev_b32 v23, 7, v23
  v_and_b32 v19, 3, v1
  v_lshl_add_u32 v23, v19, 3, v23
  v_add_u32 v23, s9, v23
  s_waitcnt vmcnt(8)
  ds_write_b128 v22, v[128:131] offset:0
  ds_write_b128 v22, v[132:135] offset:1024
  ds_write_b128 v22, v[136:139] offset:2048
  ds_write_b128 v22, v[140:143] offset:3072
  ds_read_b64_tr_b16 v[176:177], v23 offset:0
  ds_read_b64_tr_b16 v[178:179], v23 offset:2048
  ds_read_b64_tr_b16 v[180:181], v23 offset:32
  ds_read_b64_tr_b16 v[182:183], v23 offset:2080
  ds_read_b64_tr_b16 v[184:185], v23 offset:64
  ds_read_b64_tr_b16 v[186:187], v23 offset:2112
  ds_read_b64_tr_b16 v[188:189], v23 offset:96
  ds_read_b64_tr_b16 v[190:191], v23 offset:2144
  s_waitcnt lgkmcnt(0)
  buffer_store_dwordx4 v[176:179], v21, s[56:59], s8 offen offset:0 sc1
  buffer_store_dwordx4 v[180:183], v21, s[56:59], s8 offen offset:1024 sc1
  buffer_store_dwordx4 v[184:187], v21, s[56:59], s8 offen offset:2048 sc1
  buffer_store_dwordx4 v[188:191], v21, s[56:59], s8 offen offset:3072 sc1
  s_add_u32 s8, s8, 4096
  s_waitcnt vmcnt(8)
  ds_write_b128 v22, v[144:147] offset:0
  ds_write_b128 v22, v[148:151] offset:1024
  ds_write_b128 v22, v[152:155] offset:2048
  ds_write_b128 v22, v[156:159] offset:3072
  ds_read_b64_tr_b16 v[192:193], v23 offset:0
  ds_read_b64_tr_b16 v[194:195], v23 offset:2048
  ds_read_b64_tr_b16 v[196:197], v23 offset:32
  ds_read_b64_tr_b16 v[198:199], v23 offset:2080
  ds_read_b64_tr_b16 v[200:201], v23 offset:64
  ds_read_b64_tr_b16 v[202:203], v23 offset:2112
  ds_read_b64_tr_b16 v[204:205], v23 offset:96
  ds_read_b64_tr_b16 v[206:207], v23 offset:2144
  s_waitcnt lgkmcnt(0)
  buffer_store_dwordx4 v[192:195], v21, s[56:59], s8 offen offset:0 sc1
  buffer_store_dwordx4 v[196:199], v21, s[56:59], s8 offen offset:1024 sc1
  buffer_store_dwordx4 v[200:203], v21, s[56:59], s8 offen offset:2048 sc1
  buffer_store_dwordx4 v[204:207], v21, s[56:59], s8 offen offset:3072 sc1
  s_add_u32 s8, s8, 4096
  s_waitcnt vmcnt(8)
  ds_write_b128 v22, v[160:163] offset:0
  ds_write_b128 v22, v[164:167] offset:1024
  ds_write_b128 v22, v[168:171] offset:2048
  ds_write_b128 v22, v[172:175] offset:3072
  ds_read_b64_tr_b16 v[208:209], v23 offset:0
  ds_read_b64_tr_b16 v[210:211], v23 offset:2048
  ds_read_b64_tr_b16 v[212:213], v23 offset:32
  ds_read_b64_tr_b16 v[214:215], v23 offset:2080
  ds_read_b64_tr_b16 v[216:217], v23 offset:64
  ds_read_b64_tr_b16 v[218:219], v23 offset:2112
  ds_read_b64_tr_b16 v[220:221], v23 offset:96
  ds_read_b64_tr_b16 v[222:223], v23 offset:2144
  s_waitcnt lgkmcnt(0)
  buffer_store_dwordx4 v[208:211], v21, s[56:59], s8 offen offset:0 sc1
  buffer_store_dwordx4 v[212:215], v21, s[56:59], s8 offen offset:1024 sc1
  buffer_store_dwordx4 v[216:219], v21, s[56:59], s8 offen offset:2048 sc1
  buffer_store_dwordx4 v[220:223], v21, s[56:59], s8 offen offset:3072 sc1
  s_add_u32 s8, s8, 4096
  s_mov_b32 s6, s98
  s_add_u32 s11, s6, 52224
F_sig:
  s_load_dword s13, s[40:41], 0
  s_waitcnt vmcnt(0) lgkmcnt(0)
  s_cmp_lg_u32 s13, 0
  s_cbranch_scc1 ZD_26
  s_mov_b32 s13, 0x20000
  v_mov_b32 v14, 0
ZP_25:
  global_load_dword v15, v14, s[40:41] sc1
  s_waitcnt vmcnt(0)
  v_cmp_eq_u32 vcc, 0, v15
  s_cbranch_vccz ZD_26
  s_sleep 4
  s_sub_u32 s13, s13, 1
  s_cbranch_scc0 ZP_25
ZD_26:
  s_mov_b64 exec, 1
  ds_add_u32 v16, v17 offset:60
  s_mov_b64 exec, -1
  s_mov_b32 s8, 1
  s_atomic_add s8, s[42:43], s11 glc
  s_waitcnt lgkmcnt(0)
  s_add_u32 s8, s8, 1
  s_cmp_lg_u32 s8, s100
  s_cbranch_scc1 SA_27
  s_atomic_add s101, s[42:43], s6
SA_27:
F_done:
  s_cmp_lt_u32 s3, 4
  s_cbranch_scc1 F_cv
  s_cmp_lg_u32 s64, 0
  s_cbranch_scc1 F_end
F_r2:
LW_28:
  ds_read_b32 v5, v16 offset:60
  s_waitcnt lgkmcnt(0)
  v_readfirstlane_b32 s7, v5
  s_cmp_ge_u32 s7, 6
  s_cbranch_scc1 LD_29
  s_sleep 4
  s_branch LW_28
LD_29:
  s_mov_b32 s64, 1
  s_sub_u32 s12, 7, s3
  s_mul_i32 s12, s12, 112
  s_add_u32 s12, s12, s65
  s_add_u32 s12, s12, 738
  s_cmp_lt_u32 s12, 1170
  s_cbranch_scc1 F_job
F_end:
  v_lshlrev_b32 v2, 4, v1
  v_add_u32 v3, 4096, v2
  v_lshlrev_b32 v4, 2, v1
  s_and_b32 s4, s96, 1
  s_lshl_b32 s4, s4, 2
  s_and_b32 s7, s97, 3
  s_add_u32 s4, s4, s7
  s_lshr_b32 s5, s96, 1
  s_lshl_b32 s5, s5, 3
  s_lshr_b32 s7, s97, 2
  s_add_u32 s5, s5, s7
  s_mul_i32 s8, s4, 663552
  s_mul_i32 s71, s3, 3
  s_lshl_b32 s64, s71, 10
  s_add_u32 s64, s64, s8
  s_add_u32 s64, s64, 10485760
  s_add_u32 s65, s64, 24576
  s_and_b32 s9, s3, 3
  s_mul_i32 s9, s9, 9
  s_lshr_b32 s10, s3, 2
  s_lshl_b32 s10, s10, 1
  s_add_u32 s9, s9, s10
  s_lshl_b32 s66, s9, 10
  s_add_u32 s66, s66, s8
  s_add_u32 s66, s66, 15794176
  s_add_u32 s68, s66, 1024
  s_lshl_b32 s10, s4, 5
  s_add_u32 s10, s10, s5
  s_mul_i32 s67, s10, 73728
  s_lshl_b32 s9, s9, 11
  s_add_u32 s67, s67, s9
  s_add_u32 s67, s67, 21102592
  s_and_b32 s69, s3, 3
  s_lshl_b32 s69, s69, 3
  s_add_u32 s69, s69, s4
  s_lshl_b32 s69, s69, 2
  s_mul_i32 s10, s5, 4352
  s_add_u32 s69, s69, s10
  s_add_u32 s69, s69, 9896064
  s_mul_i32 s70, s4, 4352
  s_add_u32 s70, s70, 10035200
  s_branch K6_q
F_cv:
  v_lshlrev_b32 v2, 4, v1
  v_add_u32 v3, 4096, v2
  v_lshlrev_b32 v4, 2, v1
  s_and_b32 s4, s96, 1
  s_lshl_b32 s4, s4, 2
  s_and_b32 s7, s97, 3
  s_add_u32 s4, s4, s7
  s_lshr_b32 s5, s96, 1
  s_lshl_b32 s5, s5, 3
  s_lshr_b32 s7, s97, 2
  s_add_u32 s5, s5, s7
  s_mul_i32 s8, s4, 663552
  s_mul_i32 s71, s3, 3
  s_lshl_b32 s64, s71, 10
  s_add_u32 s64, s64, s8
  s_add_u32 s64, s64, 10485760
  s_add_u32 s65, s64, 24576
  s_and_b32 s9, s3, 3
  s_mul_i32 s9, s9, 9
  s_lshr_b32 s10, s3, 2
  s_lshl_b32 s10, s10, 1
  s_add_u32 s9, s9, s10
  s_lshl_b32 s66, s9, 10
  s_add_u32 s66, s66, s8
  s_add_u32 s66, s66, 15794176
  s_add_u32 s68, s66, 1024
  s_lshl_b32 s10, s4, 5
  s_add_u32 s10, s10, s5
  s_mul_i32 s67, s10, 73728
  s_lshl_b32 s9, s9, 11
  s_add_u32 s67, s67, s9
  s_add_u32 s67, s67, 21102592
  s_and_b32 s69, s3, 3
  s_lshl_b32 s69, s69, 3
  s_add_u32 s69, s69, s4
  s_lshl_b32 s69, s69, 2
  s_mul_i32 s10, s5, 4352
  s_add_u32 s69, s69, s10
  s_add_u32 s69, s69, 9896064
  s_mul_i32 s70, s4, 4352
  s_add_u32 s70, s70, 10035200
  s_lshl_b32 s6, s60, 2
  s_add_u32 s6, s6, s3
  s_mov_b32 s7, s61
  s_setprio 3
  s_mov_b32 s48, s24
  s_mov_b32 s49, s25
  s_mov_b32 s50, 2359296
  s_mov_b32 s51, 0x20000
  s_lshl_b32 s10, s6, 12
  s_add_u32 m0, s7, 17152
  s_mul_i32 s54, s6, 4224
  s_add_u32 s54, s54, 4718592
  s_add_u32 s11, s54, 4
  buffer_load_dwordx4 v2, s[48:51], s10 offen offset:0 nt lds
  buffer_load_dwordx4 v2, s[48:51], s10 offen offset:1024 nt lds
  buffer_load_dwordx4 v2, s[48:51], s10 offen offset:2048 nt lds
  buffer_load_dwordx4 v2, s[48:51], s10 offen offset:3072 nt lds
  s_lshl_b32 s8, s6, 1
  s_and_b32 s8, s8, 0xfffffffc
  s_load_dword s15, s[26:27], s8
  v_lshlrev_b32 v5, 3, v1
  v_add_u32 v5, s7, v5
  v_mov_b32 v18, 0
  v_mov_b32 v19, 0
  ds_write_b64 v5, v[18:19] offset:16640
  v_and_b32 v6, 15, v1
  v_lshrrev_b32 v7, 4, v1
  v_sub_u32 v8, 3, v6
  v_and_b32 v8, 3, v8
  v_mul_u32_u24 v8, 4160, v8
  v_and_b32 v9, 12, v6
  v_lshlrev_b32 v9, 1, v9
  v_sub_u32 v8, v8, v9
  v_lshlrev_b32 v9, 4, v7
  v_sub_u32 v8, v8, v9
  v_add_u32 v8, 520, v8
  v_add_u32 v8, s7, v8
  v_lshlrev_b32 v10, 5, v6
  v_sub_u32 v10, v10, v9
  v_add_u32 v10, 17168, v10
  v_add_u32 v10, s7, v10
  v_add_u32 v11, s7, v2
  v_min_u32 v12, 16, v2
  v_add_u32 v12, s7, v12
  v_add_u32 v12, 4096, v12
  v_lshlrev_b32 v20, 5, v6
  v_lshl_add_u32 v20, v7, 3, v20
  v_sub_u32 v21, 504, v20
  v_add_u32 v21, s7, v21
  v_mov_b32 v224, 0
  v_mov_b32 v225, 0
  v_mov_b32 v226, 0
  v_mov_b32 v227, 0
  v_mov_b32 v228, 0
  v_mov_b32 v229, 0
  v_mov_b32 v230, 0
  v_mov_b32 v231, 0
  v_mov_b32 v232, 0
  v_mov_b32 v233, 0
  v_mov_b32 v234, 0
  v_mov_b32 v235, 0
  v_mov_b32 v236, 0
  v_mov_b32 v237, 0
  v_mov_b32 v238, 0
  v_mov_b32 v239, 0
  v_mov_b32 v240, 0
  v_mov_b32 v241, 0
  v_mov_b32 v242, 0
  v_mov_b32 v243, 0
  v_mov_b32 v244, 0
  v_mov_b32 v245, 0
  v_mov_b32 v246, 0
  v_mov_b32 v247, 0
  v_mov_b32 v248, 0
  v_mov_b32 v249, 0
  v_mov_b32 v250, 0
  v_mov_b32 v251, 0
  v_mov_b32 v252, 0
  v_mov_b32 v253, 0
  v_mov_b32 v254, 0
  v_mov_b32 v255, 0
  s_cmp_lg_u32 s3, 0
  s_cbranch_scc1 F_kw
  s_lshr_b32 s8, s6, 6
  s_mul_i32 s9, s8, 86
  s_lshr_b32 s9, s9, 8
  s_mul_i32 s9, s9, 3968
  s_lshl_b32 s8, s8, 7
  s_add_u32 s8, s8, s9
  s_add_u32 s8, s8, 10070144
  s_mov_b32 s13, 0x40000
CP_30:
  s_load_dword s44, s[42:43], s8 glc
  s_waitcnt lgkmcnt(0)
  s_cmp_ge_u32 s44, 1
  s_cbranch_scc1 CD_31
  s_sleep 2
  s_sub_u32 s13, s13, 1
  s_cbranch_scc0 CP_30
CD_31:
  s_mov_b64 exec, 1
  ds_add_u32 v16, v17 offset:64
  s_mov_b64 exec, -1
F_kw:
LW_32:
  ds_read_b32 v5, v16 offset:64
  s_waitcnt lgkmcnt(0)
  v_readfirstlane_b32 s8, v5
  s_cmp_ge_u32 s8, 1
  s_cbranch_scc1 LD_33
  s_sleep 1
  s_branch LW_32
LD_33:
  s_mov_b32 m0, s7
  s_nop 0
  buffer_load_dwordx4 v2, s[56:59], s54 offen offset:0 sc1 lds
  buffer_load_dwordx4 v2, s[56:59], s54 offen offset:1024 sc1 lds
  buffer_load_dwordx4 v2, s[56:59], s54 offen offset:2048 sc1 lds
  buffer_load_dwordx4 v2, s[56:59], s54 offen offset:3072 sc1 lds
  s_add_u32 m0, s7, 8320
  s_nop 0
  buffer_load_dwordx4 v2, s[56:59], s11 offen offset:0 sc1 lds
  buffer_load_dwordx4 v2, s[56:59], s11 offen offset:1024 sc1 lds
  buffer_load_dwordx4 v2, s[56:59], s11 offen offset:2048 sc1 lds
  buffer_load_dwordx4 v2, s[56:59], s11 offen offset:3072 sc1 lds
  s_mov_b64 exec, 7
  s_add_u32 m0, s7, 4096
  s_nop 0
  buffer_load_dwordx4 v3, s[56:59], s54 offen sc1 lds
  s_add_u32 m0, s7, 12416
  s_nop 0
  buffer_load_dwordx4 v3, s[56:59], s11 offen sc1 lds
  s_mov_b64 exec, -1
  s_waitcnt vmcnt(0) lgkmcnt(0)
  s_mov_b64 exec, 1
  ds_add_u32 v16, v17 offset:68
  s_mov_b64 exec, -1
  s_waitcnt lgkmcnt(0)
  ds_read_b128 v[96:99], v11 offset:0
  ds_read_b128 v[100:103], v11 offset:8320
  ds_read_b64 v[104:105], v11 offset:16
  ds_read_b128 v[108:111], v11 offset:1024
  ds_read_b128 v[112:115], v11 offset:9344
  ds_read_b64 v[116:117], v11 offset:1040
  ds_read_b128 v[120:123], v11 offset:2048
  ds_read_b128 v[124:127], v11 offset:10368
  ds_read_b64 v[128:129], v11 offset:2064
  ds_read_b128 v[132:135], v11 offset:3072
  ds_read_b128 v[136:139], v11 offset:11392
  ds_read_b64 v[140:141], v11 offset:3088
  ds_read_b128 v[144:147], v12 offset:0
  ds_read_b128 v[148:151], v12 offset:8320
  ds_read_b64 v[152:153], v12 offset:16
  s_waitcnt lgkmcnt(12)
  v_alignbit_b32 v160, v100, v96, 16
  v_alignbit_b32 v161, v101, v97, 16
  v_alignbit_b32 v162, v102, v98, 16
  v_alignbit_b32 v163, v103, v99, 16
  v_alignbit_b32 v164, v98, v100, 16
  v_alignbit_b32 v165, v99, v101, 16
  v_alignbit_b32 v166, v104, v102, 16
  v_alignbit_b32 v167, v105, v103, 16
  ds_write_b128 v11, v[160:163] offset:4160
  ds_write_b128 v11, v[164:167] offset:12480
  s_waitcnt lgkmcnt(11)
  v_alignbit_b32 v168, v112, v108, 16
  v_alignbit_b32 v169, v113, v109, 16
  v_alignbit_b32 v170, v114, v110, 16
  v_alignbit_b32 v171, v115, v111, 16
  v_alignbit_b32 v172, v110, v112, 16
  v_alignbit_b32 v173, v111, v113, 16
  v_alignbit_b32 v174, v116, v114, 16
  v_alignbit_b32 v175, v117, v115, 16
  ds_write_b128 v11, v[168:171] offset:5184
  ds_write_b128 v11, v[172:175] offset:13504
  s_waitcnt lgkmcnt(10)
  v_alignbit_b32 v176, v124, v120, 16
  v_alignbit_b32 v177, v125, v121, 16
  v_alignbit_b32 v178, v126, v122, 16
  v_alignbit_b32 v179, v127, v123, 16
  v_alignbit_b32 v180, v122, v124, 16
  v_alignbit_b32 v181, v123, v125, 16
  v_alignbit_b32 v182, v128, v126, 16
  v_alignbit_b32 v183, v129, v127, 16
  ds_write_b128 v11, v[176:179] offset:6208
  ds_write_b128 v11, v[180:183] offset:14528
  s_waitcnt lgkmcnt(9)
  v_alignbit_b32 v184, v136, v132, 16
  v_alignbit_b32 v185, v137, v133, 16
  v_alignbit_b32 v186, v138, v134, 16
  v_alignbit_b32 v187, v139, v135, 16
  v_alignbit_b32 v188, v134, v136, 16
  v_alignbit_b32 v189, v135, v137, 16
  v_alignbit_b32 v190, v140, v138, 16
  v_alignbit_b32 v191, v141, v139, 16
  ds_write_b128 v11, v[184:187] offset:7232
  ds_write_b128 v11, v[188:191] offset:15552
  s_waitcnt lgkmcnt(8)
  v_alignbit_b32 v192, v148, v144, 16
  v_alignbit_b32 v193, v149, v145, 16
  v_alignbit_b32 v194, v150, v146, 16
  v_alignbit_b32 v195, v151, v147, 16
  v_alignbit_b32 v196, v146, v148, 16
  v_alignbit_b32 v197, v147, v149, 16
  v_alignbit_b32 v198, v152, v150, 16
  v_alignbit_b32 v199, v153, v151, 16
  ds_write_b128 v12, v[192:195] offset:4160
  ds_write_b128 v12, v[196:199] offset:12480
  ds_read_b128 v[160:163], v10 offset:0
  ds_read_b64 v[96:97], v8 offset:3584
  ds_read_b64 v[98:99], v8 offset:3592
  ds_read_b128 v[164:167], v10 offset:512
  ds_read_b64 v[100:101], v8 offset:3072
  ds_read_b64 v[102:103], v8 offset:3080
  ds_read_b128 v[168:171], v10 offset:1024
  ds_read_b64 v[104:105], v8 offset:2560
  ds_read_b64 v[106:107], v8 offset:2568
  ds_read_b128 v[172:175], v10 offset:1536
  ds_read_b64 v[108:109], v8 offset:2048
  ds_read_b64 v[110:111], v8 offset:2056
  ds_read_b128 v[176:179], v10 offset:2048
  ds_read_b64 v[112:113], v8 offset:1536
  ds_read_b64 v[114:115], v8 offset:1544
  ds_read_b128 v[180:183], v10 offset:2560
  ds_read_b64 v[116:117], v8 offset:1024
  ds_read_b64 v[118:119], v8 offset:1032
  ds_read_b128 v[184:187], v10 offset:3072
  ds_read_b64 v[120:121], v8 offset:512
  ds_read_b64 v[122:123], v8 offset:520
  ds_read_b128 v[188:191], v10 offset:3584
  ds_read_b64 v[124:125], v8 offset:0
  ds_read_b64 v[126:127], v8 offset:8
  v_subrev_u32 v8, 64, v8
  v_subrev_u32 v10, 64, v10
  s_waitcnt lgkmcnt(0)
  v_mfma_f32_16x16x32_bf16 v[224:227], v[96:99], v[160:163], v[224:227]
  ds_read_b128 v[192:195], v10 offset:0
  v_mfma_f32_16x16x32_bf16 v[228:231], v[96:99], v[164:167], v[228:231]
  ds_read_b64 v[128:129], v8 offset:3584
  v_mfma_f32_16x16x32_bf16 v[228:231], v[100:103], v[160:163], v[228:231]
  ds_read_b64 v[130:131], v8 offset:3592
  v_mfma_f32_16x16x32_bf16 v[232:235], v[100:103], v[164:167], v[232:235]
  ds_read_b128 v[196:199], v10 offset:512
  v_mfma_f32_16x16x32_bf16 v[232:235], v[96:99], v[168:171], v[232:235]
  ds_read_b64 v[132:133], v8 offset:3072
  v_mfma_f32_16x16x32_bf16 v[236:239], v[100:103], v[168:171], v[236:239]
  ds_read_b64 v[134:135], v8 offset:3080
  v_mfma_f32_16x16x32_bf16 v[232:235], v[104:107], v[160:163], v[232:235]
  ds_read_b128 v[200:203], v10 offset:1024
  v_mfma_f32_16x16x32_bf16 v[236:239], v[104:107], v[164:167], v[236:239]
  ds_read_b64 v[136:137], v8 offset:2560
  v_mfma_f32_16x16x32_bf16 v[240:243], v[104:107], v[168:171], v[240:243]
  ds_read_b64 v[138:139], v8 offset:2568
  v_mfma_f32_16x16x32_bf16 v[236:239], v[96:99], v[172:175], v[236:239]
  ds_read_b128 v[204:207], v10 offset:1536
  v_mfma_f32_16x16x32_bf16 v[240:243], v[100:103], v[172:175], v[240:243]
  ds_read_b64 v[140:141], v8 offset:2048
  v_mfma_f32_16x16x32_bf16 v[244:247], v[104:107], v[172:175], v[244:247]
  ds_read_b64 v[142:143], v8 offset:2056
  v_mfma_f32_16x16x32_bf16 v[236:239], v[108:111], v[160:163], v[236:239]
  ds_read_b128 v[208:211], v10 offset:2048
  v_mfma_f32_16x16x32_bf16 v[240:243], v[108:111], v[164:167], v[240:243]
  ds_read_b64 v[144:145], v8 offset:1536
  v_mfma_f32_16x16x32_bf16 v[244:247], v[108:111], v[168:171], v[244:247]
  ds_read_b64 v[146:147], v8 offset:1544
  v_mfma_f32_16x16x32_bf16 v[248:251], v[108:111], v[172:175], v[248:251]
  ds_read_b128 v[212:215], v10 offset:2560
  v_mfma_f32_16x16x32_bf16 v[240:243], v[96:99], v[176:179], v[240:243]
  ds_read_b64 v[148:149], v8 offset:1024
  v_mfma_f32_16x16x32_bf16 v[244:247], v[100:103], v[176:179], v[244:247]
  ds_read_b64 v[150:151], v8 offset:1032
  v_mfma_f32_16x16x32_bf16 v[248:251], v[104:107], v[176:179], v[248:251]
  ds_read_b128 v[216:219], v10 offset:3072
  v_mfma_f32_16x16x32_bf16 v[252:255], v[108:111], v[176:179], v[252:255]
  ds_read_b64 v[152:153], v8 offset:512
  v_mfma_f32_16x16x32_bf16 v[240:243], v[112:115], v[160:163], v[240:243]
  ds_read_b64 v[154:155], v8 offset:520
  v_mfma_f32_16x16x32_bf16 v[244:247], v[112:115], v[164:167], v[244:247]
  ds_read_b128 v[220:223], v10 offset:3584
  v_mfma_f32_16x16x32_bf16 v[248:251], v[112:115], v[168:171], v[248:251]
  ds_read_b64 v[156:157], v8 offset:0
  v_mfma_f32_16x16x32_bf16 v[252:255], v[112:115], v[172:175], v[252:255]
  ds_read_b64 v[158:159], v8 offset:8
  v_mfma_f32_16x16x32_bf16 v[244:247], v[96:99], v[180:183], v[244:247]
  v_mfma_f32_16x16x32_bf16 v[248:251], v[100:103], v[180:183], v[248:251]
  v_mfma_f32_16x16x32_bf16 v[252:255], v[104:107], v[180:183], v[252:255]
  v_mfma_f32_16x16x32_bf16 v[244:247], v[116:119], v[160:163], v[244:247]
  v_mfma_f32_16x16x32_bf16 v[248:251], v[116:119], v[164:167], v[248:251]
  v_mfma_f32_16x16x32_bf16 v[252:255], v[116:119], v[168:171], v[252:255]
  v_mfma_f32_16x16x32_bf16 v[248:251], v[96:99], v[184:187], v[248:251]
  v_mfma_f32_16x16x32_bf16 v[252:255], v[100:103], v[184:187], v[252:255]
  v_mfma_f32_16x16x32_bf16 v[248:251], v[120:123], v[160:163], v[248:251]
  v_mfma_f32_16x16x32_bf16 v[252:255], v[120:123], v[164:167], v[252:255]
  v_mfma_f32_16x16x32_bf16 v[252:255], v[96:99], v[188:191], v[252:255]
  v_mfma_f32_16x16x32_bf16 v[252:255], v[124:127], v[160:163], v[252:255]
  v_subrev_u32 v8, 64, v8
  v_subrev_u32 v10, 64, v10
  s_waitcnt lgkmcnt(0)
  v_mfma_f32_16x16x32_bf16 v[224:227], v[128:131], v[192:195], v[224:227]
  ds_read_b128 v[160:163], v10 offset:0
  v_mfma_f32_16x16x32_bf16 v[228:231], v[128:131], v[196:199], v[228:231]
  ds_read_b64 v[96:97], v8 offset:3584
  v_mfma_f32_16x16x32_bf16 v[228:231], v[132:135], v[192:195], v[228:231]
  ds_read_b64 v[98:99], v8 offset:3592
  v_mfma_f32_16x16x32_bf16 v[232:235], v[132:135], v[196:199], v[232:235]
  ds_read_b128 v[164:167], v10 offset:512
  v_mfma_f32_16x16x32_bf16 v[232:235], v[128:131], v[200:203], v[232:235]
  ds_read_b64 v[100:101], v8 offset:3072
  v_mfma_f32_16x16x32_bf16 v[236:239], v[132:135], v[200:203], v[236:239]
  ds_read_b64 v[102:103], v8 offset:3080
  v_mfma_f32_16x16x32_bf16 v[232:235], v[136:139], v[192:195], v[232:235]
  ds_read_b128 v[168:171], v10 offset:1024
  v_mfma_f32_16x16x32_bf16 v[236:239], v[136:139], v[196:199], v[236:239]
  ds_read_b64 v[104:105], v8 offset:2560
  v_mfma_f32_16x16x32_bf16 v[240:243], v[136:139], v[200:203], v[240:243]
  ds_read_b64 v[106:107], v8 offset:2568
  v_mfma_f32_16x16x32_bf16 v[236:239], v[128:131], v[204:207], v[236:239]
  ds_read_b128 v[172:175], v10 offset:1536
  v_mfma_f32_16x16x32_bf16 v[240:243], v[132:135], v[204:207], v[240:243]
  ds_read_b64 v[108:109], v8 offset:2048
  v_mfma_f32_16x16x32_bf16 v[244:247], v[136:139], v[204:207], v[244:247]
  ds_read_b64 v[110:111], v8 offset:2056
  v_mfma_f32_16x16x32_bf16 v[236:239], v[140:143], v[192:195], v[236:239]
  ds_read_b128 v[176:179], v10 offset:2048
  v_mfma_f32_16x16x32_bf16 v[240:243], v[140:143], v[196:199], v[240:243]
  ds_read_b64 v[112:113], v8 offset:1536
  v_mfma_f32_16x16x32_bf16 v[244:247], v[140:143], v[200:203], v[244:247]
  ds_read_b64 v[114:115], v8 offset:1544
  v_mfma_f32_16x16x32_bf16 v[248:251], v[140:143], v[204:207], v[248:251]
  ds_read_b128 v[180:183], v10 offset:2560
  v_mfma_f32_16x16x32_bf16 v[240:243], v[128:131], v[208:211], v[240:243]
  ds_read_b64 v[116:117], v8 offset:1024
  v_mfma_f32_16x16x32_bf16 v[244:247], v[132:135], v[208:211], v[244:247]
  ds_read_b64 v[118:119], v8 offset:1032
  v_mfma_f32_16x16x32_bf16 v[248:251], v[136:139], v[208:211], v[248:251]
  ds_read_b128 v[184:187], v10 offset:3072
  v_mfma_f32_16x16x32_bf16 v[252:255], v[140:143], v[208:211], v[252:255]
  ds_read_b64 v[120:121], v8 offset:512
  v_mfma_f32_16x16x32_bf16 v[240:243], v[144:147], v[192:195], v[240:243]
  ds_read_b64 v[122:123], v8 offset:520
  v_mfma_f32_16x16x32_bf16 v[244:247], v[144:147], v[196:199], v[244:247]
  ds_read_b128 v[188:191], v10 offset:3584
  v_mfma_f32_16x16x32_bf16 v[248:251], v[144:147], v[200:203], v[248:251]
  ds_read_b64 v[124:125], v8 offset:0
  v_mfma_f32_16x16x32_bf16 v[252:255], v[144:147], v[204:207], v[252:255]
  ds_read_b64 v[126:127], v8 offset:8
  v_mfma_f32_16x16x32_bf16 v[244:247], v[128:131], v[212:215], v[244:247]
  v_mfma_f32_16x16x32_bf16 v[248:251], v[132:135], v[212:215], v[248:251]
  v_mfma_f32_16x16x32_bf16 v[252:255], v[136:139], v[212:215], v[252:255]
  v_mfma_f32_16x16x32_bf16 v[244:247], v[148:151], v[192:195], v[244:247]
  v_mfma_f32_16x16x32_bf16 v[248:251], v[148:151], v[196:199], v[248:251]
  v_mfma_f32_16x16x32_bf16 v[252:255], v[148:151], v[200:203], v[252:255]
  v_mfma_f32_16x16x32_bf16 v[248:251], v[128:131], v[216:219], v[248:251]
  v_mfma_f32_16x16x32_bf16 v[252:255], v[132:135], v[216:219], v[252:255]
  v_mfma_f32_16x16x32_bf16 v[248:251], v[152:155], v[192:195], v[248:251]
  v_mfma_f32_16x16x32_bf16 v[252:255], v[152:155], v[196:199], v[252:255]
  v_mfma_f32_16x16x32_bf16 v[252:255], v[128:131], v[220:223], v[252:255]
  v_mfma_f32_16x16x32_bf16 v[252:255], v[156:159], v[192:195], v[252:255]
  s_add_u32 s55, s70, 128
  s_load_dword s53, s[42:43], s55
  v_subrev_u32 v8, 64, v8
  v_subrev_u32 v10, 64, v10
  s_waitcnt lgkmcnt(0)
  v_mfma_f32_16x16x32_bf16 v[224:227], v[96:99], v[160:163], v[224:227]
  ds_read_b128 v[192:195], v10 offset:0
  v_mfma_f32_16x16x32_bf16 v[228:231], v[96:99], v[164:167], v[228:231]
  ds_read_b64 v[128:129], v8 offset:3584
  v_mfma_f32_16x16x32_bf16 v[228:231], v[100:103], v[160:163], v[228:231]
  ds_read_b64 v[130:131], v8 offset:3592
  v_mfma_f32_16x16x32_bf16 v[232:235], v[100:103], v[164:167], v[232:235]
  ds_read_b128 v[196:199], v10 offset:512
  v_mfma_f32_16x16x32_bf16 v[232:235], v[96:99], v[168:171], v[232:235]
  ds_read_b64 v[132:133], v8 offset:3072
  v_mfma_f32_16x16x32_bf16 v[236:239], v[100:103], v[168:171], v[236:239]
  ds_read_b64 v[134:135], v8 offset:3080
  v_mfma_f32_16x16x32_bf16 v[232:235], v[104:107], v[160:163], v[232:235]
  ds_read_b128 v[200:203], v10 offset:1024
  v_mfma_f32_16x16x32_bf16 v[236:239], v[104:107], v[164:167], v[236:239]
  ds_read_b64 v[136:137], v8 offset:2560
  v_mfma_f32_16x16x32_bf16 v[240:243], v[104:107], v[168:171], v[240:243]
  ds_read_b64 v[138:139], v8 offset:2568
  v_mfma_f32_16x16x32_bf16 v[236:239], v[96:99], v[172:175], v[236:239]
  ds_read_b128 v[204:207], v10 offset:1536
  v_mfma_f32_16x16x32_bf16 v[240:243], v[100:103], v[172:175], v[240:243]
  ds_read_b64 v[140:141], v8 offset:2048
  v_mfma_f32_16x16x32_bf16 v[244:247], v[104:107], v[172:175], v[244:247]
  ds_read_b64 v[142:143], v8 offset:2056
  v_mfma_f32_16x16x32_bf16 v[236:239], v[108:111], v[160:163], v[236:239]
  ds_read_b128 v[208:211], v10 offset:2048
  v_mfma_f32_16x16x32_bf16 v[240:243], v[108:111], v[164:167], v[240:243]
  ds_read_b64 v[144:145], v8 offset:1536
  v_mfma_f32_16x16x32_bf16 v[244:247], v[108:111], v[168:171], v[244:247]
  ds_read_b64 v[146:147], v8 offset:1544
  v_mfma_f32_16x16x32_bf16 v[248:251], v[108:111], v[172:175], v[248:251]
  ds_read_b128 v[212:215], v10 offset:2560
  v_mfma_f32_16x16x32_bf16 v[240:243], v[96:99], v[176:179], v[240:243]
  ds_read_b64 v[148:149], v8 offset:1024
  v_mfma_f32_16x16x32_bf16 v[244:247], v[100:103], v[176:179], v[244:247]
  ds_read_b64 v[150:151], v8 offset:1032
  v_mfma_f32_16x16x32_bf16 v[248:251], v[104:107], v[176:179], v[248:251]
  ds_read_b128 v[216:219], v10 offset:3072
  v_mfma_f32_16x16x32_bf16 v[252:255], v[108:111], v[176:179], v[252:255]
  ds_read_b64 v[152:153], v8 offset:512
  v_mfma_f32_16x16x32_bf16 v[240:243], v[112:115], v[160:163], v[240:243]
  ds_read_b64 v[154:155], v8 offset:520
  v_mfma_f32_16x16x32_bf16 v[244:247], v[112:115], v[164:167], v[244:247]
  ds_read_b128 v[220:223], v10 offset:3584
  v_mfma_f32_16x16x32_bf16 v[248:251], v[112:115], v[168:171], v[248:251]
  ds_read_b64 v[156:157], v8 offset:0
  v_mfma_f32_16x16x32_bf16 v[252:255], v[112:115], v[172:175], v[252:255]
  ds_read_b64 v[158:159], v8 offset:8
  v_mfma_f32_16x16x32_bf16 v[244:247], v[96:99], v[180:183], v[244:247]
  v_mfma_f32_16x16x32_bf16 v[248:251], v[100:103], v[180:183], v[248:251]
  v_mfma_f32_16x16x32_bf16 v[252:255], v[104:107], v[180:183], v[252:255]
  v_mfma_f32_16x16x32_bf16 v[244:247], v[116:119], v[160:163], v[244:247]
  v_mfma_f32_16x16x32_bf16 v[248:251], v[116:119], v[164:167], v[248:251]
  v_mfma_f32_16x16x32_bf16 v[252:255], v[116:119], v[168:171], v[252:255]
  v_mfma_f32_16x16x32_bf16 v[248:251], v[96:99], v[184:187], v[248:251]
  v_mfma_f32_16x16x32_bf16 v[252:255], v[100:103], v[184:187], v[252:255]
  v_mfma_f32_16x16x32_bf16 v[248:251], v[120:123], v[160:163], v[248:251]
  v_mfma_f32_16x16x32_bf16 v[252:255], v[120:123], v[164:167], v[252:255]
  v_mfma_f32_16x16x32_bf16 v[252:255], v[96:99], v[188:191], v[252:255]
  v_mfma_f32_16x16x32_bf16 v[252:255], v[124:127], v[160:163], v[252:255]
  v_subrev_u32 v8, 64, v8
  v_subrev_u32 v10, 64, v10
  s_waitcnt lgkmcnt(0)
  v_mfma_f32_16x16x32_bf16 v[224:227], v[128:131], v[192:195], v[224:227]
  ds_read_b128 v[160:163], v10 offset:0
  v_mfma_f32_16x16x32_bf16 v[228:231], v[128:131], v[196:199], v[228:231]
  ds_read_b64 v[96:97], v8 offset:3584
  v_mfma_f32_16x16x32_bf16 v[228:231], v[132:135], v[192:195], v[228:231]
  ds_read_b64 v[98:99], v8 offset:3592
  v_mfma_f32_16x16x32_bf16 v[232:235], v[132:135], v[196:199], v[232:235]
  ds_read_b128 v[164:167], v10 offset:512
  v_mfma_f32_16x16x32_bf16 v[232:235], v[128:131], v[200:203], v[232:235]
  ds_read_b64 v[100:101], v8 offset:3072
  v_mfma_f32_16x16x32_bf16 v[236:239], v[132:135], v[200:203], v[236:239]
  ds_read_b64 v[102:103], v8 offset:3080
  v_mfma_f32_16x16x32_bf16 v[232:235], v[136:139], v[192:195], v[232:235]
  ds_read_b128 v[168:171], v10 offset:1024
  v_mfma_f32_16x16x32_bf16 v[236:239], v[136:139], v[196:199], v[236:239]
  ds_read_b64 v[104:105], v8 offset:2560
  v_mfma_f32_16x16x32_bf16 v[240:243], v[136:139], v[200:203], v[240:243]
  ds_read_b64 v[106:107], v8 offset:2568
  v_mfma_f32_16x16x32_bf16 v[236:239], v[128:131], v[204:207], v[236:239]
  ds_read_b128 v[172:175], v10 offset:1536
  v_mfma_f32_16x16x32_bf16 v[240:243], v[132:135], v[204:207], v[240:243]
  ds_read_b64 v[108:109], v8 offset:2048
  v_mfma_f32_16x16x32_bf16 v[244:247], v[136:139], v[204:207], v[244:247]
  ds_read_b64 v[110:111], v8 offset:2056
  v_mfma_f32_16x16x32_bf16 v[236:239], v[140:143], v[192:195], v[236:239]
  ds_read_b128 v[176:179], v10 offset:2048
  v_mfma_f32_16x16x32_bf16 v[240:243], v[140:143], v[196:199], v[240:243]
  ds_read_b64 v[112:113], v8 offset:1536
  v_mfma_f32_16x16x32_bf16 v[244:247], v[140:143], v[200:203], v[244:247]
  ds_read_b64 v[114:115], v8 offset:1544
  v_mfma_f32_16x16x32_bf16 v[248:251], v[140:143], v[204:207], v[248:251]
  ds_read_b128 v[180:183], v10 offset:2560
  v_mfma_f32_16x16x32_bf16 v[240:243], v[128:131], v[208:211], v[240:243]
  ds_read_b64 v[116:117], v8 offset:1024
  v_mfma_f32_16x16x32_bf16 v[244:247], v[132:135], v[208:211], v[244:247]
  ds_read_b64 v[118:119], v8 offset:1032
  v_mfma_f32_16x16x32_bf16 v[248:251], v[136:139], v[208:211], v[248:251]
  ds_read_b128 v[184:187], v10 offset:3072
  v_mfma_f32_16x16x32_bf16 v[252:255], v[140:143], v[208:211], v[252:255]
  ds_read_b64 v[120:121], v8 offset:512
  v_mfma_f32_16x16x32_bf16 v[240:243], v[144:147], v[192:195], v[240:243]
  ds_read_b64 v[122:123], v8 offset:520
  v_mfma_f32_16x16x32_bf16 v[244:247], v[144:147], v[196:199], v[244:247]
  ds_read_b128 v[188:191], v10 offset:3584
  v_mfma_f32_16x16x32_bf16 v[248:251], v[144:147], v[200:203], v[248:251]
  ds_read_b64 v[124:125], v8 offset:0
  v_mfma_f32_16x16x32_bf16 v[252:255], v[144:147], v[204:207], v[252:255]
  ds_read_b64 v[126:127], v8 offset:8
  v_mfma_f32_16x16x32_bf16 v[244:247], v[128:131], v[212:215], v[244:247]
  v_mfma_f32_16x16x32_bf16 v[248:251], v[132:135], v[212:215], v[248:251]
  v_mfma_f32_16x16x32_bf16 v[252:255], v[136:139], v[212:215], v[252:255]
  v_mfma_f32_16x16x32_bf16 v[244:247], v[148:151], v[192:195], v[244:247]
  v_mfma_f32_16x16x32_bf16 v[248:251], v[148:151], v[196:199], v[248:251]
  v_mfma_f32_16x16x32_bf16 v[252:255], v[148:151], v[200:203], v[252:255]
  v_mfma_f32_16x16x32_bf16 v[248:251], v[128:131], v[216:219], v[248:251]
  v_mfma_f32_16x16x32_bf16 v[252:255], v[132:135], v[216:219], v[252:255]
  v_mfma_f32_16x16x32_bf16 v[248:251], v[152:155], v[192:195], v[248:251]
  v_mfma_f32_16x16x32_bf16 v[252:255], v[152:155], v[196:199], v[252:255]
  v_mfma_f32_16x16x32_bf16 v[252:255], v[128:131], v[220:223], v[252:255]
  v_mfma_f32_16x16x32_bf16 v[252:255], v[156:159], v[192:195], v[252:255]
  s_mov_b64 exec, 1
  ds_add_u32 v16, v17 offset:72
  s_mov_b64 exec, -1
  s_cmp_lg_u32 s53, 0
  s_cbranch_scc1 F_w3
  s_mov_b32 s13, 0x40000
CP_34:
  s_load_dword s44, s[42:43], s55 glc
  s_waitcnt lgkmcnt(0)
  s_cmp_ge_u32 s44, 1
  s_cbranch_scc1 CD_35
  s_sleep 8
  s_sub_u32 s13, s13, 1
  s_cbranch_scc0 CP_34
CD_35:
F_w3:
  v_subrev_u32 v8, 64, v8
  v_subrev_u32 v10, 64, v10
  s_waitcnt lgkmcnt(0)
  v_mfma_f32_16x16x32_bf16 v[224:227], v[96:99], v[160:163], v[224:227]
  ds_read_b128 v[192:195], v10 offset:0
  v_mfma_f32_16x16x32_bf16 v[228:231], v[96:99], v[164:167], v[228:231]
  ds_read_b64 v[128:129], v8 offset:3584
  v_mfma_f32_16x16x32_bf16 v[228:231], v[100:103], v[160:163], v[228:231]
  ds_read_b64 v[130:131], v8 offset:3592
  v_mfma_f32_16x16x32_bf16 v[232:235], v[100:103], v[164:167], v[232:235]
  ds_read_b128 v[196:199], v10 offset:512
  v_mfma_f32_16x16x32_bf16 v[232:235], v[96:99], v[168:171], v[232:235]
  ds_read_b64 v[132:133], v8 offset:3072
  v_mfma_f32_16x16x32_bf16 v[236:239], v[100:103], v[168:171], v[236:239]
  ds_read_b64 v[134:135], v8 offset:3080
  v_mfma_f32_16x16x32_bf16 v[232:235], v[104:107], v[160:163], v[232:235]
  ds_read_b128 v[200:203], v10 offset:1024
  v_mfma_f32_16x16x32_bf16 v[236:239], v[104:107], v[164:167], v[236:239]
  ds_read_b64 v[136:137], v8 offset:2560
  v_mfma_f32_16x16x32_bf16 v[240:243], v[104:107], v[168:171], v[240:243]
  ds_read_b64 v[138:139], v8 offset:2568
  v_mfma_f32_16x16x32_bf16 v[236:239], v[96:99], v[172:175], v[236:239]
  ds_read_b128 v[204:207], v10 offset:1536
  v_mfma_f32_16x16x32_bf16 v[240:243], v[100:103], v[172:175], v[240:243]
  ds_read_b64 v[140:141], v8 offset:2048
  v_mfma_f32_16x16x32_bf16 v[244:247], v[104:107], v[172:175], v[244:247]
  ds_read_b64 v[142:143], v8 offset:2056
  v_mfma_f32_16x16x32_bf16 v[236:239], v[108:111], v[160:163], v[236:239]
  ds_read_b128 v[208:211], v10 offset:2048
  v_mfma_f32_16x16x32_bf16 v[240:243], v[108:111], v[164:167], v[240:243]
  ds_read_b64 v[144:145], v8 offset:1536
  v_mfma_f32_16x16x32_bf16 v[244:247], v[108:111], v[168:171], v[244:247]
  ds_read_b64 v[146:147], v8 offset:1544
  v_mfma_f32_16x16x32_bf16 v[248:251], v[108:111], v[172:175], v[248:251]
  ds_read_b128 v[212:215], v10 offset:2560
  v_mfma_f32_16x16x32_bf16 v[240:243], v[96:99], v[176:179], v[240:243]
  ds_read_b64 v[148:149], v8 offset:1024
  v_mfma_f32_16x16x32_bf16 v[244:247], v[100:103], v[176:179], v[244:247]
  ds_read_b64 v[150:151], v8 offset:1032
  v_mfma_f32_16x16x32_bf16 v[248:251], v[104:107], v[176:179], v[248:251]
  ds_read_b128 v[216:219], v10 offset:3072
  v_mfma_f32_16x16x32_bf16 v[252:255], v[108:111], v[176:179], v[252:255]
  ds_read_b64 v[152:153], v8 offset:512
  v_mfma_f32_16x16x32_bf16 v[240:243], v[112:115], v[160:163], v[240:243]
  ds_read_b64 v[154:155], v8 offset:520
  v_mfma_f32_16x16x32_bf16 v[244:247], v[112:115], v[164:167], v[244:247]
  ds_read_b128 v[220:223], v10 offset:3584
  v_mfma_f32_16x16x32_bf16 v[248:251], v[112:115], v[168:171], v[248:251]
  ds_read_b64 v[156:157], v8 offset:0
  v_mfma_f32_16x16x32_bf16 v[252:255], v[112:115], v[172:175], v[252:255]
  ds_read_b64 v[158:159], v8 offset:8
  v_mfma_f32_16x16x32_bf16 v[244:247], v[96:99], v[180:183], v[244:247]
  buffer_load_dwordx4 v[32:35], v2, s[56:59], s64 offen offset:0 sc1
  v_mfma_f32_16x16x32_bf16 v[248:251], v[100:103], v[180:183], v[248:251]
  v_mfma_f32_16x16x32_bf16 v[252:255], v[104:107], v[180:183], v[252:255]
  v_mfma_f32_16x16x32_bf16 v[244:247], v[116:119], v[160:163], v[244:247]
  buffer_load_dwordx4 v[36:39], v2, s[56:59], s64 offen offset:1024 sc1
  v_mfma_f32_16x16x32_bf16 v[248:251], v[116:119], v[164:167], v[248:251]
  v_mfma_f32_16x16x32_bf16 v[252:255], v[116:119], v[168:171], v[252:255]
  v_mfma_f32_16x16x32_bf16 v[248:251], v[96:99], v[184:187], v[248:251]
  buffer_load_dwordx4 v[40:43], v2, s[56:59], s64 offen offset:2048 sc1
  v_mfma_f32_16x16x32_bf16 v[252:255], v[100:103], v[184:187], v[252:255]
  v_mfma_f32_16x16x32_bf16 v[248:251], v[120:123], v[160:163], v[248:251]
  v_mfma_f32_16x16x32_bf16 v[252:255], v[120:123], v[164:167], v[252:255]
  s_add_u32 s64, s64, 36864
  buffer_load_dwordx4 v[44:47], v2, s[56:59], s64 offen offset:0 sc1
  v_mfma_f32_16x16x32_bf16 v[252:255], v[96:99], v[188:191], v[252:255]
  v_mfma_f32_16x16x32_bf16 v[252:255], v[124:127], v[160:163], v[252:255]
  v_subrev_u32 v8, 64, v8
  v_subrev_u32 v10, 64, v10
  s_waitcnt lgkmcnt(0)
  v_mfma_f32_16x16x32_bf16 v[224:227], v[128:131], v[192:195], v[224:227]
  ds_read_b128 v[160:163], v10 offset:0
  v_mfma_f32_16x16x32_bf16 v[228:231], v[128:131], v[196:199], v[228:231]
  ds_read_b64 v[96:97], v8 offset:3584
  v_mfma_f32_16x16x32_bf16 v[228:231], v[132:135], v[192:195], v[228:231]
  ds_read_b64 v[98:99], v8 offset:3592
  v_mfma_f32_16x16x32_bf16 v[232:235], v[132:135], v[196:199], v[232:235]
  ds_read_b128 v[164:167], v10 offset:512
  v_mfma_f32_16x16x32_bf16 v[232:235], v[128:131], v[200:203], v[232:235]
  ds_read_b64 v[100:101], v8 offset:3072
  v_mfma_f32_16x16x32_bf16 v[236:239], v[132:135], v[200:203], v[236:239]
  ds_read_b64 v[102:103], v8 offset:3080
  v_mfma_f32_16x16x32_bf16 v[232:235], v[136:139], v[192:195], v[232:235]
  ds_read_b128 v[168:171], v10 offset:1024
  v_mfma_f32_16x16x32_bf16 v[236:239], v[136:139], v[196:199], v[236:239]
  ds_read_b64 v[104:105], v8 offset:2560
  v_mfma_f32_16x16x32_bf16 v[240:243], v[136:139], v[200:203], v[240:243]
  ds_read_b64 v[106:107], v8 offset:2568
  v_mfma_f32_16x16x32_bf16 v[236:239], v[128:131], v[204:207], v[236:239]
  ds_read_b128 v[172:175], v10 offset:1536
  v_mfma_f32_16x16x32_bf16 v[240:243], v[132:135], v[204:207], v[240:243]
  ds_read_b64 v[108:109], v8 offset:2048
  v_mfma_f32_16x16x32_bf16 v[244:247], v[136:139], v[204:207], v[244:247]
  ds_read_b64 v[110:111], v8 offset:2056
  v_mfma_f32_16x16x32_bf16 v[236:239], v[140:143], v[192:195], v[236:239]
  ds_read_b128 v[176:179], v10 offset:2048
  v_mfma_f32_16x16x32_bf16 v[240:243], v[140:143], v[196:199], v[240:243]
  ds_read_b64 v[112:113], v8 offset:1536
  v_mfma_f32_16x16x32_bf16 v[244:247], v[140:143], v[200:203], v[244:247]
  ds_read_b64 v[114:115], v8 offset:1544
  v_mfma_f32_16x16x32_bf16 v[248:251], v[140:143], v[204:207], v[248:251]
  ds_read_b128 v[180:183], v10 offset:2560
  v_mfma_f32_16x16x32_bf16 v[240:243], v[128:131], v[208:211], v[240:243]
  ds_read_b64 v[116:117], v8 offset:1024
  v_mfma_f32_16x16x32_bf16 v[244:247], v[132:135], v[208:211], v[244:247]
  ds_read_b64 v[118:119], v8 offset:1032
  v_mfma_f32_16x16x32_bf16 v[248:251], v[136:139], v[208:211], v[248:251]
  ds_read_b128 v[184:187], v10 offset:3072
  v_mfma_f32_16x16x32_bf16 v[252:255], v[140:143], v[208:211], v[252:255]
  ds_read_b64 v[120:121], v8 offset:512
  v_mfma_f32_16x16x32_bf16 v[240:243], v[144:147], v[192:195], v[240:243]
  ds_read_b64 v[122:123], v8 offset:520
  v_mfma_f32_16x16x32_bf16 v[244:247], v[144:147], v[196:199], v[244:247]
  ds_read_b128 v[188:191], v10 offset:3584
  v_mfma_f32_16x16x32_bf16 v[248:251], v[144:147], v[200:203], v[248:251]
  ds_read_b64 v[124:125], v8 offset:0
  v_mfma_f32_16x16x32_bf16 v[252:255], v[144:147], v[204:207], v[252:255]
  ds_read_b64 v[126:127], v8 offset:8
  v_mfma_f32_16x16x32_bf16 v[244:247], v[128:131], v[212:215], v[244:247]
  buffer_load_dwordx4 v[48:51], v2, s[56:59], s64 offen offset:1024 sc1
  v_mfma_f32_16x16x32_bf16 v[248:251], v[132:135], v[212:215], v[248:251]
  v_mfma_f32_16x16x32_bf16 v[252:255], v[136:139], v[212:215], v[252:255]
  v_mfma_f32_16x16x32_bf16 v[244:247], v[148:151], v[192:195], v[244:247]
  buffer_load_dwordx4 v[52:55], v2, s[56:59], s64 offen offset:2048 sc1
  v_mfma_f32_16x16x32_bf16 v[248:251], v[148:151], v[196:199], v[248:251]
  v_mfma_f32_16x16x32_bf16 v[252:255], v[148:151], v[200:203], v[252:255]
  v_mfma_f32_16x16x32_bf16 v[248:251], v[128:131], v[216:219], v[248:251]
  s_add_u32 s64, s64, 36864
  buffer_load_dwordx4 v[56:59], v2, s[56:59], s64 offen offset:0 sc1
  v_mfma_f32_16x16x32_bf16 v[252:255], v[132:135], v[216:219], v[252:255]
  v_mfma_f32_16x16x32_bf16 v[248:251], v[152:155], v[192:195], v[248:251]
  v_mfma_f32_16x16x32_bf16 v[252:255], v[152:155], v[196:199], v[252:255]
  buffer_load_dwordx4 v[60:63], v2, s[56:59], s64 offen offset:1024 sc1
  v_mfma_f32_16x16x32_bf16 v[252:255], v[128:131], v[220:223], v[252:255]
  v_mfma_f32_16x16x32_bf16 v[252:255], v[156:159], v[192:195], v[252:255]
  v_subrev_u32 v8, 64, v8
  v_subrev_u32 v10, 64, v10
  s_waitcnt lgkmcnt(0)
  v_mfma_f32_16x16x32_bf16 v[224:227], v[96:99], v[160:163], v[224:227]
  ds_read_b128 v[192:195], v10 offset:0
  v_mfma_f32_16x16x32_bf16 v[228:231], v[96:99], v[164:167], v[228:231]
  ds_read_b64 v[128:129], v8 offset:3584
  v_mfma_f32_16x16x32_bf16 v[228:231], v[100:103], v[160:163], v[228:231]
  ds_read_b64 v[130:131], v8 offset:3592
  v_mfma_f32_16x16x32_bf16 v[232:235], v[100:103], v[164:167], v[232:235]
  ds_read_b128 v[196:199], v10 offset:512
  v_mfma_f32_16x16x32_bf16 v[232:235], v[96:99], v[168:171], v[232:235]
  ds_read_b64 v[132:133], v8 offset:3072
  v_mfma_f32_16x16x32_bf16 v[236:239], v[100:103], v[168:171], v[236:239]
  ds_read_b64 v[134:135], v8 offset:3080
  v_mfma_f32_16x16x32_bf16 v[232:235], v[104:107], v[160:163], v[232:235]
  ds_read_b128 v[200:203], v10 offset:1024
  v_mfma_f32_16x16x32_bf16 v[236:239], v[104:107], v[164:167], v[236:239]
  ds_read_b64 v[136:137], v8 offset:2560
  v_mfma_f32_16x16x32_bf16 v[240:243], v[104:107], v[168:171], v[240:243]
  ds_read_b64 v[138:139], v8 offset:2568
  v_mfma_f32_16x16x32_bf16 v[236:239], v[96:99], v[172:175], v[236:239]
  ds_read_b128 v[204:207], v10 offset:1536
  v_mfma_f32_16x16x32_bf16 v[240:243], v[100:103], v[172:175], v[240:243]
  ds_read_b64 v[140:141], v8 offset:2048
  v_mfma_f32_16x16x32_bf16 v[244:247], v[104:107], v[172:175], v[244:247]
  ds_read_b64 v[142:143], v8 offset:2056
  v_mfma_f32_16x16x32_bf16 v[236:239], v[108:111], v[160:163], v[236:239]
  ds_read_b128 v[208:211], v10 offset:2048
  v_mfma_f32_16x16x32_bf16 v[240:243], v[108:111], v[164:167], v[240:243]
  ds_read_b64 v[144:145], v8 offset:1536
  v_mfma_f32_16x16x32_bf16 v[244:247], v[108:111], v[168:171], v[244:247]
  ds_read_b64 v[146:147], v8 offset:1544
  v_mfma_f32_16x16x32_bf16 v[248:251], v[108:111], v[172:175], v[248:251]
  ds_read_b128 v[212:215], v10 offset:2560
  v_mfma_f32_16x16x32_bf16 v[240:243], v[96:99], v[176:179], v[240:243]
  ds_read_b64 v[148:149], v8 offset:1024
  v_mfma_f32_16x16x32_bf16 v[244:247], v[100:103], v[176:179], v[244:247]
  ds_read_b64 v[150:151], v8 offset:1032
  v_mfma_f32_16x16x32_bf16 v[248:251], v[104:107], v[176:179], v[248:251]
  ds_read_b128 v[216:219], v10 offset:3072
  v_mfma_f32_16x16x32_bf16 v[252:255], v[108:111], v[176:179], v[252:255]
  ds_read_b64 v[152:153], v8 offset:512
  v_mfma_f32_16x16x32_bf16 v[240:243], v[112:115], v[160:163], v[240:243]
  ds_read_b64 v[154:155], v8 offset:520
  v_mfma_f32_16x16x32_bf16 v[244:247], v[112:115], v[164:167], v[244:247]
  ds_read_b128 v[220:223], v10 offset:3584
  v_mfma_f32_16x16x32_bf16 v[248:251], v[112:115], v[168:171], v[248:251]
  ds_read_b64 v[156:157], v8 offset:0
  v_mfma_f32_16x16x32_bf16 v[252:255], v[112:115], v[172:175], v[252:255]
  ds_read_b64 v[158:159], v8 offset:8
  v_mfma_f32_16x16x32_bf16 v[244:247], v[96:99], v[180:183], v[244:247]
  buffer_load_dwordx4 v[64:67], v2, s[56:59], s64 offen offset:2048 sc1
  v_mfma_f32_16x16x32_bf16 v[248:251], v[100:103], v[180:183], v[248:251]
  v_mfma_f32_16x16x32_bf16 v[252:255], v[104:107], v[180:183], v[252:255]
  v_mfma_f32_16x16x32_bf16 v[244:247], v[116:119], v[160:163], v[244:247]
  s_add_u32 s64, s64, 36864
  buffer_load_dwordx4 v[68:71], v2, s[56:59], s64 offen offset:0 sc1
  v_mfma_f32_16x16x32_bf16 v[248:251], v[116:119], v[164:167], v[248:251]
  v_mfma_f32_16x16x32_bf16 v[252:255], v[116:119], v[168:171], v[252:255]
  v_mfma_f32_16x16x32_bf16 v[248:251], v[96:99], v[184:187], v[248:251]
  buffer_load_dwordx4 v[72:75], v2, s[56:59], s64 offen offset:1024 sc1
  v_mfma_f32_16x16x32_bf16 v[252:255], v[100:103], v[184:187], v[252:255]
  v_mfma_f32_16x16x32_bf16 v[248:251], v[120:123], v[160:163], v[248:251]
  v_mfma_f32_16x16x32_bf16 v[252:255], v[120:123], v[164:167], v[252:255]
  buffer_load_dwordx4 v[76:79], v2, s[56:59], s64 offen offset:2048 sc1
  v_mfma_f32_16x16x32_bf16 v[252:255], v[96:99], v[188:191], v[252:255]
  v_mfma_f32_16x16x32_bf16 v[252:255], v[124:127], v[160:163], v[252:255]
  v_subrev_u32 v8, 64, v8
  v_subrev_u32 v10, 64, v10
  s_waitcnt lgkmcnt(0)
  v_mfma_f32_16x16x32_bf16 v[224:227], v[128:131], v[192:195], v[224:227]
  v_mfma_f32_16x16x32_bf16 v[228:231], v[128:131], v[196:199], v[228:231]
  v_mfma_f32_16x16x32_bf16 v[228:231], v[132:135], v[192:195], v[228:231]
  v_mfma_f32_16x16x32_bf16 v[232:235], v[132:135], v[196:199], v[232:235]
  v_mfma_f32_16x16x32_bf16 v[232:235], v[128:131], v[200:203], v[232:235]
  v_mfma_f32_16x16x32_bf16 v[236:239], v[132:135], v[200:203], v[236:239]
  v_mfma_f32_16x16x32_bf16 v[232:235], v[136:139], v[192:195], v[232:235]
  v_mfma_f32_16x16x32_bf16 v[236:239], v[136:139], v[196:199], v[236:239]
  v_mfma_f32_16x16x32_bf16 v[240:243], v[136:139], v[200:203], v[240:243]
  v_mfma_f32_16x16x32_bf16 v[236:239], v[128:131], v[204:207], v[236:239]
  v_mfma_f32_16x16x32_bf16 v[240:243], v[132:135], v[204:207], v[240:243]
  v_mfma_f32_16x16x32_bf16 v[244:247], v[136:139], v[204:207], v[244:247]
  v_mfma_f32_16x16x32_bf16 v[236:239], v[140:143], v[192:195], v[236:239]
  v_mfma_f32_16x16x32_bf16 v[240:243], v[140:143], v[196:199], v[240:243]
  v_mfma_f32_16x16x32_bf16 v[244:247], v[140:143], v[200:203], v[244:247]
  v_mfma_f32_16x16x32_bf16 v[248:251], v[140:143], v[204:207], v[248:251]
  v_mfma_f32_16x16x32_bf16 v[240:243], v[128:131], v[208:211], v[240:243]
  v_mfma_f32_16x16x32_bf16 v[244:247], v[132:135], v[208:211], v[244:247]
  v_mfma_f32_16x16x32_bf16 v[248:251], v[136:139], v[208:211], v[248:251]
  v_mfma_f32_16x16x32_bf16 v[252:255], v[140:143], v[208:211], v[252:255]
  v_mfma_f32_16x16x32_bf16 v[240:243], v[144:147], v[192:195], v[240:243]
  v_mfma_f32_16x16x32_bf16 v[244:247], v[144:147], v[196:199], v[244:247]
  v_mfma_f32_16x16x32_bf16 v[248:251], v[144:147], v[200:203], v[248:251]
  v_mfma_f32_16x16x32_bf16 v[252:255], v[144:147], v[204:207], v[252:255]
  v_mfma_f32_16x16x32_bf16 v[244:247], v[128:131], v[212:215], v[244:247]
  s_add_u32 s64, s64, 36864
  buffer_load_dwordx4 v[80:83], v2, s[56:59], s64 offen offset:0 sc1
  v_mfma_f32_16x16x32_bf16 v[248:251], v[132:135], v[212:215], v[248:251]
  v_mfma_f32_16x16x32_bf16 v[252:255], v[136:139], v[212:215], v[252:255]
  v_mfma_f32_16x16x32_bf16 v[244:247], v[148:151], v[192:195], v[244:247]
  buffer_load_dwordx4 v[84:87], v2, s[56:59], s64 offen offset:1024 sc1
  v_mfma_f32_16x16x32_bf16 v[248:251], v[148:151], v[196:199], v[248:251]
  v_mfma_f32_16x16x32_bf16 v[252:255], v[148:151], v[200:203], v[252:255]
  v_mfma_f32_16x16x32_bf16 v[248:251], v[128:131], v[216:219], v[248:251]
  buffer_load_dwordx4 v[88:91], v2, s[56:59], s64 offen offset:2048 sc1
  v_mfma_f32_16x16x32_bf16 v[252:255], v[132:135], v[216:219], v[252:255]
  v_mfma_f32_16x16x32_bf16 v[248:251], v[152:155], v[192:195], v[248:251]
  v_mfma_f32_16x16x32_bf16 v[252:255], v[152:155], v[196:199], v[252:255]
  s_add_u32 s64, s64, 36864
  buffer_load_dwordx4 v[92:95], v2, s[56:59], s64 offen offset:0 sc1
  v_mfma_f32_16x16x32_bf16 v[252:255], v[128:131], v[220:223], v[252:255]
  v_mfma_f32_16x16x32_bf16 v[252:255], v[156:159], v[192:195], v[252:255]
  ds_read_b64 v[96:97], v21 offset:3584
  ds_read_b64 v[98:99], v21 offset:3072
  ds_read_b64 v[100:101], v21 offset:2560
  ds_read_b64 v[102:103], v21 offset:2048
  ds_read_b64 v[104:105], v21 offset:1536
  ds_read_b64 v[106:107], v21 offset:1024
  ds_read_b64 v[108:109], v21 offset:512
  ds_read_b64 v[110:111], v21 offset:0
  s_lshl_b32 s13, s15, 16
  s_and_b32 s14, s15, 0xffff0000
  s_bitcmp1_b32 s6, 0
  s_cselect_b32 s13, s14, s13
  s_mul_i32 s10, s6, 4224
  s_add_u32 s10, s10, 4718592
  s_waitcnt lgkmcnt(0)
  v_and_b32 v22, 0xffff0000, v97
  v_lshlrev_b32 v23, 16, v97
  v_and_b32 v24, 0xffff0000, v96
  v_lshlrev_b32 v25, 16, v96
  v_fmac_f32 v224, s13, v22
  v_fmac_f32 v225, s13, v23
  v_fmac_f32 v226, s13, v24
  v_fmac_f32 v227, s13, v25
  v_cvt_pk_bf16_f32 v160, v224, v225
  v_cvt_pk_bf16_f32 v161, v226, v227
  buffer_store_dwordx2 v[160:161], v20, s[56:59], s10 offen offset:0 sc1
  v_and_b32 v22, 0xffff0000, v99
  v_lshlrev_b32 v23, 16, v99
  v_and_b32 v24, 0xffff0000, v98
  v_lshlrev_b32 v25, 16, v98
  v_fmac_f32 v228, s13, v22
  v_fmac_f32 v229, s13, v23
  v_fmac_f32 v230, s13, v24
  v_fmac_f32 v231, s13, v25
  v_cvt_pk_bf16_f32 v162, v228, v229
  v_cvt_pk_bf16_f32 v163, v230, v231
  buffer_store_dwordx2 v[162:163], v20, s[56:59], s10 offen offset:512 sc1
  v_and_b32 v22, 0xffff0000, v101
  v_lshlrev_b32 v23, 16, v101
  v_and_b32 v24, 0xffff0000, v100
  v_lshlrev_b32 v25, 16, v100
  v_fmac_f32 v232, s13, v22
  v_fmac_f32 v233, s13, v23
  v_fmac_f32 v234, s13, v24
  v_fmac_f32 v235, s13, v25
  v_cvt_pk_bf16_f32 v164, v232, v233
  v_cvt_pk_bf16_f32 v165, v234, v235
  buffer_store_dwordx2 v[164:165], v20, s[56:59], s10 offen offset:1024 sc1
  v_and_b32 v22, 0xffff0000, v103
  v_lshlrev_b32 v23, 16, v103
  v_and_b32 v24, 0xffff0000, v102
  v_lshlrev_b32 v25, 16, v102
  v_fmac_f32 v236, s13, v22
  v_fmac_f32 v237, s13, v23
  v_fmac_f32 v238, s13, v24
  v_fmac_f32 v239, s13, v25
  v_cvt_pk_bf16_f32 v166, v236, v237
  v_cvt_pk_bf16_f32 v167, v238, v239
  buffer_store_dwordx2 v[166:167], v20, s[56:59], s10 offen offset:1536 sc1
  v_and_b32 v22, 0xffff0000, v105
  v_lshlrev_b32 v23, 16, v105
  v_and_b32 v24, 0xffff0000, v104
  v_lshlrev_b32 v25, 16, v104
  v_fmac_f32 v240, s13, v22
  v_fmac_f32 v241, s13, v23
  v_fmac_f32 v242, s13, v24
  v_fmac_f32 v243, s13, v25
  v_cvt_pk_bf16_f32 v168, v240, v241
  v_cvt_pk_bf16_f32 v169, v242, v243
  buffer_store_dwordx2 v[168:169], v20, s[56:59], s10 offen offset:2048 sc1
  v_and_b32 v22, 0xffff0000, v107
  v_lshlrev_b32 v23, 16, v107
  v_and_b32 v24, 0xffff0000, v106
  v_lshlrev_b32 v25, 16, v106
  v_fmac_f32 v244, s13, v22
  v_fmac_f32 v245, s13, v23
  v_fmac_f32 v246, s13, v24
  v_fmac_f32 v247, s13, v25
  v_cvt_pk_bf16_f32 v170, v244, v245
  v_cvt_pk_bf16_f32 v171, v246, v247
  buffer_store_dwordx2 v[170:171], v20, s[56:59], s10 offen offset:2560 sc1
  v_and_b32 v22, 0xffff0000, v109
  v_lshlrev_b32 v23, 16, v109
  v_and_b32 v24, 0xffff0000, v108
  v_lshlrev_b32 v25, 16, v108
  v_fmac_f32 v248, s13, v22
  v_fmac_f32 v249, s13, v23
  v_fmac_f32 v250, s13, v24
  v_fmac_f32 v251, s13, v25
  v_cvt_pk_bf16_f32 v172, v248, v249
  v_cvt_pk_bf16_f32 v173, v250, v251
  buffer_store_dwordx2 v[172:173], v20, s[56:59], s10 offen offset:3072 sc1
  v_and_b32 v22, 0xffff0000, v111
  v_lshlrev_b32 v23, 16, v111
  v_and_b32 v24, 0xffff0000, v110
  v_lshlrev_b32 v25, 16, v110
  v_fmac_f32 v252, s13, v22
  v_fmac_f32 v253, s13, v23
  v_fmac_f32 v254, s13, v24
  v_fmac_f32 v255, s13, v25
  v_cvt_pk_bf16_f32 v174, v252, v253
  v_cvt_pk_bf16_f32 v175, v254, v255
  buffer_store_dwordx2 v[174:175], v20, s[56:59], s10 offen offset:3584 sc1
  s_lshl_b32 s6, s6, 5
  s_add_u32 s6, s6, 9739264
  v_mov_b32 v5, 2
  s_mov_b32 s98, s6
  s_mov_b64 exec, 1
  ds_add_u32 v16, v5 offset:0
  s_mov_b64 exec, -1
  s_branch K6_p2
K6_p:
  s_cmp_lg_u32 s3, 1
  s_cbranch_scc1 KB_w3
  s_add_u32 s6, s70, 128
  s_load_dword s48, s[42:43], s6
  s_waitcnt lgkmcnt(0)
  s_cmp_lg_u32 s48, 0
  s_cbranch_scc1 DP_36
  s_mov_b32 s13, 0x40000
CP_37:
  s_load_dword s48, s[42:43], s6 glc
  s_waitcnt lgkmcnt(0)
  s_cmp_ge_u32 s48, 1
  s_cbranch_scc1 CD_38
  s_sleep 8
  s_sub_u32 s13, s13, 1
  s_cbranch_scc0 CP_37
CD_38:
DP_36:
  s_mov_b64 exec, 1
  ds_add_u32 v16, v17 offset:56
  s_mov_b64 exec, -1
KB_w3:
LW_39:
  ds_read_b32 v5, v16 offset:56
  s_waitcnt lgkmcnt(0)
  v_readfirstlane_b32 s7, v5
  s_cmp_ge_u32 s7, 1
  s_cbranch_scc1 LD_40
  s_sleep 1
  s_branch LW_39
LD_40:
  buffer_load_dwordx4 v[32:35], v2, s[56:59], s64 offen offset:0 sc1
  buffer_load_dwordx4 v[36:39], v2, s[56:59], s64 offen offset:1024 sc1
  buffer_load_dwordx4 v[40:43], v2, s[56:59], s64 offen offset:2048 sc1
  s_add_u32 s64, s64, 36864
  buffer_load_dwordx4 v[44:47], v2, s[56:59], s64 offen offset:0 sc1
  buffer_load_dwordx4 v[48:51], v2, s[56:59], s64 offen offset:1024 sc1
  buffer_load_dwordx4 v[52:55], v2, s[56:59], s64 offen offset:2048 sc1
  s_add_u32 s64, s64, 36864
  buffer_load_dwordx4 v[56:59], v2, s[56:59], s64 offen offset:0 sc1
  buffer_load_dwordx4 v[60:63], v2, s[56:59], s64 offen offset:1024 sc1
  s_waitcnt vmcnt(7)
  buffer_load_dwordx4 v[64:67], v2, s[56:59], s64 offen offset:2048 sc1
  s_waitcnt vmcnt(7)
  s_add_u32 s64, s64, 36864
  buffer_load_dwordx4 v[68:71], v2, s[56:59], s64 offen offset:0 sc1
  s_waitcnt vmcnt(7)
  buffer_load_dwordx4 v[72:75], v2, s[56:59], s64 offen offset:1024 sc1
  s_waitcnt vmcnt(7)
  buffer_load_dwordx4 v[76:79], v2, s[56:59], s64 offen offset:2048 sc1
  s_waitcnt vmcnt(7)
  s_add_u32 s64, s64, 36864
  buffer_load_dwordx4 v[80:83], v2, s[56:59], s64 offen offset:0 sc1
  s_waitcnt vmcnt(7)
  buffer_load_dwordx4 v[84:87], v2, s[56:59], s64 offen offset:1024 sc1
  s_waitcnt vmcnt(7)
  buffer_load_dwordx4 v[88:91], v2, s[56:59], s64 offen offset:2048 sc1
  s_waitcnt vmcnt(7)
  s_add_u32 s64, s64, 36864
  buffer_load_dwordx4 v[92:95], v2, s[56:59], s64 offen offset:0 sc1
  s_mov_b32 s98, 0
K6_p2:
  s_setprio 2
  buffer_load_dwordx4 v[96:99], v2, s[56:59], s64 offen offset:1024 sc1
  buffer_load_dwordx4 v[100:103], v2, s[56:59], s64 offen offset:2048 sc1
  v_mov_b32 v6, v2
  v_add_u32 v7, 36864, v2
  v_add_u32 v8, 73728, v2
  v_add_u32 v9, 110592, v2
  s_add_u32 s12, s71, 0
  s_lshr_b32 s13, s12, 1
  s_lshl_b32 s13, s13, 10
  s_and_b32 s12, s12, 1
  s_lshl_b32 s12, s12, 3
  s_add_u32 s12, s12, s13
  s_add_u32 s12, s12, 73728
  v_add_u32 v10, s12, v2
  v_add_u32 v11, 36864, v10
  s_add_u32 s12, s71, 1
  s_lshr_b32 s13, s12, 1
  s_lshl_b32 s13, s13, 10
  s_and_b32 s12, s12, 1
  s_lshl_b32 s12, s12, 3
  s_add_u32 s12, s12, s13
  s_add_u32 s12, s12, 73728
  v_add_u32 v12, s12, v2
  v_add_u32 v13, 36864, v12
  s_lshr_b32 s11, s5, 1
  s_mul_i32 s6, s11, 4352
  s_add_u32 s6, s6, 9895936
  s_mul_i32 s9, s3, 18432
  s_mov_b32 m0, s9
  s_mul_i32 s7, s5, 73728
  s_add_u32 s7, s7, s9
  s_add_u32 s7, s7, 2359296
  s_cmp_lg_u32 s3, 0
  s_cbranch_scc1 KB_xw
  s_mov_b32 s13, 0x40000
CP_41:
  s_load_dword s44, s[42:43], s6 glc
  s_waitcnt lgkmcnt(0)
  s_cmp_ge_u32 s44, 9
  s_cbranch_scc1 CD_42
  s_sleep 1
  s_sub_u32 s13, s13, 1
  s_cbranch_scc0 CP_41
CD_42:
LW_43:
  ds_read_b32 v5, v16 offset:0
  s_waitcnt lgkmcnt(0)
  v_readfirstlane_b32 s8, v5
  s_cmp_ge_u32 s8, 8
  s_cbranch_scc1 LD_44
  s_sleep 1
  s_branch LW_43
LD_44:
  s_mov_b64 exec, 1
  ds_add_u32 v16, v17 offset:12
  s_mov_b64 exec, -1
  s_branch KB_xg
KB_xw:
LW_45:
  ds_read_b32 v5, v16 offset:12
  s_waitcnt lgkmcnt(0)
  v_readfirstlane_b32 s8, v5
  s_cmp_ge_u32 s8, 1
  s_cbranch_scc1 LD_46
  s_sleep 1
  s_branch LW_45
LD_46:
KB_xg:
  buffer_load_dwordx4 v2, s[56:59], s7 offen offset:0 sc1 lds
  buffer_load_dwordx4 v2, s[56:59], s7 offen offset:1024 sc1 lds
  buffer_load_dwordx4 v2, s[56:59], s7 offen offset:2048 sc1 lds
  buffer_load_dwordx4 v2, s[56:59], s7 offen offset:3072 sc1 lds
  s_add_u32 m0, m0, 4096
  s_add_u32 s7, s7, 4096
  buffer_load_dwordx4 v2, s[56:59], s7 offen offset:0 sc1 lds
  buffer_load_dwordx4 v2, s[56:59], s7 offen offset:1024 sc1 lds
  buffer_load_dwordx4 v2, s[56:59], s7 offen offset:2048 sc1 lds
  buffer_load_dwordx4 v2, s[56:59], s7 offen offset:3072 sc1 lds
  s_add_u32 m0, m0, 4096
  s_add_u32 s7, s7, 4096
  buffer_load_dwordx4 v2, s[56:59], s7 offen offset:0 sc1 lds
  buffer_load_dwordx4 v2, s[56:59], s7 offen offset:1024 sc1 lds
  buffer_load_dwordx4 v2, s[56:59], s7 offen offset:2048 sc1 lds
  buffer_load_dwordx4 v2, s[56:59], s7 offen offset:3072 sc1 lds
  s_add_u32 m0, m0, 4096
  s_add_u32 s7, s7, 4096
  buffer_load_dwordx4 v2, s[56:59], s7 offen offset:0 sc1 lds
  buffer_load_dwordx4 v2, s[56:59], s7 offen offset:1024 sc1 lds
  buffer_load_dwordx4 v2, s[56:59], s7 offen offset:2048 sc1 lds
  buffer_load_dwordx4 v2, s[56:59], s7 offen offset:3072 sc1 lds
  s_add_u32 m0, m0, 4096
  s_add_u32 s7, s7, 4096
  buffer_load_dwordx4 v2, s[56:59], s7 offen offset:0 sc1 lds
  buffer_load_dwordx4 v2, s[56:59], s7 offen offset:1024 sc1 lds
  s_waitcnt vmcnt(12)
  s_cmp_eq_u32 s98, 0
  s_cbranch_scc1 KB_fy
  s_mov_b64 exec, 1
  v_mov_b32 v14, 0
  v_mov_b32 v15, 1
  buffer_store_dword v15, v14, s[56:59], s98 offen sc1
  s_mov_b64 exec, -1
KB_fy:
  s_mov_b64 exec, 1
  v_mov_b32 v5, 1
  ds_add_u32 v16, v5 offset:4
  s_mov_b64 exec, -1
LW_47:
  ds_read_b32 v5, v16 offset:4
  s_waitcnt lgkmcnt(0)
  v_readfirstlane_b32 s10, v5
  s_cmp_ge_u32 s10, 4
  s_cbranch_scc1 LD_48
  s_sleep 1
  s_branch LW_47
LD_48:
  s_setprio 2
  ds_read_b128 v[104:107], v6 offset:0
  ds_read_b128 v[108:111], v6 offset:18432
  ds_read_b128 v[112:115], v7 offset:0
  ds_read_b128 v[116:119], v7 offset:18432
  s_waitcnt vmcnt(33) lgkmcnt(0)
  v_mfma_f32_16x16x32_bf16 v[136:139], v[32:35], v[104:107], 0
  v_mfma_f32_16x16x32_bf16 v[140:143], v[32:35], v[108:111], 0
  v_mfma_f32_16x16x32_bf16 v[144:147], v[32:35], v[112:115], 0
  ds_read_b128 v[120:123], v6 offset:1024
  v_mfma_f32_16x16x32_bf16 v[148:151], v[32:35], v[116:119], 0
  ds_read_b128 v[124:127], v6 offset:19456
  v_mfma_f32_16x16x32_bf16 v[152:155], v[36:39], v[104:107], 0
  s_add_u32 s64, s64, 36864
  v_mfma_f32_16x16x32_bf16 v[156:159], v[36:39], v[108:111], 0
  buffer_load_dwordx4 v[32:35], v2, s[56:59], s64 offen offset:0 sc1
  v_mfma_f32_16x16x32_bf16 v[160:163], v[36:39], v[112:115], 0
  ds_read_b128 v[128:131], v7 offset:1024
  v_mfma_f32_16x16x32_bf16 v[164:167], v[36:39], v[116:119], 0
  ds_read_b128 v[132:135], v7 offset:19456
  v_mfma_f32_16x16x32_bf16 v[168:171], v[40:43], v[104:107], 0
  v_mfma_f32_16x16x32_bf16 v[172:175], v[40:43], v[108:111], 0
  buffer_load_dwordx4 v[36:39], v2, s[56:59], s64 offen offset:1024 sc1
  v_mfma_f32_16x16x32_bf16 v[176:179], v[40:43], v[112:115], 0
  v_mfma_f32_16x16x32_bf16 v[180:183], v[40:43], v[116:119], 0
  s_waitcnt vmcnt(32) lgkmcnt(0)
  v_mfma_f32_16x16x32_bf16 v[136:139], v[44:47], v[120:123], v[136:139]
  v_mfma_f32_16x16x32_bf16 v[140:143], v[44:47], v[124:127], v[140:143]
  buffer_load_dwordx4 v[40:43], v2, s[56:59], s64 offen offset:2048 sc1
  v_mfma_f32_16x16x32_bf16 v[144:147], v[44:47], v[128:131], v[144:147]
  ds_read_b128 v[104:107], v6 offset:2048
  v_mfma_f32_16x16x32_bf16 v[148:151], v[44:47], v[132:135], v[148:151]
  ds_read_b128 v[108:111], v6 offset:20480
  v_mfma_f32_16x16x32_bf16 v[152:155], v[48:51], v[120:123], v[152:155]
  s_add_u32 s64, s64, 36864
  v_mfma_f32_16x16x32_bf16 v[156:159], v[48:51], v[124:127], v[156:159]
  buffer_load_dwordx4 v[44:47], v2, s[56:59], s64 offen offset:0 sc1
  v_mfma_f32_16x16x32_bf16 v[160:163], v[48:51], v[128:131], v[160:163]
  ds_read_b128 v[112:115], v7 offset:2048
  v_mfma_f32_16x16x32_bf16 v[164:167], v[48:51], v[132:135], v[164:167]
  ds_read_b128 v[116:119], v7 offset:20480
  v_mfma_f32_16x16x32_bf16 v[168:171], v[52:55], v[120:123], v[168:171]
  v_mfma_f32_16x16x32_bf16 v[172:175], v[52:55], v[124:127], v[172:175]
  buffer_load_dwordx4 v[48:51], v2, s[56:59], s64 offen offset:1024 sc1
  v_mfma_f32_16x16x32_bf16 v[176:179], v[52:55], v[128:131], v[176:179]
  v_mfma_f32_16x16x32_bf16 v[180:183], v[52:55], v[132:135], v[180:183]
  s_waitcnt vmcnt(32) lgkmcnt(0)
  v_mfma_f32_16x16x32_bf16 v[136:139], v[56:59], v[104:107], v[136:139]
  v_mfma_f32_16x16x32_bf16 v[140:143], v[56:59], v[108:111], v[140:143]
  buffer_load_dwordx4 v[52:55], v2, s[56:59], s64 offen offset:2048 sc1
  v_mfma_f32_16x16x32_bf16 v[144:147], v[56:59], v[112:115], v[144:147]
  ds_read_b128 v[120:123], v6 offset:3072
  v_mfma_f32_16x16x32_bf16 v[148:151], v[56:59], v[116:119], v[148:151]
  ds_read_b128 v[124:127], v6 offset:21504
  v_mfma_f32_16x16x32_bf16 v[152:155], v[60:63], v[104:107], v[152:155]
  s_add_u32 s64, s64, 36864
  v_mfma_f32_16x16x32_bf16 v[156:159], v[60:63], v[108:111], v[156:159]
  buffer_load_dwordx4 v[56:59], v2, s[56:59], s64 offen offset:0 sc1
  v_mfma_f32_16x16x32_bf16 v[160:163], v[60:63], v[112:115], v[160:163]
  ds_read_b128 v[128:131], v7 offset:3072
  v_mfma_f32_16x16x32_bf16 v[164:167], v[60:63], v[116:119], v[164:167]
  ds_read_b128 v[132:135], v7 offset:21504
  v_mfma_f32_16x16x32_bf16 v[168:171], v[64:67], v[104:107], v[168:171]
  v_mfma_f32_16x16x32_bf16 v[172:175], v[64:67], v[108:111], v[172:175]
  buffer_load_dwordx4 v[60:63], v2, s[56:59], s64 offen offset:1024 sc1
  v_mfma_f32_16x16x32_bf16 v[176:179], v[64:67], v[112:115], v[176:179]
  v_mfma_f32_16x16x32_bf16 v[180:183], v[64:67], v[116:119], v[180:183]
  s_waitcnt vmcnt(32) lgkmcnt(0)
  v_mfma_f32_16x16x32_bf16 v[136:139], v[68:71], v[120:123], v[136:139]
  v_mfma_f32_16x16x32_bf16 v[140:143], v[68:71], v[124:127], v[140:143]
  buffer_load_dwordx4 v[64:67], v2, s[56:59], s64 offen offset:2048 sc1
  v_mfma_f32_16x16x32_bf16 v[144:147], v[68:71], v[128:131], v[144:147]
  ds_read_b128 v[104:107], v6 offset:4096
  v_mfma_f32_16x16x32_bf16 v[148:151], v[68:71], v[132:135], v[148:151]
  ds_read_b128 v[108:111], v6 offset:22528
  v_mfma_f32_16x16x32_bf16 v[152:155], v[72:75], v[120:123], v[152:155]
  s_add_u32 s64, s64, 36864
  v_mfma_f32_16x16x32_bf16 v[156:159], v[72:75], v[124:127], v[156:159]
  buffer_load_dwordx4 v[68:71], v2, s[56:59], s64 offen offset:0 sc1
  v_mfma_f32_16x16x32_bf16 v[160:163], v[72:75], v[128:131], v[160:163]
  ds_read_b128 v[112:115], v7 offset:4096
  v_mfma_f32_16x16x32_bf16 v[164:167], v[72:75], v[132:135], v[164:167]
  ds_read_b128 v[116:119], v7 offset:22528
  v_mfma_f32_16x16x32_bf16 v[168:171], v[76:79], v[120:123], v[168:171]
  v_mfma_f32_16x16x32_bf16 v[172:175], v[76:79], v[124:127], v[172:175]
  buffer_load_dwordx4 v[72:75], v2, s[56:59], s64 offen offset:1024 sc1
  v_mfma_f32_16x16x32_bf16 v[176:179], v[76:79], v[128:131], v[176:179]
  v_mfma_f32_16x16x32_bf16 v[180:183], v[76:79], v[132:135], v[180:183]
  s_waitcnt vmcnt(32) lgkmcnt(0)
  v_mfma_f32_16x16x32_bf16 v[136:139], v[80:83], v[104:107], v[136:139]
  v_mfma_f32_16x16x32_bf16 v[140:143], v[80:83], v[108:111], v[140:143]
  buffer_load_dwordx4 v[76:79], v2, s[56:59], s64 offen offset:2048 sc1
  v_mfma_f32_16x16x32_bf16 v[144:147], v[80:83], v[112:115], v[144:147]
  ds_read_b128 v[120:123], v6 offset:5120
  v_mfma_f32_16x16x32_bf16 v[148:151], v[80:83], v[116:119], v[148:151]
  ds_read_b128 v[124:127], v6 offset:23552
  v_mfma_f32_16x16x32_bf16 v[152:155], v[84:87], v[104:107], v[152:155]
  s_add_u32 s64, s64, 36864
  v_mfma_f32_16x16x32_bf16 v[156:159], v[84:87], v[108:111], v[156:159]
  buffer_load_dwordx4 v[80:83], v2, s[56:59], s64 offen offset:0 sc1
  v_mfma_f32_16x16x32_bf16 v[160:163], v[84:87], v[112:115], v[160:163]
  ds_read_b128 v[128:131], v7 offset:5120
  v_mfma_f32_16x16x32_bf16 v[164:167], v[84:87], v[116:119], v[164:167]
  ds_read_b128 v[132:135], v7 offset:23552
  v_mfma_f32_16x16x32_bf16 v[168:171], v[88:91], v[104:107], v[168:171]
  v_mfma_f32_16x16x32_bf16 v[172:175], v[88:91], v[108:111], v[172:175]
  buffer_load_dwordx4 v[84:87], v2, s[56:59], s64 offen offset:1024 sc1
  v_mfma_f32_16x16x32_bf16 v[176:179], v[88:91], v[112:115], v[176:179]
  v_mfma_f32_16x16x32_bf16 v[180:183], v[88:91], v[116:119], v[180:183]
  s_waitcnt vmcnt(32) lgkmcnt(0)
  v_mfma_f32_16x16x32_bf16 v[136:139], v[92:95], v[120:123], v[136:139]
  v_mfma_f32_16x16x32_bf16 v[140:143], v[92:95], v[124:127], v[140:143]
  buffer_load_dwordx4 v[88:91], v2, s[56:59], s64 offen offset:2048 sc1
  v_mfma_f32_16x16x32_bf16 v[144:147], v[92:95], v[128:131], v[144:147]
  v_mfma_f32_16x16x32_bf16 v[148:151], v[92:95], v[132:135], v[148:151]
  v_mfma_f32_16x16x32_bf16 v[152:155], v[96:99], v[120:123], v[152:155]
  s_add_u32 s64, s64, 36864
  v_mfma_f32_16x16x32_bf16 v[156:159], v[96:99], v[124:127], v[156:159]
  buffer_load_dwordx4 v[92:95], v2, s[56:59], s64 offen offset:0 sc1
  v_mfma_f32_16x16x32_bf16 v[160:163], v[96:99], v[128:131], v[160:163]
  v_mfma_f32_16x16x32_bf16 v[164:167], v[96:99], v[132:135], v[164:167]
  v_mfma_f32_16x16x32_bf16 v[168:171], v[100:103], v[120:123], v[168:171]
  v_mfma_f32_16x16x32_bf16 v[172:175], v[100:103], v[124:127], v[172:175]
  buffer_load_dwordx4 v[96:99], v2, s[56:59], s64 offen offset:1024 sc1
  v_mfma_f32_16x16x32_bf16 v[176:179], v[100:103], v[128:131], v[176:179]
  v_mfma_f32_16x16x32_bf16 v[180:183], v[100:103], v[132:135], v[180:183]
  buffer_load_dwordx4 v[100:103], v2, s[56:59], s64 offen offset:2048 sc1
  s_setprio 0
  s_waitcnt vmcnt(18)
  s_mov_b64 exec, 1
  v_mov_b32 v5, 1
  ds_add_u32 v16, v5 offset:8
  s_mov_b64 exec, -1
LW_49:
  ds_read_b32 v5, v16 offset:8
  s_waitcnt lgkmcnt(0)
  v_readfirstlane_b32 s7, v5
  s_cmp_ge_u32 s7, 4
  s_cbranch_scc1 LD_50
  s_sleep 1
  s_branch LW_49
LD_50:
  s_setprio 2
  ds_read_b128 v[104:107], v6 offset:6144
  ds_read_b128 v[108:111], v6 offset:24576
  ds_read_b128 v[112:115], v7 offset:6144
  ds_read_b128 v[116:119], v7 offset:24576
  s_waitcnt vmcnt(15) lgkmcnt(0)
  v_mfma_f32_16x16x32_bf16 v[136:139], v[32:35], v[104:107], v[136:139]
  v_mfma_f32_16x16x32_bf16 v[140:143], v[32:35], v[108:111], v[140:143]
  v_mfma_f32_16x16x32_bf16 v[144:147], v[32:35], v[112:115], v[144:147]
  ds_read_b128 v[120:123], v6 offset:7168
  v_mfma_f32_16x16x32_bf16 v[148:151], v[32:35], v[116:119], v[148:151]
  ds_read_b128 v[124:127], v6 offset:25600
  v_mfma_f32_16x16x32_bf16 v[152:155], v[36:39], v[104:107], v[152:155]
  s_add_u32 s64, s64, 36864
  v_mfma_f32_16x16x32_bf16 v[156:159], v[36:39], v[108:111], v[156:159]
  buffer_load_dwordx4 v[32:35], v2, s[56:59], s64 offen offset:0 sc1
  v_mfma_f32_16x16x32_bf16 v[160:163], v[36:39], v[112:115], v[160:163]
  ds_read_b128 v[128:131], v7 offset:7168
  v_mfma_f32_16x16x32_bf16 v[164:167], v[36:39], v[116:119], v[164:167]
  ds_read_b128 v[132:135], v7 offset:25600
  v_mfma_f32_16x16x32_bf16 v[168:171], v[40:43], v[104:107], v[168:171]
  v_mfma_f32_16x16x32_bf16 v[172:175], v[40:43], v[108:111], v[172:175]
  buffer_load_dwordx4 v[36:39], v2, s[56:59], s64 offen offset:1024 sc1
  v_mfma_f32_16x16x32_bf16 v[176:179], v[40:43], v[112:115], v[176:179]
  v_mfma_f32_16x16x32_bf16 v[180:183], v[40:43], v[116:119], v[180:183]
  s_waitcnt vmcnt(14) lgkmcnt(0)
  v_mfma_f32_16x16x32_bf16 v[136:139], v[44:47], v[120:123], v[136:139]
  v_mfma_f32_16x16x32_bf16 v[140:143], v[44:47], v[124:127], v[140:143]
  buffer_load_dwordx4 v[40:43], v2, s[56:59], s64 offen offset:2048 sc1
  v_mfma_f32_16x16x32_bf16 v[144:147], v[44:47], v[128:131], v[144:147]
  ds_read_b128 v[104:107], v6 offset:8192
  v_mfma_f32_16x16x32_bf16 v[148:151], v[44:47], v[132:135], v[148:151]
  ds_read_b128 v[108:111], v6 offset:26624
  v_mfma_f32_16x16x32_bf16 v[152:155], v[48:51], v[120:123], v[152:155]
  s_add_u32 s64, s64, 36864
  v_mfma_f32_16x16x32_bf16 v[156:159], v[48:51], v[124:127], v[156:159]
  buffer_load_dwordx4 v[44:47], v2, s[56:59], s64 offen offset:0 sc1
  v_mfma_f32_16x16x32_bf16 v[160:163], v[48:51], v[128:131], v[160:163]
  ds_read_b128 v[112:115], v7 offset:8192
  v_mfma_f32_16x16x32_bf16 v[164:167], v[48:51], v[132:135], v[164:167]
  ds_read_b128 v[116:119], v7 offset:26624
  v_mfma_f32_16x16x32_bf16 v[168:171], v[52:55], v[120:123], v[168:171]
  v_mfma_f32_16x16x32_bf16 v[172:175], v[52:55], v[124:127], v[172:175]
  buffer_load_dwordx4 v[48:51], v2, s[56:59], s64 offen offset:1024 sc1
  v_mfma_f32_16x16x32_bf16 v[176:179], v[52:55], v[128:131], v[176:179]
  v_mfma_f32_16x16x32_bf16 v[180:183], v[52:55], v[132:135], v[180:183]
  s_waitcnt vmcnt(14) lgkmcnt(0)
  v_mfma_f32_16x16x32_bf16 v[136:139], v[56:59], v[104:107], v[136:139]
  v_mfma_f32_16x16x32_bf16 v[140:143], v[56:59], v[108:111], v[140:143]
  buffer_load_dwordx4 v[52:55], v2, s[56:59], s64 offen offset:2048 sc1
  v_mfma_f32_16x16x32_bf16 v[144:147], v[56:59], v[112:115], v[144:147]
  ds_read_b128 v[120:123], v6 offset:9216
  v_mfma_f32_16x16x32_bf16 v[148:151], v[56:59], v[116:119], v[148:151]
  ds_read_b128 v[124:127], v6 offset:27648
  v_mfma_f32_16x16x32_bf16 v[152:155], v[60:63], v[104:107], v[152:155]
  s_add_u32 s64, s64, 36864
  v_mfma_f32_16x16x32_bf16 v[156:159], v[60:63], v[108:111], v[156:159]
  buffer_load_dwordx4 v[56:59], v2, s[56:59], s64 offen offset:0 sc1
  v_mfma_f32_16x16x32_bf16 v[160:163], v[60:63], v[112:115], v[160:163]
  ds_read_b128 v[128:131], v7 offset:9216
  v_mfma_f32_16x16x32_bf16 v[164:167], v[60:63], v[116:119], v[164:167]
  ds_read_b128 v[132:135], v7 offset:27648
  v_mfma_f32_16x16x32_bf16 v[168:171], v[64:67], v[104:107], v[168:171]
  v_mfma_f32_16x16x32_bf16 v[172:175], v[64:67], v[108:111], v[172:175]
  buffer_load_dwordx4 v[60:63], v2, s[56:59], s64 offen offset:1024 sc1
  v_mfma_f32_16x16x32_bf16 v[176:179], v[64:67], v[112:115], v[176:179]
  v_mfma_f32_16x16x32_bf16 v[180:183], v[64:67], v[116:119], v[180:183]
  s_waitcnt vmcnt(14) lgkmcnt(0)
  v_mfma_f32_16x16x32_bf16 v[136:139], v[68:71], v[120:123], v[136:139]
  v_mfma_f32_16x16x32_bf16 v[140:143], v[68:71], v[124:127], v[140:143]
  buffer_load_dwordx4 v[64:67], v2, s[56:59], s64 offen offset:2048 sc1
  v_mfma_f32_16x16x32_bf16 v[144:147], v[68:71], v[128:131], v[144:147]
  ds_read_b128 v[104:107], v6 offset:10240
  v_mfma_f32_16x16x32_bf16 v[148:151], v[68:71], v[132:135], v[148:151]
  ds_read_b128 v[108:111], v6 offset:28672
  v_mfma_f32_16x16x32_bf16 v[152:155], v[72:75], v[120:123], v[152:155]
  s_add_u32 s64, s64, 36864
  v_mfma_f32_16x16x32_bf16 v[156:159], v[72:75], v[124:127], v[156:159]
  buffer_load_dwordx4 v[68:71], v2, s[56:59], s64 offen offset:0 sc1
  v_mfma_f32_16x16x32_bf16 v[160:163], v[72:75], v[128:131], v[160:163]
  ds_read_b128 v[112:115], v7 offset:10240
  v_mfma_f32_16x16x32_bf16 v[164:167], v[72:75], v[132:135], v[164:167]
  ds_read_b128 v[116:119], v7 offset:28672
  v_mfma_f32_16x16x32_bf16 v[168:171], v[76:79], v[120:123], v[168:171]
  v_mfma_f32_16x16x32_bf16 v[172:175], v[76:79], v[124:127], v[172:175]
  buffer_load_dwordx4 v[72:75], v2, s[56:59], s64 offen offset:1024 sc1
  v_mfma_f32_16x16x32_bf16 v[176:179], v[76:79], v[128:131], v[176:179]
  v_mfma_f32_16x16x32_bf16 v[180:183], v[76:79], v[132:135], v[180:183]
  s_waitcnt vmcnt(14) lgkmcnt(0)
  v_mfma_f32_16x16x32_bf16 v[136:139], v[80:83], v[104:107], v[136:139]
  v_mfma_f32_16x16x32_bf16 v[140:143], v[80:83], v[108:111], v[140:143]
  buffer_load_dwordx4 v[76:79], v2, s[56:59], s64 offen offset:2048 sc1
  v_mfma_f32_16x16x32_bf16 v[144:147], v[80:83], v[112:115], v[144:147]
  ds_read_b128 v[120:123], v6 offset:11264
  v_mfma_f32_16x16x32_bf16 v[148:151], v[80:83], v[116:119], v[148:151]
  ds_read_b128 v[124:127], v6 offset:29696
  v_mfma_f32_16x16x32_bf16 v[152:155], v[84:87], v[104:107], v[152:155]
  s_add_u32 s64, s64, 36864
  v_mfma_f32_16x16x32_bf16 v[156:159], v[84:87], v[108:111], v[156:159]
  buffer_load_dwordx4 v[80:83], v2, s[56:59], s64 offen offset:0 sc1
  v_mfma_f32_16x16x32_bf16 v[160:163], v[84:87], v[112:115], v[160:163]
  ds_read_b128 v[128:131], v7 offset:11264
  v_mfma_f32_16x16x32_bf16 v[164:167], v[84:87], v[116:119], v[164:167]
  ds_read_b128 v[132:135], v7 offset:29696
  v_mfma_f32_16x16x32_bf16 v[168:171], v[88:91], v[104:107], v[168:171]
  v_mfma_f32_16x16x32_bf16 v[172:175], v[88:91], v[108:111], v[172:175]
  buffer_load_dwordx4 v[84:87], v2, s[56:59], s64 offen offset:1024 sc1
  v_mfma_f32_16x16x32_bf16 v[176:179], v[88:91], v[112:115], v[176:179]
  v_mfma_f32_16x16x32_bf16 v[180:183], v[88:91], v[116:119], v[180:183]
  s_waitcnt vmcnt(14) lgkmcnt(0)
  v_mfma_f32_16x16x32_bf16 v[136:139], v[92:95], v[120:123], v[136:139]
  v_mfma_f32_16x16x32_bf16 v[140:143], v[92:95], v[124:127], v[140:143]
  buffer_load_dwordx4 v[88:91], v2, s[56:59], s64 offen offset:2048 sc1
  v_mfma_f32_16x16x32_bf16 v[144:147], v[92:95], v[128:131], v[144:147]
  ds_read_b128 v[104:107], v6 offset:12288
  v_mfma_f32_16x16x32_bf16 v[148:151], v[92:95], v[132:135], v[148:151]
  ds_read_b128 v[108:111], v6 offset:30720
  v_mfma_f32_16x16x32_bf16 v[152:155], v[96:99], v[120:123], v[152:155]
  s_add_u32 s64, s64, 36864
  v_mfma_f32_16x16x32_bf16 v[156:159], v[96:99], v[124:127], v[156:159]
  buffer_load_dwordx4 v[92:95], v2, s[56:59], s64 offen offset:0 sc1
  v_mfma_f32_16x16x32_bf16 v[160:163], v[96:99], v[128:131], v[160:163]
  ds_read_b128 v[112:115], v7 offset:12288
  v_mfma_f32_16x16x32_bf16 v[164:167], v[96:99], v[132:135], v[164:167]
  ds_read_b128 v[116:119], v7 offset:30720
  v_mfma_f32_16x16x32_bf16 v[168:171], v[100:103], v[120:123], v[168:171]
  v_mfma_f32_16x16x32_bf16 v[172:175], v[100:103], v[124:127], v[172:175]
  buffer_load_dwordx4 v[96:99], v2, s[56:59], s64 offen offset:1024 sc1
  v_mfma_f32_16x16x32_bf16 v[176:179], v[100:103], v[128:131], v[176:179]
LW_51:
  ds_read_b32 v5, v16 offset:48
  s_waitcnt lgkmcnt(0)
  v_readfirstlane_b32 s7, v5
  s_cmp_ge_u32 s7, 1
  s_cbranch_scc1 LD_52
  s_sleep 1
  s_branch LW_51
LD_52:
  v_mfma_f32_16x16x32_bf16 v[180:183], v[100:103], v[132:135], v[180:183]
  s_waitcnt vmcnt(14) lgkmcnt(0)
  v_mfma_f32_16x16x32_bf16 v[136:139], v[32:35], v[104:107], v[136:139]
  v_mfma_f32_16x16x32_bf16 v[140:143], v[32:35], v[108:111], v[140:143]
  buffer_load_dwordx4 v[100:103], v2, s[56:59], s64 offen offset:2048 sc1
  v_mfma_f32_16x16x32_bf16 v[144:147], v[32:35], v[112:115], v[144:147]
  ds_read_b128 v[120:123], v6 offset:13312
  v_mfma_f32_16x16x32_bf16 v[148:151], v[32:35], v[116:119], v[148:151]
  ds_read_b128 v[124:127], v6 offset:31744
  v_mfma_f32_16x16x32_bf16 v[152:155], v[36:39], v[104:107], v[152:155]
  v_mfma_f32_16x16x32_bf16 v[156:159], v[36:39], v[108:111], v[156:159]
  buffer_load_dwordx4 v[32:35], v2, s[56:59], s65 offen offset:0 sc1
  v_mfma_f32_16x16x32_bf16 v[160:163], v[36:39], v[112:115], v[160:163]
  ds_read_b128 v[128:131], v7 offset:13312
  v_mfma_f32_16x16x32_bf16 v[164:167], v[36:39], v[116:119], v[164:167]
  ds_read_b128 v[132:135], v7 offset:31744
  v_mfma_f32_16x16x32_bf16 v[168:171], v[40:43], v[104:107], v[168:171]
  v_mfma_f32_16x16x32_bf16 v[172:175], v[40:43], v[108:111], v[172:175]
  buffer_load_dwordx4 v[36:39], v2, s[56:59], s65 offen offset:1024 sc1
  v_mfma_f32_16x16x32_bf16 v[176:179], v[40:43], v[112:115], v[176:179]
  v_mfma_f32_16x16x32_bf16 v[180:183], v[40:43], v[116:119], v[180:183]
  s_waitcnt vmcnt(14) lgkmcnt(0)
  v_mfma_f32_16x16x32_bf16 v[136:139], v[44:47], v[120:123], v[136:139]
  v_mfma_f32_16x16x32_bf16 v[140:143], v[44:47], v[124:127], v[140:143]
  buffer_load_dwordx4 v[40:43], v2, s[56:59], s65 offen offset:2048 sc1
  v_mfma_f32_16x16x32_bf16 v[144:147], v[44:47], v[128:131], v[144:147]
  ds_read_b128 v[104:107], v6 offset:14336
  v_mfma_f32_16x16x32_bf16 v[148:151], v[44:47], v[132:135], v[148:151]
  ds_read_b128 v[108:111], v6 offset:32768
  v_mfma_f32_16x16x32_bf16 v[152:155], v[48:51], v[120:123], v[152:155]
  s_add_u32 s65, s65, 36864
  v_mfma_f32_16x16x32_bf16 v[156:159], v[48:51], v[124:127], v[156:159]
  buffer_load_dwordx4 v[44:47], v2, s[56:59], s65 offen offset:0 sc1
  v_mfma_f32_16x16x32_bf16 v[160:163], v[48:51], v[128:131], v[160:163]
  ds_read_b128 v[112:115], v7 offset:14336
  v_mfma_f32_16x16x32_bf16 v[164:167], v[48:51], v[132:135], v[164:167]
  ds_read_b128 v[116:119], v7 offset:32768
  v_mfma_f32_16x16x32_bf16 v[168:171], v[52:55], v[120:123], v[168:171]
  v_mfma_f32_16x16x32_bf16 v[172:175], v[52:55], v[124:127], v[172:175]
  buffer_load_dwordx4 v[48:51], v2, s[56:59], s65 offen offset:1024 sc1
  v_mfma_f32_16x16x32_bf16 v[176:179], v[52:55], v[128:131], v[176:179]
  v_mfma_f32_16x16x32_bf16 v[180:183], v[52:55], v[132:135], v[180:183]
  s_waitcnt vmcnt(14) lgkmcnt(0)
  v_mfma_f32_16x16x32_bf16 v[136:139], v[56:59], v[104:107], v[136:139]
  v_mfma_f32_16x16x32_bf16 v[140:143], v[56:59], v[108:111], v[140:143]
  buffer_load_dwordx4 v[52:55], v2, s[56:59], s65 offen offset:2048 sc1
  v_mfma_f32_16x16x32_bf16 v[144:147], v[56:59], v[112:115], v[144:147]
  ds_read_b128 v[120:123], v6 offset:15360
  v_mfma_f32_16x16x32_bf16 v[148:151], v[56:59], v[116:119], v[148:151]
  ds_read_b128 v[124:127], v6 offset:33792
  v_mfma_f32_16x16x32_bf16 v[152:155], v[60:63], v[104:107], v[152:155]
  s_add_u32 s65, s65, 36864
  v_mfma_f32_16x16x32_bf16 v[156:159], v[60:63], v[108:111], v[156:159]
  buffer_load_dwordx4 v[56:59], v2, s[56:59], s65 offen offset:0 sc1
  v_mfma_f32_16x16x32_bf16 v[160:163], v[60:63], v[112:115], v[160:163]
  ds_read_b128 v[128:131], v7 offset:15360
  v_mfma_f32_16x16x32_bf16 v[164:167], v[60:63], v[116:119], v[164:167]
  ds_read_b128 v[132:135], v7 offset:33792
  v_mfma_f32_16x16x32_bf16 v[168:171], v[64:67], v[104:107], v[168:171]
  v_mfma_f32_16x16x32_bf16 v[172:175], v[64:67], v[108:111], v[172:175]
  buffer_load_dwordx4 v[60:63], v2, s[56:59], s65 offen offset:1024 sc1
  v_mfma_f32_16x16x32_bf16 v[176:179], v[64:67], v[112:115], v[176:179]
  v_mfma_f32_16x16x32_bf16 v[180:183], v[64:67], v[116:119], v[180:183]
  s_waitcnt vmcnt(14) lgkmcnt(0)
  v_mfma_f32_16x16x32_bf16 v[136:139], v[68:71], v[120:123], v[136:139]
  v_mfma_f32_16x16x32_bf16 v[140:143], v[68:71], v[124:127], v[140:143]
  buffer_load_dwordx4 v[64:67], v2, s[56:59], s65 offen offset:2048 sc1
  v_mfma_f32_16x16x32_bf16 v[144:147], v[68:71], v[128:131], v[144:147]
  ds_read_b128 v[104:107], v6 offset:16384
  v_mfma_f32_16x16x32_bf16 v[148:151], v[68:71], v[132:135], v[148:151]
  ds_read_b128 v[108:111], v6 offset:34816
  v_mfma_f32_16x16x32_bf16 v[152:155], v[72:75], v[120:123], v[152:155]
  s_add_u32 s65, s65, 36864
  v_mfma_f32_16x16x32_bf16 v[156:159], v[72:75], v[124:127], v[156:159]
  buffer_load_dwordx4 v[68:71], v2, s[56:59], s65 offen offset:0 sc1
  v_mfma_f32_16x16x32_bf16 v[160:163], v[72:75], v[128:131], v[160:163]
  ds_read_b128 v[112:115], v7 offset:16384
  v_mfma_f32_16x16x32_bf16 v[164:167], v[72:75], v[132:135], v[164:167]
  ds_read_b128 v[116:119], v7 offset:34816
  v_mfma_f32_16x16x32_bf16 v[168:171], v[76:79], v[120:123], v[168:171]
  v_mfma_f32_16x16x32_bf16 v[172:175], v[76:79], v[124:127], v[172:175]
  buffer_load_dwordx4 v[72:75], v2, s[56:59], s65 offen offset:1024 sc1
  v_mfma_f32_16x16x32_bf16 v[176:179], v[76:79], v[128:131], v[176:179]
  v_mfma_f32_16x16x32_bf16 v[180:183], v[76:79], v[132:135], v[180:183]
  s_waitcnt vmcnt(14) lgkmcnt(0)
  v_mfma_f32_16x16x32_bf16 v[136:139], v[80:83], v[104:107], v[136:139]
  v_mfma_f32_16x16x32_bf16 v[140:143], v[80:83], v[108:111], v[140:143]
  buffer_load_dwordx4 v[76:79], v2, s[56:59], s65 offen offset:2048 sc1
  v_mfma_f32_16x16x32_bf16 v[144:147], v[80:83], v[112:115], v[144:147]
  ds_read_b128 v[120:123], v6 offset:17408
  v_mfma_f32_16x16x32_bf16 v[148:151], v[80:83], v[116:119], v[148:151]
  ds_read_b128 v[124:127], v6 offset:35840
  v_mfma_f32_16x16x32_bf16 v[152:155], v[84:87], v[104:107], v[152:155]
  s_add_u32 s65, s65, 36864
  v_mfma_f32_16x16x32_bf16 v[156:159], v[84:87], v[108:111], v[156:159]
  buffer_load_dwordx4 v[80:83], v2, s[56:59], s65 offen offset:0 sc1
  v_mfma_f32_16x16x32_bf16 v[160:163], v[84:87], v[112:115], v[160:163]
  ds_read_b128 v[128:131], v7 offset:17408
  v_mfma_f32_16x16x32_bf16 v[164:167], v[84:87], v[116:119], v[164:167]
  ds_read_b128 v[132:135], v7 offset:35840
  v_mfma_f32_16x16x32_bf16 v[168:171], v[88:91], v[104:107], v[168:171]
  v_mfma_f32_16x16x32_bf16 v[172:175], v[88:91], v[108:111], v[172:175]
  buffer_load_dwordx4 v[84:87], v2, s[56:59], s65 offen offset:1024 sc1
  v_mfma_f32_16x16x32_bf16 v[176:179], v[88:91], v[112:115], v[176:179]
  v_mfma_f32_16x16x32_bf16 v[180:183], v[88:91], v[116:119], v[180:183]
  s_waitcnt vmcnt(14) lgkmcnt(0)
  v_mfma_f32_16x16x32_bf16 v[136:139], v[92:95], v[120:123], v[136:139]
  v_mfma_f32_16x16x32_bf16 v[140:143], v[92:95], v[124:127], v[140:143]
  buffer_load_dwordx4 v[88:91], v2, s[56:59], s65 offen offset:2048 sc1
  v_mfma_f32_16x16x32_bf16 v[144:147], v[92:95], v[128:131], v[144:147]
  v_mfma_f32_16x16x32_bf16 v[148:151], v[92:95], v[132:135], v[148:151]
  v_mfma_f32_16x16x32_bf16 v[152:155], v[96:99], v[120:123], v[152:155]
  s_add_u32 s65, s65, 36864
  v_mfma_f32_16x16x32_bf16 v[156:159], v[96:99], v[124:127], v[156:159]
  buffer_load_dwordx4 v[92:95], v2, s[56:59], s65 offen offset:0 sc1
  v_mfma_f32_16x16x32_bf16 v[160:163], v[96:99], v[128:131], v[160:163]
  v_mfma_f32_16x16x32_bf16 v[164:167], v[96:99], v[132:135], v[164:167]
  v_mfma_f32_16x16x32_bf16 v[168:171], v[100:103], v[120:123], v[168:171]
  v_mfma_f32_16x16x32_bf16 v[172:175], v[100:103], v[124:127], v[172:175]
  buffer_load_dwordx4 v[96:99], v2, s[56:59], s65 offen offset:1024 sc1
  v_mfma_f32_16x16x32_bf16 v[176:179], v[100:103], v[128:131], v[176:179]
  v_mfma_f32_16x16x32_bf16 v[180:183], v[100:103], v[132:135], v[180:183]
  buffer_load_dwordx4 v[100:103], v2, s[56:59], s65 offen offset:2048 sc1
  s_setprio 0
LW_53:
  ds_read_b32 v5, v16 offset:16
  s_waitcnt lgkmcnt(0)
  v_readfirstlane_b32 s7, v5
  s_cmp_ge_u32 s7, 5
  s_cbranch_scc1 LD_54
  s_sleep 1
  s_branch LW_53
LD_54:
  v_and_b32 v5, 15, v1
  v_lshlrev_b32 v5, 4, v5
  v_add_u32 v5, 158720, v5
  ds_read_b32 v224, v5 offset:0
  ds_read_b32 v225, v5 offset:256
  ds_read_b32 v226, v5 offset:512
  ds_read_b32 v227, v5 offset:768
  s_waitcnt lgkmcnt(0)
  v_mul_f32 v216, 0xc0135761, v224
  v_mul_f32 v224, v224, v224
  v_mul_f32 v224, 0x3d372713, v224
  v_mul_f32 v217, v224, v216
  v_mul_f32 v218, 0xc0135761, v225
  v_mul_f32 v225, v225, v225
  v_mul_f32 v225, 0x3d372713, v225
  v_mul_f32 v219, v225, v218
  v_mul_f32 v220, 0xc0135761, v226
  v_mul_f32 v226, v226, v226
  v_mul_f32 v226, 0x3d372713, v226
  v_mul_f32 v221, v226, v220
  v_mul_f32 v222, 0xc0135761, v227
  v_mul_f32 v227, v227, v227
  v_mul_f32 v227, 0x3d372713, v227
  v_mul_f32 v223, v227, v222
  s_nop 7
  v_mul_f32 v224, v136, v136
  v_mul_f32 v225, v137, v137
  v_mul_f32 v226, v138, v138
  v_mul_f32 v227, v139, v139
  v_mul_f32 v228, v140, v140
  v_mul_f32 v229, v141, v141
  v_mul_f32 v230, v142, v142
  v_mul_f32 v231, v143, v143
  v_fma_f32 v224, v224, v217, v216
  v_fma_f32 v225, v225, v217, v216
  v_fma_f32 v226, v226, v217, v216
  v_fma_f32 v227, v227, v217, v216
  v_fma_f32 v228, v228, v219, v218
  v_fma_f32 v229, v229, v219, v218
  v_fma_f32 v230, v230, v219, v218
  v_fma_f32 v231, v231, v219, v218
  v_mul_f32 v224, v224, v136
  v_mul_f32 v225, v225, v137
  v_mul_f32 v226, v226, v138
  v_mul_f32 v227, v227, v139
  v_mul_f32 v228, v228, v140
  v_mul_f32 v229, v229, v141
  v_mul_f32 v230, v230, v142
  v_mul_f32 v231, v231, v143
  v_exp_f32 v224, v224
  v_exp_f32 v225, v225
  v_exp_f32 v226, v226
  v_exp_f32 v227, v227
  v_exp_f32 v228, v228
  v_exp_f32 v229, v229
  v_exp_f32 v230, v230
  v_exp_f32 v231, v231
  v_add_f32 v224, 1.0, v224
  v_add_f32 v225, 1.0, v225
  v_add_f32 v226, 1.0, v226
  v_add_f32 v227, 1.0, v227
  v_add_f32 v228, 1.0, v228
  v_add_f32 v229, 1.0, v229
  v_add_f32 v230, 1.0, v230
  v_add_f32 v231, 1.0, v231
  v_rcp_f32 v224, v224
  v_rcp_f32 v225, v225
  v_rcp_f32 v226, v226
  v_rcp_f32 v227, v227
  v_rcp_f32 v228, v228
  v_rcp_f32 v229, v229
  v_rcp_f32 v230, v230
  v_rcp_f32 v231, v231
  v_mul_f32 v136, v224, v136
  v_mul_f32 v137, v225, v137
  v_mul_f32 v138, v226, v138
  v_mul_f32 v139, v227, v139
  v_mul_f32 v140, v228, v140
  v_mul_f32 v141, v229, v141
  v_mul_f32 v142, v230, v142
  v_mul_f32 v143, v231, v143
  v_cvt_pk_bf16_f32 v232, v136, v137
  v_cvt_pk_bf16_f32 v233, v138, v139
  v_cvt_pk_bf16_f32 v234, v140, v141
  v_cvt_pk_bf16_f32 v235, v142, v143
  ds_write_b64 v10, v[232:233] offset:0
  ds_write_b64 v10, v[234:235] offset:18432
  v_mul_f32 v224, v144, v144
  v_mul_f32 v225, v145, v145
  v_mul_f32 v226, v146, v146
  v_mul_f32 v227, v147, v147
  v_mul_f32 v228, v148, v148
  v_mul_f32 v229, v149, v149
  v_mul_f32 v230, v150, v150
  v_mul_f32 v231, v151, v151
  v_fma_f32 v224, v224, v221, v220
  v_fma_f32 v225, v225, v221, v220
  v_fma_f32 v226, v226, v221, v220
  v_fma_f32 v227, v227, v221, v220
  v_fma_f32 v228, v228, v223, v222
  v_fma_f32 v229, v229, v223, v222
  v_fma_f32 v230, v230, v223, v222
  v_fma_f32 v231, v231, v223, v222
  v_mul_f32 v224, v224, v144
  v_mul_f32 v225, v225, v145
  v_mul_f32 v226, v226, v146
  v_mul_f32 v227, v227, v147
  v_mul_f32 v228, v228, v148
  v_mul_f32 v229, v229, v149
  v_mul_f32 v230, v230, v150
  v_mul_f32 v231, v231, v151
  v_exp_f32 v224, v224
  v_exp_f32 v225, v225
  v_exp_f32 v226, v226
  v_exp_f32 v227, v227
  v_exp_f32 v228, v228
  v_exp_f32 v229, v229
  v_exp_f32 v230, v230
  v_exp_f32 v231, v231
  v_add_f32 v224, 1.0, v224
  v_add_f32 v225, 1.0, v225
  v_add_f32 v226, 1.0, v226
  v_add_f32 v227, 1.0, v227
  v_add_f32 v228, 1.0, v228
  v_add_f32 v229, 1.0, v229
  v_add_f32 v230, 1.0, v230
  v_add_f32 v231, 1.0, v231
  v_rcp_f32 v224, v224
  v_rcp_f32 v225, v225
  v_rcp_f32 v226, v226
  v_rcp_f32 v227, v227
  v_rcp_f32 v228, v228
  v_rcp_f32 v229, v229
  v_rcp_f32 v230, v230
  v_rcp_f32 v231, v231
  v_mul_f32 v144, v224, v144
  v_mul_f32 v145, v225, v145
  v_mul_f32 v146, v226, v146
  v_mul_f32 v147, v227, v147
  v_mul_f32 v148, v228, v148
  v_mul_f32 v149, v229, v149
  v_mul_f32 v150, v230, v150
  v_mul_f32 v151, v231, v151
  v_cvt_pk_bf16_f32 v236, v144, v145
  v_cvt_pk_bf16_f32 v237, v146, v147
  v_cvt_pk_bf16_f32 v238, v148, v149
  v_cvt_pk_bf16_f32 v239, v150, v151
  ds_write_b64 v11, v[236:237] offset:0
  ds_write_b64 v11, v[238:239] offset:18432
  v_mul_f32 v224, v152, v152
  v_mul_f32 v225, v153, v153
  v_mul_f32 v226, v154, v154
  v_mul_f32 v227, v155, v155
  v_mul_f32 v228, v156, v156
  v_mul_f32 v229, v157, v157
  v_mul_f32 v230, v158, v158
  v_mul_f32 v231, v159, v159
  v_fma_f32 v224, v224, v217, v216
  v_fma_f32 v225, v225, v217, v216
  v_fma_f32 v226, v226, v217, v216
  v_fma_f32 v227, v227, v217, v216
  v_fma_f32 v228, v228, v219, v218
  v_fma_f32 v229, v229, v219, v218
  v_fma_f32 v230, v230, v219, v218
  v_fma_f32 v231, v231, v219, v218
  v_mul_f32 v224, v224, v152
  v_mul_f32 v225, v225, v153
  v_mul_f32 v226, v226, v154
  v_mul_f32 v227, v227, v155
  v_mul_f32 v228, v228, v156
  v_mul_f32 v229, v229, v157
  v_mul_f32 v230, v230, v158
  v_mul_f32 v231, v231, v159
  v_exp_f32 v224, v224
  v_exp_f32 v225, v225
  v_exp_f32 v226, v226
  v_exp_f32 v227, v227
  v_exp_f32 v228, v228
  v_exp_f32 v229, v229
  v_exp_f32 v230, v230
  v_exp_f32 v231, v231
  v_add_f32 v224, 1.0, v224
  v_add_f32 v225, 1.0, v225
  v_add_f32 v226, 1.0, v226
  v_add_f32 v227, 1.0, v227
  v_add_f32 v228, 1.0, v228
  v_add_f32 v229, 1.0, v229
  v_add_f32 v230, 1.0, v230
  v_add_f32 v231, 1.0, v231
  v_rcp_f32 v224, v224
  v_rcp_f32 v225, v225
  v_rcp_f32 v226, v226
  v_rcp_f32 v227, v227
  v_rcp_f32 v228, v228
  v_rcp_f32 v229, v229
  v_rcp_f32 v230, v230
  v_rcp_f32 v231, v231
  v_mul_f32 v152, v224, v152
  v_mul_f32 v153, v225, v153
  v_mul_f32 v154, v226, v154
  v_mul_f32 v155, v227, v155
  v_mul_f32 v156, v228, v156
  v_mul_f32 v157, v229, v157
  v_mul_f32 v158, v230, v158
  v_mul_f32 v159, v231, v159
  v_cvt_pk_bf16_f32 v232, v152, v153
  v_cvt_pk_bf16_f32 v233, v154, v155
  v_cvt_pk_bf16_f32 v234, v156, v157
  v_cvt_pk_bf16_f32 v235, v158, v159
  ds_write_b64 v12, v[232:233] offset:0
  ds_write_b64 v12, v[234:235] offset:18432
  v_mul_f32 v224, v160, v160
  v_mul_f32 v225, v161, v161
  v_mul_f32 v226, v162, v162
  v_mul_f32 v227, v163, v163
  v_mul_f32 v228, v164, v164
  v_mul_f32 v229, v165, v165
  v_mul_f32 v230, v166, v166
  v_mul_f32 v231, v167, v167
  v_fma_f32 v224, v224, v221, v220
  v_fma_f32 v225, v225, v221, v220
  v_fma_f32 v226, v226, v221, v220
  v_fma_f32 v227, v227, v221, v220
  v_fma_f32 v228, v228, v223, v222
  v_fma_f32 v229, v229, v223, v222
  v_fma_f32 v230, v230, v223, v222
  v_fma_f32 v231, v231, v223, v222
  v_mul_f32 v224, v224, v160
  v_mul_f32 v225, v225, v161
  v_mul_f32 v226, v226, v162
  v_mul_f32 v227, v227, v163
  v_mul_f32 v228, v228, v164
  v_mul_f32 v229, v229, v165
  v_mul_f32 v230, v230, v166
  v_mul_f32 v231, v231, v167
  v_exp_f32 v224, v224
  v_exp_f32 v225, v225
  v_exp_f32 v226, v226
  v_exp_f32 v227, v227
  v_exp_f32 v228, v228
  v_exp_f32 v229, v229
  v_exp_f32 v230, v230
  v_exp_f32 v231, v231
  v_add_f32 v224, 1.0, v224
  v_add_f32 v225, 1.0, v225
  v_add_f32 v226, 1.0, v226
  v_add_f32 v227, 1.0, v227
  v_add_f32 v228, 1.0, v228
  v_add_f32 v229, 1.0, v229
  v_add_f32 v230, 1.0, v230
  v_add_f32 v231, 1.0, v231
  v_rcp_f32 v224, v224
  v_rcp_f32 v225, v225
  v_rcp_f32 v226, v226
  v_rcp_f32 v227, v227
  v_rcp_f32 v228, v228
  v_rcp_f32 v229, v229
  v_rcp_f32 v230, v230
  v_rcp_f32 v231, v231
  v_mul_f32 v160, v224, v160
  v_mul_f32 v161, v225, v161
  v_mul_f32 v162, v226, v162
  v_mul_f32 v163, v227, v163
  v_mul_f32 v164, v228, v164
  v_mul_f32 v165, v229, v165
  v_mul_f32 v166, v230, v166
  v_mul_f32 v167, v231, v167
  v_cvt_pk_bf16_f32 v236, v160, v161
  v_cvt_pk_bf16_f32 v237, v162, v163
  v_cvt_pk_bf16_f32 v238, v164, v165
  v_cvt_pk_bf16_f32 v239, v166, v167
  ds_write_b64 v13, v[236:237] offset:0
  ds_write_b64 v13, v[238:239] offset:18432
  v_mul_f32 v224, v168, v168
  v_mul_f32 v225, v169, v169
  v_mul_f32 v226, v170, v170
  v_mul_f32 v227, v171, v171
  v_mul_f32 v228, v172, v172
  v_mul_f32 v229, v173, v173
  v_mul_f32 v230, v174, v174
  v_mul_f32 v231, v175, v175
  v_fma_f32 v224, v224, v217, v216
  v_fma_f32 v225, v225, v217, v216
  v_fma_f32 v226, v226, v217, v216
  v_fma_f32 v227, v227, v217, v216
  v_fma_f32 v228, v228, v219, v218
  v_fma_f32 v229, v229, v219, v218
  v_fma_f32 v230, v230, v219, v218
  v_fma_f32 v231, v231, v219, v218
  v_mul_f32 v224, v224, v168
  v_mul_f32 v225, v225, v169
  v_mul_f32 v226, v226, v170
  v_mul_f32 v227, v227, v171
  v_mul_f32 v228, v228, v172
  v_mul_f32 v229, v229, v173
  v_mul_f32 v230, v230, v174
  v_mul_f32 v231, v231, v175
  v_exp_f32 v224, v224
  v_exp_f32 v225, v225
  v_exp_f32 v226, v226
  v_exp_f32 v227, v227
  v_exp_f32 v228, v228
  v_exp_f32 v229, v229
  v_exp_f32 v230, v230
  v_exp_f32 v231, v231
  v_add_f32 v224, 1.0, v224
  v_add_f32 v225, 1.0, v225
  v_add_f32 v226, 1.0, v226
  v_add_f32 v227, 1.0, v227
  v_add_f32 v228, 1.0, v228
  v_add_f32 v229, 1.0, v229
  v_add_f32 v230, 1.0, v230
  v_add_f32 v231, 1.0, v231
  v_rcp_f32 v224, v224
  v_rcp_f32 v225, v225
  v_rcp_f32 v226, v226
  v_rcp_f32 v227, v227
  v_rcp_f32 v228, v228
  v_rcp_f32 v229, v229
  v_rcp_f32 v230, v230
  v_rcp_f32 v231, v231
  v_mul_f32 v168, v224, v168
  v_mul_f32 v169, v225, v169
  v_mul_f32 v170, v226, v170
  v_mul_f32 v171, v227, v171
  v_mul_f32 v172, v228, v172
  v_mul_f32 v173, v229, v173
  v_mul_f32 v174, v230, v174
  v_mul_f32 v175, v231, v175
  v_cvt_pk_bf16_f32 v232, v168, v169
  v_cvt_pk_bf16_f32 v233, v170, v171
  v_cvt_pk_bf16_f32 v234, v172, v173
  v_cvt_pk_bf16_f32 v235, v174, v175
  ds_write_b64 v10, v[232:233] offset:1024
  ds_write_b64 v10, v[234:235] offset:19456
  v_mul_f32 v224, v176, v176
  v_mul_f32 v225, v177, v177
  v_mul_f32 v226, v178, v178
  v_mul_f32 v227, v179, v179
  v_mul_f32 v228, v180, v180
  v_mul_f32 v229, v181, v181
  v_mul_f32 v230, v182, v182
  v_mul_f32 v231, v183, v183
  v_fma_f32 v224, v224, v221, v220
  v_fma_f32 v225, v225, v221, v220
  v_fma_f32 v226, v226, v221, v220
  v_fma_f32 v227, v227, v221, v220
  v_fma_f32 v228, v228, v223, v222
  v_fma_f32 v229, v229, v223, v222
  v_fma_f32 v230, v230, v223, v222
  v_fma_f32 v231, v231, v223, v222
  v_mul_f32 v224, v224, v176
  v_mul_f32 v225, v225, v177
  v_mul_f32 v226, v226, v178
  v_mul_f32 v227, v227, v179
  v_mul_f32 v228, v228, v180
  v_mul_f32 v229, v229, v181
  v_mul_f32 v230, v230, v182
  v_mul_f32 v231, v231, v183
  v_exp_f32 v224, v224
  v_exp_f32 v225, v225
  v_exp_f32 v226, v226
  v_exp_f32 v227, v227
  v_exp_f32 v228, v228
  v_exp_f32 v229, v229
  v_exp_f32 v230, v230
  v_exp_f32 v231, v231
  v_add_f32 v224, 1.0, v224
  v_add_f32 v225, 1.0, v225
  v_add_f32 v226, 1.0, v226
  v_add_f32 v227, 1.0, v227
  v_add_f32 v228, 1.0, v228
  v_add_f32 v229, 1.0, v229
  v_add_f32 v230, 1.0, v230
  v_add_f32 v231, 1.0, v231
  v_rcp_f32 v224, v224
  v_rcp_f32 v225, v225
  v_rcp_f32 v226, v226
  v_rcp_f32 v227, v227
  v_rcp_f32 v228, v228
  v_rcp_f32 v229, v229
  v_rcp_f32 v230, v230
  v_rcp_f32 v231, v231
  v_mul_f32 v176, v224, v176
  v_mul_f32 v177, v225, v177
  v_mul_f32 v178, v226, v178
  v_mul_f32 v179, v227, v179
  v_mul_f32 v180, v228, v180
  v_mul_f32 v181, v229, v181
  v_mul_f32 v182, v230, v182
  v_mul_f32 v183, v231, v183
  v_cvt_pk_bf16_f32 v236, v176, v177
  v_cvt_pk_bf16_f32 v237, v178, v179
  v_cvt_pk_bf16_f32 v238, v180, v181
  v_cvt_pk_bf16_f32 v239, v182, v183
  ds_write_b64 v11, v[236:237] offset:1024
  ds_write_b64 v11, v[238:239] offset:19456
  s_mov_b64 exec, 1
  ds_add_u32 v16, v17 offset:20
  s_mov_b64 exec, -1
  s_add_u32 s71, s71, 24
  s_add_u32 s12, s71, 0
  s_lshr_b32 s13, s12, 1
  s_lshl_b32 s13, s13, 10
  s_and_b32 s12, s12, 1
  s_lshl_b32 s12, s12, 3
  s_add_u32 s12, s12, s13
  s_add_u32 s12, s12, 73728
  v_add_u32 v10, s12, v2
  v_add_u32 v11, 36864, v10
  s_add_u32 s12, s71, 1
  s_lshr_b32 s13, s12, 1
  s_lshl_b32 s13, s13, 10
  s_and_b32 s12, s12, 1
  s_lshl_b32 s12, s12, 3
  s_add_u32 s12, s12, s13
  s_add_u32 s12, s12, 73728
  v_add_u32 v12, s12, v2
  v_add_u32 v13, 36864, v12
  s_mul_i32 s6, s4, 9
  s_lshr_b32 s6, s6, 1
  s_and_b32 s7, s3, 3
  s_mul_i32 s8, s7, 3
  s_add_u32 s8, s8, 4
  s_mul_i32 s9, s7, 5
  s_add_u32 s9, s9, 16
  s_cmp_ge_u32 s3, 4
  s_cselect_b32 s8, s9, s8
  s_add_u32 s8, s8, s6
  v_add_u32 v29, s8, v1
  v_subrev_u32 v5, 36, v29
  v_min_u32 v29, v29, v5
  s_add_u32 s9, s8, 0
  s_sub_u32 s10, s9, 36
  s_min_u32 s9, s9, s10
  s_lshl_b32 s44, s9, 10
  v_add_u32 v24, s44, v2
  s_add_u32 s9, s8, 1
  s_sub_u32 s10, s9, 36
  s_min_u32 s9, s9, s10
  s_lshl_b32 s45, s9, 10
  v_add_u32 v25, s45, v2
  s_add_u32 s9, s8, 2
  s_sub_u32 s10, s9, 36
  s_min_u32 s9, s9, s10
  s_lshl_b32 s46, s9, 10
  v_add_u32 v26, s46, v2
  s_add_u32 s9, s8, 3
  s_add_u32 s10, s6, s7
  s_cmp_lt_u32 s3, 4
  s_cselect_b32 s9, s10, s9
  s_sub_u32 s10, s9, 36
  s_min_u32 s9, s9, s10
  s_lshl_b32 s47, s9, 10
  v_add_u32 v27, s47, v2
  s_add_u32 s9, s8, 4
  s_sub_u32 s10, s9, 36
  s_min_u32 s9, s9, s10
  s_lshl_b32 s48, s9, 10
  v_add_u32 v28, s48, v2
  v_lshl_add_u32 v5, v29, 1, 1
  v_mul_u32_u24 v5, 57, v5
  v_lshrrev_b32 v5, 9, v5
  v_subrev_u32 v5, s4, v5
  v_and_b32 v5, 7, v5
  v_lshlrev_b32 v5, 2, v5
  v_lshl_add_u32 v29, v29, 5, v5
  s_mul_i32 s66, s4, 663552
  s_add_u32 s66, s66, 15794176
  s_mov_b32 s68, s66
  s_lshl_b32 s10, s4, 5
  s_add_u32 s10, s10, s5
  s_mul_i32 s67, s10, 73728
  s_add_u32 s67, s67, 21102592
  s_mul_i32 s69, s5, 1152
  s_add_u32 s69, s69, 9702400
  s_setprio 1
  ds_read_b128 v[104:107], v6 offset:0
  ds_read_b128 v[108:111], v6 offset:18432
  ds_read_b128 v[112:115], v7 offset:0
  ds_read_b128 v[116:119], v7 offset:18432
  s_waitcnt vmcnt(15) lgkmcnt(0)
  v_mfma_f32_16x16x32_bf16 v[136:139], v[32:35], v[104:107], 0
  v_mfma_f32_16x16x32_bf16 v[140:143], v[32:35], v[108:111], 0
  v_mfma_f32_16x16x32_bf16 v[144:147], v[32:35], v[112:115], 0
  ds_read_b128 v[120:123], v6 offset:1024
  v_mfma_f32_16x16x32_bf16 v[148:151], v[32:35], v[116:119], 0
  ds_read_b128 v[124:127], v6 offset:19456
  v_mfma_f32_16x16x32_bf16 v[152:155], v[36:39], v[104:107], 0
  s_add_u32 s65, s65, 36864
  v_mfma_f32_16x16x32_bf16 v[156:159], v[36:39], v[108:111], 0
  buffer_load_dwordx4 v[32:35], v2, s[56:59], s65 offen offset:0 sc1
  v_mfma_f32_16x16x32_bf16 v[160:163], v[36:39], v[112:115], 0
  ds_read_b128 v[128:131], v7 offset:1024
  v_mfma_f32_16x16x32_bf16 v[164:167], v[36:39], v[116:119], 0
  ds_read_b128 v[132:135], v7 offset:19456
  v_mfma_f32_16x16x32_bf16 v[168:171], v[40:43], v[104:107], 0
  v_mfma_f32_16x16x32_bf16 v[172:175], v[40:43], v[108:111], 0
  buffer_load_dwordx4 v[36:39], v2, s[56:59], s65 offen offset:1024 sc1
  v_mfma_f32_16x16x32_bf16 v[176:179], v[40:43], v[112:115], 0
  v_mfma_f32_16x16x32_bf16 v[180:183], v[40:43], v[116:119], 0
  s_waitcnt vmcnt(14) lgkmcnt(0)
  v_mfma_f32_16x16x32_bf16 v[136:139], v[44:47], v[120:123], v[136:139]
  v_mfma_f32_16x16x32_bf16 v[140:143], v[44:47], v[124:127], v[140:143]
  buffer_load_dwordx4 v[40:43], v2, s[56:59], s65 offen offset:2048 sc1
  v_mfma_f32_16x16x32_bf16 v[144:147], v[44:47], v[128:131], v[144:147]
  ds_read_b128 v[104:107], v6 offset:2048
  v_mfma_f32_16x16x32_bf16 v[148:151], v[44:47], v[132:135], v[148:151]
  ds_read_b128 v[108:111], v6 offset:20480
  v_mfma_f32_16x16x32_bf16 v[152:155], v[48:51], v[120:123], v[152:155]
  s_add_u32 s65, s65, 36864
  v_mfma_f32_16x16x32_bf16 v[156:159], v[48:51], v[124:127], v[156:159]
  buffer_load_dwordx4 v[44:47], v2, s[56:59], s65 offen offset:0 sc1
  v_mfma_f32_16x16x32_bf16 v[160:163], v[48:51], v[128:131], v[160:163]
  ds_read_b128 v[112:115], v7 offset:2048
  v_mfma_f32_16x16x32_bf16 v[164:167], v[48:51], v[132:135], v[164:167]
  ds_read_b128 v[116:119], v7 offset:20480
  v_mfma_f32_16x16x32_bf16 v[168:171], v[52:55], v[120:123], v[168:171]
  v_mfma_f32_16x16x32_bf16 v[172:175], v[52:55], v[124:127], v[172:175]
  buffer_load_dwordx4 v[48:51], v2, s[56:59], s65 offen offset:1024 sc1
  v_mfma_f32_16x16x32_bf16 v[176:179], v[52:55], v[128:131], v[176:179]
  v_mfma_f32_16x16x32_bf16 v[180:183], v[52:55], v[132:135], v[180:183]
  s_waitcnt vmcnt(14) lgkmcnt(0)
  v_mfma_f32_16x16x32_bf16 v[136:139], v[56:59], v[104:107], v[136:139]
  v_mfma_f32_16x16x32_bf16 v[140:143], v[56:59], v[108:111], v[140:143]
  buffer_load_dwordx4 v[52:55], v2, s[56:59], s65 offen offset:2048 sc1
  v_mfma_f32_16x16x32_bf16 v[144:147], v[56:59], v[112:115], v[144:147]
  ds_read_b128 v[120:123], v6 offset:3072
  v_mfma_f32_16x16x32_bf16 v[148:151], v[56:59], v[116:119], v[148:151]
  ds_read_b128 v[124:127], v6 offset:21504
  v_mfma_f32_16x16x32_bf16 v[152:155], v[60:63], v[104:107], v[152:155]
  s_add_u32 s65, s65, 36864
  v_mfma_f32_16x16x32_bf16 v[156:159], v[60:63], v[108:111], v[156:159]
  buffer_load_dwordx4 v[56:59], v2, s[56:59], s65 offen offset:0 sc1
  v_mfma_f32_16x16x32_bf16 v[160:163], v[60:63], v[112:115], v[160:163]
  ds_read_b128 v[128:131], v7 offset:3072
  v_mfma_f32_16x16x32_bf16 v[164:167], v[60:63], v[116:119], v[164:167]
  ds_read_b128 v[132:135], v7 offset:21504
  v_mfma_f32_16x16x32_bf16 v[168:171], v[64:67], v[104:107], v[168:171]
  v_mfma_f32_16x16x32_bf16 v[172:175], v[64:67], v[108:111], v[172:175]
  buffer_load_dwordx4 v[60:63], v2, s[56:59], s65 offen offset:1024 sc1
  v_mfma_f32_16x16x32_bf16 v[176:179], v[64:67], v[112:115], v[176:179]
  v_mfma_f32_16x16x32_bf16 v[180:183], v[64:67], v[116:119], v[180:183]
  s_waitcnt vmcnt(14) lgkmcnt(0)
  v_mfma_f32_16x16x32_bf16 v[136:139], v[68:71], v[120:123], v[136:139]
  v_mfma_f32_16x16x32_bf16 v[140:143], v[68:71], v[124:127], v[140:143]
  buffer_load_dwordx4 v[64:67], v2, s[56:59], s65 offen offset:2048 sc1
  v_mfma_f32_16x16x32_bf16 v[144:147], v[68:71], v[128:131], v[144:147]
  ds_read_b128 v[104:107], v6 offset:4096
  v_mfma_f32_16x16x32_bf16 v[148:151], v[68:71], v[132:135], v[148:151]
  ds_read_b128 v[108:111], v6 offset:22528
  v_mfma_f32_16x16x32_bf16 v[152:155], v[72:75], v[120:123], v[152:155]
  s_add_u32 s65, s65, 36864
  v_mfma_f32_16x16x32_bf16 v[156:159], v[72:75], v[124:127], v[156:159]
  buffer_load_dwordx4 v[68:71], v2, s[56:59], s65 offen offset:0 sc1
  v_mfma_f32_16x16x32_bf16 v[160:163], v[72:75], v[128:131], v[160:163]
  ds_read_b128 v[112:115], v7 offset:4096
  v_mfma_f32_16x16x32_bf16 v[164:167], v[72:75], v[132:135], v[164:167]
  ds_read_b128 v[116:119], v7 offset:22528
  v_mfma_f32_16x16x32_bf16 v[168:171], v[76:79], v[120:123], v[168:171]
  v_mfma_f32_16x16x32_bf16 v[172:175], v[76:79], v[124:127], v[172:175]
  buffer_load_dwordx4 v[72:75], v2, s[56:59], s65 offen offset:1024 sc1
  v_mfma_f32_16x16x32_bf16 v[176:179], v[76:79], v[128:131], v[176:179]
  v_mfma_f32_16x16x32_bf16 v[180:183], v[76:79], v[132:135], v[180:183]
  s_waitcnt vmcnt(14) lgkmcnt(0)
  v_mfma_f32_16x16x32_bf16 v[136:139], v[80:83], v[104:107], v[136:139]
  v_mfma_f32_16x16x32_bf16 v[140:143], v[80:83], v[108:111], v[140:143]
  buffer_load_dwordx4 v[76:79], v2, s[56:59], s65 offen offset:2048 sc1
  v_mfma_f32_16x16x32_bf16 v[144:147], v[80:83], v[112:115], v[144:147]
  ds_read_b128 v[120:123], v6 offset:5120
  v_mfma_f32_16x16x32_bf16 v[148:151], v[80:83], v[116:119], v[148:151]
  ds_read_b128 v[124:127], v6 offset:23552
  v_mfma_f32_16x16x32_bf16 v[152:155], v[84:87], v[104:107], v[152:155]
  s_add_u32 s65, s65, 36864
  v_mfma_f32_16x16x32_bf16 v[156:159], v[84:87], v[108:111], v[156:159]
  buffer_load_dwordx4 v[80:83], v2, s[56:59], s65 offen offset:0 sc1
  v_mfma_f32_16x16x32_bf16 v[160:163], v[84:87], v[112:115], v[160:163]
  ds_read_b128 v[128:131], v7 offset:5120
  v_mfma_f32_16x16x32_bf16 v[164:167], v[84:87], v[116:119], v[164:167]
  ds_read_b128 v[132:135], v7 offset:23552
  v_mfma_f32_16x16x32_bf16 v[168:171], v[88:91], v[104:107], v[168:171]
  v_mfma_f32_16x16x32_bf16 v[172:175], v[88:91], v[108:111], v[172:175]
  buffer_load_dwordx4 v[84:87], v2, s[56:59], s65 offen offset:1024 sc1
  v_mfma_f32_16x16x32_bf16 v[176:179], v[88:91], v[112:115], v[176:179]
  v_mfma_f32_16x16x32_bf16 v[180:183], v[88:91], v[116:119], v[180:183]
  s_waitcnt vmcnt(14) lgkmcnt(0)
  v_mfma_f32_16x16x32_bf16 v[136:139], v[92:95], v[120:123], v[136:139]
  v_mfma_f32_16x16x32_bf16 v[140:143], v[92:95], v[124:127], v[140:143]
  buffer_load_dwordx4 v[88:91], v2, s[56:59], s65 offen offset:2048 sc1
  v_mfma_f32_16x16x32_bf16 v[144:147], v[92:95], v[128:131], v[144:147]
  ds_read_b128 v[104:107], v6 offset:6144
  v_mfma_f32_16x16x32_bf16 v[148:151], v[92:95], v[132:135], v[148:151]
  ds_read_b128 v[108:111], v6 offset:24576
  v_mfma_f32_16x16x32_bf16 v[152:155], v[96:99], v[120:123], v[152:155]
  s_add_u32 s65, s65, 36864
  v_mfma_f32_16x16x32_bf16 v[156:159], v[96:99], v[124:127], v[156:159]
  buffer_load_dwordx4 v[92:95], v2, s[56:59], s65 offen offset:0 sc1
  v_mfma_f32_16x16x32_bf16 v[160:163], v[96:99], v[128:131], v[160:163]
  ds_read_b128 v[112:115], v7 offset:6144
  v_mfma_f32_16x16x32_bf16 v[164:167], v[96:99], v[132:135], v[164:167]
  ds_read_b128 v[116:119], v7 offset:24576
  v_mfma_f32_16x16x32_bf16 v[168:171], v[100:103], v[120:123], v[168:171]
  v_mfma_f32_16x16x32_bf16 v[172:175], v[100:103], v[124:127], v[172:175]
  buffer_load_dwordx4 v[96:99], v2, s[56:59], s65 offen offset:1024 sc1
  v_mfma_f32_16x16x32_bf16 v[176:179], v[100:103], v[128:131], v[176:179]
  v_mfma_f32_16x16x32_bf16 v[180:183], v[100:103], v[132:135], v[180:183]
  s_waitcnt vmcnt(14) lgkmcnt(0)
  v_mfma_f32_16x16x32_bf16 v[136:139], v[32:35], v[104:107], v[136:139]
  v_mfma_f32_16x16x32_bf16 v[140:143], v[32:35], v[108:111], v[140:143]
  buffer_load_dwordx4 v[100:103], v2, s[56:59], s65 offen offset:2048 sc1
  v_mfma_f32_16x16x32_bf16 v[144:147], v[32:35], v[112:115], v[144:147]
  ds_read_b128 v[120:123], v6 offset:7168
  v_mfma_f32_16x16x32_bf16 v[148:151], v[32:35], v[116:119], v[148:151]
  ds_read_b128 v[124:127], v6 offset:25600
  v_mfma_f32_16x16x32_bf16 v[152:155], v[36:39], v[104:107], v[152:155]
  s_add_u32 s65, s65, 36864
  v_mfma_f32_16x16x32_bf16 v[156:159], v[36:39], v[108:111], v[156:159]
  buffer_load_dwordx4 v[32:35], v2, s[56:59], s65 offen offset:0 sc1
  v_mfma_f32_16x16x32_bf16 v[160:163], v[36:39], v[112:115], v[160:163]
  ds_read_b128 v[128:131], v7 offset:7168
  v_mfma_f32_16x16x32_bf16 v[164:167], v[36:39], v[116:119], v[164:167]
  ds_read_b128 v[132:135], v7 offset:25600
  v_mfma_f32_16x16x32_bf16 v[168:171], v[40:43], v[104:107], v[168:171]
  v_mfma_f32_16x16x32_bf16 v[172:175], v[40:43], v[108:111], v[172:175]
  buffer_load_dwordx4 v[36:39], v2, s[56:59], s65 offen offset:1024 sc1
  v_mfma_f32_16x16x32_bf16 v[176:179], v[40:43], v[112:115], v[176:179]
  v_mfma_f32_16x16x32_bf16 v[180:183], v[40:43], v[116:119], v[180:183]
  s_waitcnt vmcnt(14) lgkmcnt(0)
  v_mfma_f32_16x16x32_bf16 v[136:139], v[44:47], v[120:123], v[136:139]
  v_mfma_f32_16x16x32_bf16 v[140:143], v[44:47], v[124:127], v[140:143]
  buffer_load_dwordx4 v[40:43], v2, s[56:59], s65 offen offset:2048 sc1
  v_mfma_f32_16x16x32_bf16 v[144:147], v[44:47], v[128:131], v[144:147]
  ds_read_b128 v[104:107], v6 offset:8192
  v_mfma_f32_16x16x32_bf16 v[148:151], v[44:47], v[132:135], v[148:151]
  ds_read_b128 v[108:111], v6 offset:26624
  v_mfma_f32_16x16x32_bf16 v[152:155], v[48:51], v[120:123], v[152:155]
  s_add_u32 s65, s65, 36864
  v_mfma_f32_16x16x32_bf16 v[156:159], v[48:51], v[124:127], v[156:159]
  buffer_load_dwordx4 v[44:47], v2, s[56:59], s65 offen offset:0 sc1
  v_mfma_f32_16x16x32_bf16 v[160:163], v[48:51], v[128:131], v[160:163]
  ds_read_b128 v[112:115], v7 offset:8192
  v_mfma_f32_16x16x32_bf16 v[164:167], v[48:51], v[132:135], v[164:167]
  ds_read_b128 v[116:119], v7 offset:26624
  v_mfma_f32_16x16x32_bf16 v[168:171], v[52:55], v[120:123], v[168:171]
  v_mfma_f32_16x16x32_bf16 v[172:175], v[52:55], v[124:127], v[172:175]
  buffer_load_dwordx4 v[48:51], v2, s[56:59], s65 offen offset:1024 sc1
  v_mfma_f32_16x16x32_bf16 v[176:179], v[52:55], v[128:131], v[176:179]
  v_mfma_f32_16x16x32_bf16 v[180:183], v[52:55], v[132:135], v[180:183]
  s_waitcnt vmcnt(14) lgkmcnt(0)
  v_mfma_f32_16x16x32_bf16 v[136:139], v[56:59], v[104:107], v[136:139]
  v_mfma_f32_16x16x32_bf16 v[140:143], v[56:59], v[108:111], v[140:143]
  buffer_load_dwordx4 v[52:55], v2, s[56:59], s65 offen offset:2048 sc1
  v_mfma_f32_16x16x32_bf16 v[144:147], v[56:59], v[112:115], v[144:147]
  ds_read_b128 v[120:123], v6 offset:9216
  v_mfma_f32_16x16x32_bf16 v[148:151], v[56:59], v[116:119], v[148:151]
  ds_read_b128 v[124:127], v6 offset:27648
  v_mfma_f32_16x16x32_bf16 v[152:155], v[60:63], v[104:107], v[152:155]
  s_add_u32 s65, s65, 36864
  v_mfma_f32_16x16x32_bf16 v[156:159], v[60:63], v[108:111], v[156:159]
  buffer_load_dwordx4 v[56:59], v2, s[56:59], s65 offen offset:0 sc1
  v_mfma_f32_16x16x32_bf16 v[160:163], v[60:63], v[112:115], v[160:163]
  ds_read_b128 v[128:131], v7 offset:9216
  v_mfma_f32_16x16x32_bf16 v[164:167], v[60:63], v[116:119], v[164:167]
  ds_read_b128 v[132:135], v7 offset:27648
  v_mfma_f32_16x16x32_bf16 v[168:171], v[64:67], v[104:107], v[168:171]
  v_mfma_f32_16x16x32_bf16 v[172:175], v[64:67], v[108:111], v[172:175]
  buffer_load_dwordx4 v[60:63], v2, s[56:59], s65 offen offset:1024 sc1
  v_mfma_f32_16x16x32_bf16 v[176:179], v[64:67], v[112:115], v[176:179]
  v_mfma_f32_16x16x32_bf16 v[180:183], v[64:67], v[116:119], v[180:183]
  s_waitcnt vmcnt(14) lgkmcnt(0)
  v_mfma_f32_16x16x32_bf16 v[136:139], v[68:71], v[120:123], v[136:139]
  v_mfma_f32_16x16x32_bf16 v[140:143], v[68:71], v[124:127], v[140:143]
  buffer_load_dwordx4 v[64:67], v2, s[56:59], s65 offen offset:2048 sc1
  v_mfma_f32_16x16x32_bf16 v[144:147], v[68:71], v[128:131], v[144:147]
  ds_read_b128 v[104:107], v6 offset:10240
  v_mfma_f32_16x16x32_bf16 v[148:151], v[68:71], v[132:135], v[148:151]
  ds_read_b128 v[108:111], v6 offset:28672
  v_mfma_f32_16x16x32_bf16 v[152:155], v[72:75], v[120:123], v[152:155]
  s_add_u32 s65, s65, 36864
  v_mfma_f32_16x16x32_bf16 v[156:159], v[72:75], v[124:127], v[156:159]
  buffer_load_dwordx4 v[68:71], v2, s[56:59], s65 offen offset:0 sc1
  v_mfma_f32_16x16x32_bf16 v[160:163], v[72:75], v[128:131], v[160:163]
  ds_read_b128 v[112:115], v7 offset:10240
  v_mfma_f32_16x16x32_bf16 v[164:167], v[72:75], v[132:135], v[164:167]
  ds_read_b128 v[116:119], v7 offset:28672
  v_mfma_f32_16x16x32_bf16 v[168:171], v[76:79], v[120:123], v[168:171]
  v_mfma_f32_16x16x32_bf16 v[172:175], v[76:79], v[124:127], v[172:175]
  buffer_load_dwordx4 v[72:75], v2, s[56:59], s65 offen offset:1024 sc1
  v_mfma_f32_16x16x32_bf16 v[176:179], v[76:79], v[128:131], v[176:179]
  v_mfma_f32_16x16x32_bf16 v[180:183], v[76:79], v[132:135], v[180:183]
  s_waitcnt vmcnt(14) lgkmcnt(0)
  v_mfma_f32_16x16x32_bf16 v[136:139], v[80:83], v[104:107], v[136:139]
  v_mfma_f32_16x16x32_bf16 v[140:143], v[80:83], v[108:111], v[140:143]
  buffer_load_dwordx4 v[76:79], v2, s[56:59], s65 offen offset:2048 sc1
  v_mfma_f32_16x16x32_bf16 v[144:147], v[80:83], v[112:115], v[144:147]
  ds_read_b128 v[120:123], v6 offset:11264
  v_mfma_f32_16x16x32_bf16 v[148:151], v[80:83], v[116:119], v[148:151]
  ds_read_b128 v[124:127], v6 offset:29696
  v_mfma_f32_16x16x32_bf16 v[152:155], v[84:87], v[104:107], v[152:155]
  s_add_u32 s65, s65, 36864
  v_mfma_f32_16x16x32_bf16 v[156:159], v[84:87], v[108:111], v[156:159]
  buffer_load_dwordx4 v[80:83], v2, s[56:59], s65 offen offset:0 sc1
  v_mfma_f32_16x16x32_bf16 v[160:163], v[84:87], v[112:115], v[160:163]
  ds_read_b128 v[128:131], v7 offset:11264
  v_mfma_f32_16x16x32_bf16 v[164:167], v[84:87], v[116:119], v[164:167]
  ds_read_b128 v[132:135], v7 offset:29696
  v_mfma_f32_16x16x32_bf16 v[168:171], v[88:91], v[104:107], v[168:171]
  v_mfma_f32_16x16x32_bf16 v[172:175], v[88:91], v[108:111], v[172:175]
  buffer_load_dwordx4 v[84:87], v2, s[56:59], s65 offen offset:1024 sc1
  v_mfma_f32_16x16x32_bf16 v[176:179], v[88:91], v[112:115], v[176:179]
  v_mfma_f32_16x16x32_bf16 v[180:183], v[88:91], v[116:119], v[180:183]
  s_waitcnt vmcnt(14) lgkmcnt(0)
  v_mfma_f32_16x16x32_bf16 v[136:139], v[92:95], v[120:123], v[136:139]
  v_mfma_f32_16x16x32_bf16 v[140:143], v[92:95], v[124:127], v[140:143]
  buffer_load_dwordx4 v[88:91], v2, s[56:59], s65 offen offset:2048 sc1
  v_mfma_f32_16x16x32_bf16 v[144:147], v[92:95], v[128:131], v[144:147]
  ds_read_b128 v[104:107], v6 offset:12288
  v_mfma_f32_16x16x32_bf16 v[148:151], v[92:95], v[132:135], v[148:151]
  ds_read_b128 v[108:111], v6 offset:30720
  v_mfma_f32_16x16x32_bf16 v[152:155], v[96:99], v[120:123], v[152:155]
  s_add_u32 s65, s65, 36864
  v_mfma_f32_16x16x32_bf16 v[156:159], v[96:99], v[124:127], v[156:159]
  buffer_load_dwordx4 v[92:95], v2, s[56:59], s65 offen offset:0 sc1
  v_mfma_f32_16x16x32_bf16 v[160:163], v[96:99], v[128:131], v[160:163]
  ds_read_b128 v[112:115], v7 offset:12288
  v_mfma_f32_16x16x32_bf16 v[164:167], v[96:99], v[132:135], v[164:167]
  ds_read_b128 v[116:119], v7 offset:30720
  v_mfma_f32_16x16x32_bf16 v[168:171], v[100:103], v[120:123], v[168:171]
  v_mfma_f32_16x16x32_bf16 v[172:175], v[100:103], v[124:127], v[172:175]
  buffer_load_dwordx4 v[96:99], v2, s[56:59], s65 offen offset:1024 sc1
  v_mfma_f32_16x16x32_bf16 v[176:179], v[100:103], v[128:131], v[176:179]
LW_55:
  ds_read_b32 v5, v16 offset:32
  s_waitcnt lgkmcnt(0)
  v_readfirstlane_b32 s7, v5
  s_cmp_ge_u32 s7, 1
  s_cbranch_scc1 LD_56
  s_sleep 1
  s_branch LW_55
LD_56:
  v_mfma_f32_16x16x32_bf16 v[180:183], v[100:103], v[132:135], v[180:183]
  s_waitcnt vmcnt(14) lgkmcnt(0)
  v_mfma_f32_16x16x32_bf16 v[136:139], v[32:35], v[104:107], v[136:139]
  v_mfma_f32_16x16x32_bf16 v[140:143], v[32:35], v[108:111], v[140:143]
  buffer_load_dwordx4 v[100:103], v2, s[56:59], s65 offen offset:2048 sc1
  v_mfma_f32_16x16x32_bf16 v[144:147], v[32:35], v[112:115], v[144:147]
  ds_read_b128 v[120:123], v6 offset:13312
  v_mfma_f32_16x16x32_bf16 v[148:151], v[32:35], v[116:119], v[148:151]
  ds_read_b128 v[124:127], v6 offset:31744
  v_mfma_f32_16x16x32_bf16 v[152:155], v[36:39], v[104:107], v[152:155]
  v_mfma_f32_16x16x32_bf16 v[156:159], v[36:39], v[108:111], v[156:159]
  buffer_load_dwordx4 v[32:35], v24, s[56:59], s66 offen offset:0 sc1
  v_mfma_f32_16x16x32_bf16 v[160:163], v[36:39], v[112:115], v[160:163]
  ds_read_b128 v[128:131], v7 offset:13312
  v_mfma_f32_16x16x32_bf16 v[164:167], v[36:39], v[116:119], v[164:167]
  ds_read_b128 v[132:135], v7 offset:31744
  v_mfma_f32_16x16x32_bf16 v[168:171], v[40:43], v[104:107], v[168:171]
  v_mfma_f32_16x16x32_bf16 v[172:175], v[40:43], v[108:111], v[172:175]
  buffer_load_dwordx4 v[36:39], v25, s[56:59], s66 offen offset:0 sc1
  v_mfma_f32_16x16x32_bf16 v[176:179], v[40:43], v[112:115], v[176:179]
  v_mfma_f32_16x16x32_bf16 v[180:183], v[40:43], v[116:119], v[180:183]
  s_waitcnt vmcnt(14) lgkmcnt(0)
  v_mfma_f32_16x16x32_bf16 v[136:139], v[44:47], v[120:123], v[136:139]
  v_mfma_f32_16x16x32_bf16 v[140:143], v[44:47], v[124:127], v[140:143]
  buffer_load_dwordx4 v[40:43], v26, s[56:59], s66 offen offset:0 sc1
  v_mfma_f32_16x16x32_bf16 v[144:147], v[44:47], v[128:131], v[144:147]
  ds_read_b128 v[104:107], v6 offset:14336
  v_mfma_f32_16x16x32_bf16 v[148:151], v[44:47], v[132:135], v[148:151]
  ds_read_b128 v[108:111], v6 offset:32768
  v_mfma_f32_16x16x32_bf16 v[152:155], v[48:51], v[120:123], v[152:155]
  s_add_u32 s66, s66, 36864
  v_mfma_f32_16x16x32_bf16 v[156:159], v[48:51], v[124:127], v[156:159]
  buffer_load_dwordx4 v[44:47], v24, s[56:59], s66 offen offset:0 sc1
  v_mfma_f32_16x16x32_bf16 v[160:163], v[48:51], v[128:131], v[160:163]
  ds_read_b128 v[112:115], v7 offset:14336
  v_mfma_f32_16x16x32_bf16 v[164:167], v[48:51], v[132:135], v[164:167]
  ds_read_b128 v[116:119], v7 offset:32768
  v_mfma_f32_16x16x32_bf16 v[168:171], v[52:55], v[120:123], v[168:171]
  v_mfma_f32_16x16x32_bf16 v[172:175], v[52:55], v[124:127], v[172:175]
  buffer_load_dwordx4 v[48:51], v25, s[56:59], s66 offen offset:0 sc1
  v_mfma_f32_16x16x32_bf16 v[176:179], v[52:55], v[128:131], v[176:179]
  v_mfma_f32_16x16x32_bf16 v[180:183], v[52:55], v[132:135], v[180:183]
  s_waitcnt vmcnt(14) lgkmcnt(0)
  v_mfma_f32_16x16x32_bf16 v[136:139], v[56:59], v[104:107], v[136:139]
  v_mfma_f32_16x16x32_bf16 v[140:143], v[56:59], v[108:111], v[140:143]
  buffer_load_dwordx4 v[52:55], v26, s[56:59], s66 offen offset:0 sc1
  v_mfma_f32_16x16x32_bf16 v[144:147], v[56:59], v[112:115], v[144:147]
  ds_read_b128 v[120:123], v6 offset:15360
  v_mfma_f32_16x16x32_bf16 v[148:151], v[56:59], v[116:119], v[148:151]
  ds_read_b128 v[124:127], v6 offset:33792
  v_mfma_f32_16x16x32_bf16 v[152:155], v[60:63], v[104:107], v[152:155]
  s_add_u32 s66, s66, 36864
  v_mfma_f32_16x16x32_bf16 v[156:159], v[60:63], v[108:111], v[156:159]
  buffer_load_dwordx4 v[56:59], v24, s[56:59], s66 offen offset:0 sc1
  v_mfma_f32_16x16x32_bf16 v[160:163], v[60:63], v[112:115], v[160:163]
  ds_read_b128 v[128:131], v7 offset:15360
  v_mfma_f32_16x16x32_bf16 v[164:167], v[60:63], v[116:119], v[164:167]
  ds_read_b128 v[132:135], v7 offset:33792
  v_mfma_f32_16x16x32_bf16 v[168:171], v[64:67], v[104:107], v[168:171]
  v_mfma_f32_16x16x32_bf16 v[172:175], v[64:67], v[108:111], v[172:175]
  buffer_load_dwordx4 v[60:63], v25, s[56:59], s66 offen offset:0 sc1
  v_mfma_f32_16x16x32_bf16 v[176:179], v[64:67], v[112:115], v[176:179]
  v_mfma_f32_16x16x32_bf16 v[180:183], v[64:67], v[116:119], v[180:183]
  s_waitcnt vmcnt(14) lgkmcnt(0)
  v_mfma_f32_16x16x32_bf16 v[136:139], v[68:71], v[120:123], v[136:139]
  v_mfma_f32_16x16x32_bf16 v[140:143], v[68:71], v[124:127], v[140:143]
  buffer_load_dwordx4 v[64:67], v26, s[56:59], s66 offen offset:0 sc1
  v_mfma_f32_16x16x32_bf16 v[144:147], v[68:71], v[128:131], v[144:147]
  ds_read_b128 v[104:107], v6 offset:16384
  v_mfma_f32_16x16x32_bf16 v[148:151], v[68:71], v[132:135], v[148:151]
  ds_read_b128 v[108:111], v6 offset:34816
  v_mfma_f32_16x16x32_bf16 v[152:155], v[72:75], v[120:123], v[152:155]
  s_add_u32 s66, s66, 36864
  v_mfma_f32_16x16x32_bf16 v[156:159], v[72:75], v[124:127], v[156:159]
  buffer_load_dwordx4 v[68:71], v24, s[56:59], s66 offen offset:0 sc1
  v_mfma_f32_16x16x32_bf16 v[160:163], v[72:75], v[128:131], v[160:163]
  ds_read_b128 v[112:115], v7 offset:16384
  v_mfma_f32_16x16x32_bf16 v[164:167], v[72:75], v[132:135], v[164:167]
  ds_read_b128 v[116:119], v7 offset:34816
  v_mfma_f32_16x16x32_bf16 v[168:171], v[76:79], v[120:123], v[168:171]
  v_mfma_f32_16x16x32_bf16 v[172:175], v[76:79], v[124:127], v[172:175]
  buffer_load_dwordx4 v[72:75], v25, s[56:59], s66 offen offset:0 sc1
  v_mfma_f32_16x16x32_bf16 v[176:179], v[76:79], v[128:131], v[176:179]
  v_mfma_f32_16x16x32_bf16 v[180:183], v[76:79], v[132:135], v[180:183]
  s_waitcnt vmcnt(14) lgkmcnt(0)
  v_mfma_f32_16x16x32_bf16 v[136:139], v[80:83], v[104:107], v[136:139]
  v_mfma_f32_16x16x32_bf16 v[140:143], v[80:83], v[108:111], v[140:143]
  buffer_load_dwordx4 v[76:79], v26, s[56:59], s66 offen offset:0 sc1
  v_mfma_f32_16x16x32_bf16 v[144:147], v[80:83], v[112:115], v[144:147]
  ds_read_b128 v[120:123], v6 offset:17408
  v_mfma_f32_16x16x32_bf16 v[148:151], v[80:83], v[116:119], v[148:151]
  ds_read_b128 v[124:127], v6 offset:35840
  v_mfma_f32_16x16x32_bf16 v[152:155], v[84:87], v[104:107], v[152:155]
  s_add_u32 s66, s66, 36864
  v_mfma_f32_16x16x32_bf16 v[156:159], v[84:87], v[108:111], v[156:159]
  buffer_load_dwordx4 v[80:83], v24, s[56:59], s66 offen offset:0 sc1
  v_mfma_f32_16x16x32_bf16 v[160:163], v[84:87], v[112:115], v[160:163]
  ds_read_b128 v[128:131], v7 offset:17408
  v_mfma_f32_16x16x32_bf16 v[164:167], v[84:87], v[116:119], v[164:167]
  ds_read_b128 v[132:135], v7 offset:35840
  v_mfma_f32_16x16x32_bf16 v[168:171], v[88:91], v[104:107], v[168:171]
  v_mfma_f32_16x16x32_bf16 v[172:175], v[88:91], v[108:111], v[172:175]
  buffer_load_dwordx4 v[84:87], v25, s[56:59], s66 offen offset:0 sc1
  v_mfma_f32_16x16x32_bf16 v[176:179], v[88:91], v[112:115], v[176:179]
  v_mfma_f32_16x16x32_bf16 v[180:183], v[88:91], v[116:119], v[180:183]
  s_waitcnt vmcnt(14) lgkmcnt(0)
  v_mfma_f32_16x16x32_bf16 v[136:139], v[92:95], v[120:123], v[136:139]
  v_mfma_f32_16x16x32_bf16 v[140:143], v[92:95], v[124:127], v[140:143]
  buffer_load_dwordx4 v[88:91], v26, s[56:59], s66 offen offset:0 sc1
  v_mfma_f32_16x16x32_bf16 v[144:147], v[92:95], v[128:131], v[144:147]
  v_mfma_f32_16x16x32_bf16 v[148:151], v[92:95], v[132:135], v[148:151]
  v_mfma_f32_16x16x32_bf16 v[152:155], v[96:99], v[120:123], v[152:155]
  s_add_u32 s66, s66, 36864
  v_mfma_f32_16x16x32_bf16 v[156:159], v[96:99], v[124:127], v[156:159]
  buffer_load_dwordx4 v[92:95], v24, s[56:59], s66 offen offset:0 sc1
  v_mfma_f32_16x16x32_bf16 v[160:163], v[96:99], v[128:131], v[160:163]
  v_mfma_f32_16x16x32_bf16 v[164:167], v[96:99], v[132:135], v[164:167]
  v_mfma_f32_16x16x32_bf16 v[168:171], v[100:103], v[120:123], v[168:171]
  v_mfma_f32_16x16x32_bf16 v[172:175], v[100:103], v[124:127], v[172:175]
  buffer_load_dwordx4 v[96:99], v25, s[56:59], s66 offen offset:0 sc1
  v_mfma_f32_16x16x32_bf16 v[176:179], v[100:103], v[128:131], v[176:179]
  v_mfma_f32_16x16x32_bf16 v[180:183], v[100:103], v[132:135], v[180:183]
  buffer_load_dwordx4 v[100:103], v26, s[56:59], s66 offen offset:0 sc1
  s_setprio 0
  s_mov_b64 exec, 1
  ds_add_u32 v16, v17 offset:100
  s_mov_b64 exec, -1
  s_nop 7
  v_mul_f32 v224, v136, v136
  v_mul_f32 v225, v137, v137
  v_mul_f32 v226, v138, v138
  v_mul_f32 v227, v139, v139
  v_mul_f32 v228, v140, v140
  v_mul_f32 v229, v141, v141
  v_mul_f32 v230, v142, v142
  v_mul_f32 v231, v143, v143
  v_fma_f32 v224, v224, v217, v216
  v_fma_f32 v225, v225, v217, v216
  v_fma_f32 v226, v226, v217, v216
  v_fma_f32 v227, v227, v217, v216
  v_fma_f32 v228, v228, v219, v218
  v_fma_f32 v229, v229, v219, v218
  v_fma_f32 v230, v230, v219, v218
  v_fma_f32 v231, v231, v219, v218
  v_mul_f32 v224, v224, v136
  v_mul_f32 v225, v225, v137
  v_mul_f32 v226, v226, v138
  v_mul_f32 v227, v227, v139
  v_mul_f32 v228, v228, v140
  v_mul_f32 v229, v229, v141
  v_mul_f32 v230, v230, v142
  v_mul_f32 v231, v231, v143
  v_exp_f32 v224, v224
  v_exp_f32 v225, v225
  v_exp_f32 v226, v226
  v_exp_f32 v227, v227
  v_exp_f32 v228, v228
  v_exp_f32 v229, v229
  v_exp_f32 v230, v230
  v_exp_f32 v231, v231
  v_add_f32 v224, 1.0, v224
  v_add_f32 v225, 1.0, v225
  v_add_f32 v226, 1.0, v226
  v_add_f32 v227, 1.0, v227
  v_add_f32 v228, 1.0, v228
  v_add_f32 v229, 1.0, v229
  v_add_f32 v230, 1.0, v230
  v_add_f32 v231, 1.0, v231
  v_rcp_f32 v224, v224
  v_rcp_f32 v225, v225
  v_rcp_f32 v226, v226
  v_rcp_f32 v227, v227
  v_rcp_f32 v228, v228
  v_rcp_f32 v229, v229
  v_rcp_f32 v230, v230
  v_rcp_f32 v231, v231
  v_mul_f32 v136, v224, v136
  v_mul_f32 v137, v225, v137
  v_mul_f32 v138, v226, v138
  v_mul_f32 v139, v227, v139
  v_mul_f32 v140, v228, v140
  v_mul_f32 v141, v229, v141
  v_mul_f32 v142, v230, v142
  v_mul_f32 v143, v231, v143
  v_cvt_pk_bf16_f32 v232, v136, v137
  v_cvt_pk_bf16_f32 v233, v138, v139
  v_cvt_pk_bf16_f32 v234, v140, v141
  v_cvt_pk_bf16_f32 v235, v142, v143
  ds_write_b64 v10, v[232:233] offset:0
  ds_write_b64 v10, v[234:235] offset:18432
LW_57:
  ds_read_b32 v5, v16 offset:100
  s_waitcnt lgkmcnt(0)
  v_readfirstlane_b32 s7, v5
  s_cmp_ge_u32 s7, 4
  s_cbranch_scc1 LD_58
  s_sleep 1
  s_branch LW_57
LD_58:
LW_59:
  ds_read_b32 v5, v16 offset:20
  s_waitcnt lgkmcnt(0)
  v_readfirstlane_b32 s7, v5
  s_cmp_ge_u32 s7, 8
  s_cbranch_scc1 LD_60
  s_sleep 1
  s_branch LW_59
LD_60:
  s_setprio 3
  s_mov_b32 s12, s16
  s_mov_b32 s13, s17
  s_mov_b32 s14, 2359296
  s_mov_b32 s15, 0x20000
  s_lshr_b32 s61, s4, 1
  s_and_b32 s62, s4, 1
  s_mul_i32 s52, s61, 9
  s_lshl_b32 s6, s62, 2
  s_add_u32 s52, s52, s6
  s_cmp_lt_u32 s4, 4
  s_cselect_b32 s53, 12288, 0
  s_mul_i32 s54, s5, 73728
  s_lshl_b32 s6, s52, 5
  s_add_u32 s55, s54, s6
  s_mul_i32 s6, s3, 18432
  s_add_u32 s7, s6, s53
  s_mov_b32 m0, s7
  s_add_u32 s6, s6, s55
  s_movk_i32 s8, 6554
  s_movk_i32 s9, 992
  v_add_u32 v5, 0, v1
  v_min_u32 v5, 159, v5
  v_mul_lo_u32 v14, v5, s8
  v_lshrrev_b32 v14, 16, v14
  v_lshlrev_b32 v5, 4, v5
  v_mad_u32_u24 v5, v14, s9, v5
  buffer_load_dwordx4 v5, s[12:15], s6 offen nt lds
  s_add_u32 m0, m0, 1024
  v_add_u32 v5, 64, v1
  v_min_u32 v5, 159, v5
  v_mul_lo_u32 v14, v5, s8
  v_lshrrev_b32 v14, 16, v14
  v_lshlrev_b32 v5, 4, v5
  v_mad_u32_u24 v5, v14, s9, v5
  buffer_load_dwordx4 v5, s[12:15], s6 offen nt lds
  s_add_u32 m0, m0, 1024
  v_add_u32 v5, 128, v1
  v_min_u32 v5, 159, v5
  v_mul_lo_u32 v14, v5, s8
  v_lshrrev_b32 v14, 16, v14
  v_lshlrev_b32 v5, 4, v5
  v_mad_u32_u24 v5, v14, s9, v5
  buffer_load_dwordx4 v5, s[12:15], s6 offen nt lds
  s_add_u32 m0, m0, 1024
  v_lshrrev_b32 v5, 3, v1
  v_and_b32 v14, 7, v1
  v_mul_u32_u24 v5, 4224, v5
  v_lshl_add_u32 v5, v14, 4, v5
  s_mul_i32 s6, s52, 67584
  s_mul_i32 s7, s3, 33792
  s_add_u32 s6, s6, s7
  s_lshl_b32 s7, s5, 7
  s_add_u32 s6, s6, s7
  s_add_u32 s6, s6, 4718592
  buffer_load_dwordx4 v5, s[56:59], s6 offen sc1 lds
  s_add_u32 m0, m0, 1024
  s_add_u32 s6, s6, 135168
  buffer_load_dwordx4 v5, s[56:59], s6 offen sc1 lds
  s_add_u32 m0, m0, 1024
  s_add_u32 s6, s6, 135168
  s_sub_u32 s7, s6, 135168
  s_cmp_ge_u32 s3, 2
  s_cselect_b32 s6, s7, s6
  buffer_load_dwordx4 v5, s[56:59], s6 offen sc1 lds
  s_add_u32 m0, m0, 1024
  s_add_u32 s6, s6, 135168
FN_y:
  s_setprio 0
  v_mul_f32 v224, v144, v144
  v_mul_f32 v225, v145, v145
  v_mul_f32 v226, v146, v146
  v_mul_f32 v227, v147, v147
  v_mul_f32 v228, v148, v148
  v_mul_f32 v229, v149, v149
  v_mul_f32 v230, v150, v150
  v_mul_f32 v231, v151, v151
  v_fma_f32 v224, v224, v221, v220
  v_fma_f32 v225, v225, v221, v220
  v_fma_f32 v226, v226, v221, v220
  v_fma_f32 v227, v227, v221, v220
  v_fma_f32 v228, v228, v223, v222
  v_fma_f32 v229, v229, v223, v222
  v_fma_f32 v230, v230, v223, v222
  v_fma_f32 v231, v231, v223, v222
  v_mul_f32 v224, v224, v144
  v_mul_f32 v225, v225, v145
  v_mul_f32 v226, v226, v146
  v_mul_f32 v227, v227, v147
  v_mul_f32 v228, v228, v148
  v_mul_f32 v229, v229, v149
  v_mul_f32 v230, v230, v150
  v_mul_f32 v231, v231, v151
  v_exp_f32 v224, v224
  v_exp_f32 v225, v225
  v_exp_f32 v226, v226
  v_exp_f32 v227, v227
  v_exp_f32 v228, v228
  v_exp_f32 v229, v229
  v_exp_f32 v230, v230
  v_exp_f32 v231, v231
  v_add_f32 v224, 1.0, v224
  v_add_f32 v225, 1.0, v225
  v_add_f32 v226, 1.0, v226
  v_add_f32 v227, 1.0, v227
  v_add_f32 v228, 1.0, v228
  v_add_f32 v229, 1.0, v229
  v_add_f32 v230, 1.0, v230
  v_add_f32 v231, 1.0, v231
  v_rcp_f32 v224, v224
  v_rcp_f32 v225, v225
  v_rcp_f32 v226, v226
  v_rcp_f32 v227, v227
  v_rcp_f32 v228, v228
  v_rcp_f32 v229, v229
  v_rcp_f32 v230, v230
  v_rcp_f32 v231, v231
  v_mul_f32 v144, v224, v144
  v_mul_f32 v145, v225, v145
  v_mul_f32 v146, v226, v146
  v_mul_f32 v147, v227, v147
  v_mul_f32 v148, v228, v148
  v_mul_f32 v149, v229, v149
  v_mul_f32 v150, v230, v150
  v_mul_f32 v151, v231, v151
  v_cvt_pk_bf16_f32 v236, v144, v145
  v_cvt_pk_bf16_f32 v237, v146, v147
  v_cvt_pk_bf16_f32 v238, v148, v149
  v_cvt_pk_bf16_f32 v239, v150, v151
  ds_write_b64 v11, v[236:237] offset:0
  ds_write_b64 v11, v[238:239] offset:18432
  v_mul_f32 v224, v152, v152
  v_mul_f32 v225, v153, v153
  v_mul_f32 v226, v154, v154
  v_mul_f32 v227, v155, v155
  v_mul_f32 v228, v156, v156
  v_mul_f32 v229, v157, v157
  v_mul_f32 v230, v158, v158
  v_mul_f32 v231, v159, v159
  v_fma_f32 v224, v224, v217, v216
  v_fma_f32 v225, v225, v217, v216
  v_fma_f32 v226, v226, v217, v216
  v_fma_f32 v227, v227, v217, v216
  v_fma_f32 v228, v228, v219, v218
  v_fma_f32 v229, v229, v219, v218
  v_fma_f32 v230, v230, v219, v218
  v_fma_f32 v231, v231, v219, v218
  v_mul_f32 v224, v224, v152
  v_mul_f32 v225, v225, v153
  v_mul_f32 v226, v226, v154
  v_mul_f32 v227, v227, v155
  v_mul_f32 v228, v228, v156
  v_mul_f32 v229, v229, v157
  v_mul_f32 v230, v230, v158
  v_mul_f32 v231, v231, v159
  v_exp_f32 v224, v224
  v_exp_f32 v225, v225
  v_exp_f32 v226, v226
  v_exp_f32 v227, v227
  v_exp_f32 v228, v228
  v_exp_f32 v229, v229
  v_exp_f32 v230, v230
  v_exp_f32 v231, v231
  v_add_f32 v224, 1.0, v224
  v_add_f32 v225, 1.0, v225
  v_add_f32 v226, 1.0, v226
  v_add_f32 v227, 1.0, v227
  v_add_f32 v228, 1.0, v228
  v_add_f32 v229, 1.0, v229
  v_add_f32 v230, 1.0, v230
  v_add_f32 v231, 1.0, v231
  v_rcp_f32 v224, v224
  v_rcp_f32 v225, v225
  v_rcp_f32 v226, v226
  v_rcp_f32 v227, v227
  v_rcp_f32 v228, v228
  v_rcp_f32 v229, v229
  v_rcp_f32 v230, v230
  v_rcp_f32 v231, v231
  v_mul_f32 v152, v224, v152
  v_mul_f32 v153, v225, v153
  v_mul_f32 v154, v226, v154
  v_mul_f32 v155, v227, v155
  v_mul_f32 v156, v228, v156
  v_mul_f32 v157, v229, v157
  v_mul_f32 v158, v230, v158
  v_mul_f32 v159, v231, v159
  v_cvt_pk_bf16_f32 v232, v152, v153
  v_cvt_pk_bf16_f32 v233, v154, v155
  v_cvt_pk_bf16_f32 v234, v156, v157
  v_cvt_pk_bf16_f32 v235, v158, v159
  ds_write_b64 v12, v[232:233] offset:0
  ds_write_b64 v12, v[234:235] offset:18432
  v_mul_f32 v224, v160, v160
  v_mul_f32 v225, v161, v161
  v_mul_f32 v226, v162, v162
  v_mul_f32 v227, v163, v163
  v_mul_f32 v228, v164, v164
  v_mul_f32 v229, v165, v165
  v_mul_f32 v230, v166, v166
  v_mul_f32 v231, v167, v167
  v_fma_f32 v224, v224, v221, v220
  v_fma_f32 v225, v225, v221, v220
  v_fma_f32 v226, v226, v221, v220
  v_fma_f32 v227, v227, v221, v220
  v_fma_f32 v228, v228, v223, v222
  v_fma_f32 v229, v229, v223, v222
  v_fma_f32 v230, v230, v223, v222
  v_fma_f32 v231, v231, v223, v222
  v_mul_f32 v224, v224, v160
  v_mul_f32 v225, v225, v161
  v_mul_f32 v226, v226, v162
  v_mul_f32 v227, v227, v163
  v_mul_f32 v228, v228, v164
  v_mul_f32 v229, v229, v165
  v_mul_f32 v230, v230, v166
  v_mul_f32 v231, v231, v167
  v_exp_f32 v224, v224
  v_exp_f32 v225, v225
  v_exp_f32 v226, v226
  v_exp_f32 v227, v227
  v_exp_f32 v228, v228
  v_exp_f32 v229, v229
  v_exp_f32 v230, v230
  v_exp_f32 v231, v231
  v_add_f32 v224, 1.0, v224
  v_add_f32 v225, 1.0, v225
  v_add_f32 v226, 1.0, v226
  v_add_f32 v227, 1.0, v227
  v_add_f32 v228, 1.0, v228
  v_add_f32 v229, 1.0, v229
  v_add_f32 v230, 1.0, v230
  v_add_f32 v231, 1.0, v231
  v_rcp_f32 v224, v224
  v_rcp_f32 v225, v225
  v_rcp_f32 v226, v226
  v_rcp_f32 v227, v227
  v_rcp_f32 v228, v228
  v_rcp_f32 v229, v229
  v_rcp_f32 v230, v230
  v_rcp_f32 v231, v231
  v_mul_f32 v160, v224, v160
  v_mul_f32 v161, v225, v161
  v_mul_f32 v162, v226, v162
  v_mul_f32 v163, v227, v163
  v_mul_f32 v164, v228, v164
  v_mul_f32 v165, v229, v165
  v_mul_f32 v166, v230, v166
  v_mul_f32 v167, v231, v167
  v_cvt_pk_bf16_f32 v236, v160, v161
  v_cvt_pk_bf16_f32 v237, v162, v163
  v_cvt_pk_bf16_f32 v238, v164, v165
  v_cvt_pk_bf16_f32 v239, v166, v167
  ds_write_b64 v13, v[236:237] offset:0
  ds_write_b64 v13, v[238:239] offset:18432
  v_mul_f32 v224, v168, v168
  v_mul_f32 v225, v169, v169
  v_mul_f32 v226, v170, v170
  v_mul_f32 v227, v171, v171
  v_mul_f32 v228, v172, v172
  v_mul_f32 v229, v173, v173
  v_mul_f32 v230, v174, v174
  v_mul_f32 v231, v175, v175
  v_fma_f32 v224, v224, v217, v216
  v_fma_f32 v225, v225, v217, v216
  v_fma_f32 v226, v226, v217, v216
  v_fma_f32 v227, v227, v217, v216
  v_fma_f32 v228, v228, v219, v218
  v_fma_f32 v229, v229, v219, v218
  v_fma_f32 v230, v230, v219, v218
  v_fma_f32 v231, v231, v219, v218
  v_mul_f32 v224, v224, v168
  v_mul_f32 v225, v225, v169
  v_mul_f32 v226, v226, v170
  v_mul_f32 v227, v227, v171
  v_mul_f32 v228, v228, v172
  v_mul_f32 v229, v229, v173
  v_mul_f32 v230, v230, v174
  v_mul_f32 v231, v231, v175
  v_exp_f32 v224, v224
  v_exp_f32 v225, v225
  v_exp_f32 v226, v226
  v_exp_f32 v227, v227
  v_exp_f32 v228, v228
  v_exp_f32 v229, v229
  v_exp_f32 v230, v230
  v_exp_f32 v231, v231
  v_add_f32 v224, 1.0, v224
  v_add_f32 v225, 1.0, v225
  v_add_f32 v226, 1.0, v226
  v_add_f32 v227, 1.0, v227
  v_add_f32 v228, 1.0, v228
  v_add_f32 v229, 1.0, v229
  v_add_f32 v230, 1.0, v230
  v_add_f32 v231, 1.0, v231
  v_rcp_f32 v224, v224
  v_rcp_f32 v225, v225
  v_rcp_f32 v226, v226
  v_rcp_f32 v227, v227
  v_rcp_f32 v228, v228
  v_rcp_f32 v229, v229
  v_rcp_f32 v230, v230
  v_rcp_f32 v231, v231
  v_mul_f32 v168, v224, v168
  v_mul_f32 v169, v225, v169
  v_mul_f32 v170, v226, v170
  v_mul_f32 v171, v227, v171
  v_mul_f32 v172, v228, v172
  v_mul_f32 v173, v229, v173
  v_mul_f32 v174, v230, v174
  v_mul_f32 v175, v231, v175
  v_cvt_pk_bf16_f32 v232, v168, v169
  v_cvt_pk_bf16_f32 v233, v170, v171
  v_cvt_pk_bf16_f32 v234, v172, v173
  v_cvt_pk_bf16_f32 v235, v174, v175
  ds_write_b64 v10, v[232:233] offset:1024
  ds_write_b64 v10, v[234:235] offset:19456
  v_mul_f32 v224, v176, v176
  v_mul_f32 v225, v177, v177
  v_mul_f32 v226, v178, v178
  v_mul_f32 v227, v179, v179
  v_mul_f32 v228, v180, v180
  v_mul_f32 v229, v181, v181
  v_mul_f32 v230, v182, v182
  v_mul_f32 v231, v183, v183
  v_fma_f32 v224, v224, v221, v220
  v_fma_f32 v225, v225, v221, v220
  v_fma_f32 v226, v226, v221, v220
  v_fma_f32 v227, v227, v221, v220
  v_fma_f32 v228, v228, v223, v222
  v_fma_f32 v229, v229, v223, v222
  v_fma_f32 v230, v230, v223, v222
  v_fma_f32 v231, v231, v223, v222
  v_mul_f32 v224, v224, v176
  v_mul_f32 v225, v225, v177
  v_mul_f32 v226, v226, v178
  v_mul_f32 v227, v227, v179
  v_mul_f32 v228, v228, v180
  v_mul_f32 v229, v229, v181
  v_mul_f32 v230, v230, v182
  v_mul_f32 v231, v231, v183
  v_exp_f32 v224, v224
  v_exp_f32 v225, v225
  v_exp_f32 v226, v226
  v_exp_f32 v227, v227
  v_exp_f32 v228, v228
  v_exp_f32 v229, v229
  v_exp_f32 v230, v230
  v_exp_f32 v231, v231
  v_add_f32 v224, 1.0, v224
  v_add_f32 v225, 1.0, v225
  v_add_f32 v226, 1.0, v226
  v_add_f32 v227, 1.0, v227
  v_add_f32 v228, 1.0, v228
  v_add_f32 v229, 1.0, v229
  v_add_f32 v230, 1.0, v230
  v_add_f32 v231, 1.0, v231
  v_rcp_f32 v224, v224
  v_rcp_f32 v225, v225
  v_rcp_f32 v226, v226
  v_rcp_f32 v227, v227
  v_rcp_f32 v228, v228
  v_rcp_f32 v229, v229
  v_rcp_f32 v230, v230
  v_rcp_f32 v231, v231
  v_mul_f32 v176, v224, v176
  v_mul_f32 v177, v225, v177
  v_mul_f32 v178, v226, v178
  v_mul_f32 v179, v227, v179
  v_mul_f32 v180, v228, v180
  v_mul_f32 v181, v229, v181
  v_mul_f32 v182, v230, v182
  v_mul_f32 v183, v231, v183
  v_cvt_pk_bf16_f32 v236, v176, v177
  v_cvt_pk_bf16_f32 v237, v178, v179
  v_cvt_pk_bf16_f32 v238, v180, v181
  v_cvt_pk_bf16_f32 v239, v182, v183
  ds_write_b64 v11, v[236:237] offset:1024
  ds_write_b64 v11, v[238:239] offset:19456
  s_mov_b64 exec, 1
  ds_add_u32 v16, v17 offset:28
  s_mov_b64 exec, -1
  s_waitcnt vmcnt(0)
  s_mov_b64 exec, 1
  ds_add_u32 v16, v17 offset:24
  s_mov_b64 exec, -1
LW_61:
  ds_read_b32 v5, v16 offset:28
  s_waitcnt lgkmcnt(0)
  v_readfirstlane_b32 s7, v5
  s_cmp_ge_u32 s7, 4
  s_cbranch_scc1 LD_62
  s_sleep 1
  s_branch LW_61
LD_62:
  s_setprio 2
  ds_read_b128 v[104:107], v8 offset:0
  ds_read_b128 v[108:111], v8 offset:18432
  ds_read_b128 v[112:115], v9 offset:0
  ds_read_b128 v[116:119], v9 offset:18432
  s_waitcnt vmcnt(21) lgkmcnt(0)
  v_mfma_f32_16x16x32_bf16 v[136:139], v[32:35], v[104:107], 0
  v_mfma_f32_16x16x32_bf16 v[140:143], v[32:35], v[108:111], 0
  v_mfma_f32_16x16x32_bf16 v[144:147], v[32:35], v[112:115], 0
  ds_read_b128 v[120:123], v8 offset:1024
  v_mfma_f32_16x16x32_bf16 v[148:151], v[32:35], v[116:119], 0
  ds_read_b128 v[124:127], v8 offset:19456
  v_mfma_f32_16x16x32_bf16 v[152:155], v[36:39], v[104:107], 0
  s_add_u32 s66, s66, 36864
  v_mfma_f32_16x16x32_bf16 v[156:159], v[36:39], v[108:111], 0
  buffer_load_dwordx4 v[32:35], v24, s[56:59], s66 offen offset:0 sc1
  v_mfma_f32_16x16x32_bf16 v[160:163], v[36:39], v[112:115], 0
  ds_read_b128 v[128:131], v9 offset:1024
  v_mfma_f32_16x16x32_bf16 v[164:167], v[36:39], v[116:119], 0
  ds_read_b128 v[132:135], v9 offset:19456
  v_mfma_f32_16x16x32_bf16 v[168:171], v[40:43], v[104:107], 0
  v_mfma_f32_16x16x32_bf16 v[172:175], v[40:43], v[108:111], 0
  buffer_load_dwordx4 v[36:39], v25, s[56:59], s66 offen offset:0 sc1
  v_mfma_f32_16x16x32_bf16 v[176:179], v[40:43], v[112:115], 0
  v_mfma_f32_16x16x32_bf16 v[180:183], v[40:43], v[116:119], 0
  s_waitcnt vmcnt(20) lgkmcnt(0)
  v_mfma_f32_16x16x32_bf16 v[136:139], v[44:47], v[120:123], v[136:139]
  v_mfma_f32_16x16x32_bf16 v[140:143], v[44:47], v[124:127], v[140:143]
  buffer_load_dwordx4 v[40:43], v26, s[56:59], s66 offen offset:0 sc1
  v_mfma_f32_16x16x32_bf16 v[144:147], v[44:47], v[128:131], v[144:147]
  ds_read_b128 v[104:107], v8 offset:2048
  v_mfma_f32_16x16x32_bf16 v[148:151], v[44:47], v[132:135], v[148:151]
  ds_read_b128 v[108:111], v8 offset:20480
  v_mfma_f32_16x16x32_bf16 v[152:155], v[48:51], v[120:123], v[152:155]
  s_add_u32 s66, s66, 36864
  v_mfma_f32_16x16x32_bf16 v[156:159], v[48:51], v[124:127], v[156:159]
  buffer_load_dwordx4 v[44:47], v24, s[56:59], s66 offen offset:0 sc1
  v_mfma_f32_16x16x32_bf16 v[160:163], v[48:51], v[128:131], v[160:163]
  ds_read_b128 v[112:115], v9 offset:2048
  v_mfma_f32_16x16x32_bf16 v[164:167], v[48:51], v[132:135], v[164:167]
  ds_read_b128 v[116:119], v9 offset:20480
  v_mfma_f32_16x16x32_bf16 v[168:171], v[52:55], v[120:123], v[168:171]
  v_mfma_f32_16x16x32_bf16 v[172:175], v[52:55], v[124:127], v[172:175]
  buffer_load_dwordx4 v[48:51], v25, s[56:59], s66 offen offset:0 sc1
  v_mfma_f32_16x16x32_bf16 v[176:179], v[52:55], v[128:131], v[176:179]
  v_mfma_f32_16x16x32_bf16 v[180:183], v[52:55], v[132:135], v[180:183]
  s_waitcnt vmcnt(20) lgkmcnt(0)
  v_mfma_f32_16x16x32_bf16 v[136:139], v[56:59], v[104:107], v[136:139]
  v_mfma_f32_16x16x32_bf16 v[140:143], v[56:59], v[108:111], v[140:143]
  buffer_load_dwordx4 v[52:55], v26, s[56:59], s66 offen offset:0 sc1
  v_mfma_f32_16x16x32_bf16 v[144:147], v[56:59], v[112:115], v[144:147]
  ds_read_b128 v[120:123], v8 offset:3072
  v_mfma_f32_16x16x32_bf16 v[148:151], v[56:59], v[116:119], v[148:151]
  ds_read_b128 v[124:127], v8 offset:21504
  v_mfma_f32_16x16x32_bf16 v[152:155], v[60:63], v[104:107], v[152:155]
  s_add_u32 s66, s66, 36864
  v_mfma_f32_16x16x32_bf16 v[156:159], v[60:63], v[108:111], v[156:159]
  buffer_load_dwordx4 v[56:59], v24, s[56:59], s66 offen offset:0 sc1
  v_mfma_f32_16x16x32_bf16 v[160:163], v[60:63], v[112:115], v[160:163]
  ds_read_b128 v[128:131], v9 offset:3072
  v_mfma_f32_16x16x32_bf16 v[164:167], v[60:63], v[116:119], v[164:167]
  ds_read_b128 v[132:135], v9 offset:21504
  v_mfma_f32_16x16x32_bf16 v[168:171], v[64:67], v[104:107], v[168:171]
  v_mfma_f32_16x16x32_bf16 v[172:175], v[64:67], v[108:111], v[172:175]
  buffer_load_dwordx4 v[60:63], v25, s[56:59], s66 offen offset:0 sc1
  v_mfma_f32_16x16x32_bf16 v[176:179], v[64:67], v[112:115], v[176:179]
  v_mfma_f32_16x16x32_bf16 v[180:183], v[64:67], v[116:119], v[180:183]
  s_waitcnt vmcnt(20) lgkmcnt(0)
  v_mfma_f32_16x16x32_bf16 v[136:139], v[68:71], v[120:123], v[136:139]
  v_mfma_f32_16x16x32_bf16 v[140:143], v[68:71], v[124:127], v[140:143]
  buffer_load_dwordx4 v[64:67], v26, s[56:59], s66 offen offset:0 sc1
  v_mfma_f32_16x16x32_bf16 v[144:147], v[68:71], v[128:131], v[144:147]
  ds_read_b128 v[104:107], v8 offset:4096
  v_mfma_f32_16x16x32_bf16 v[148:151], v[68:71], v[132:135], v[148:151]
  ds_read_b128 v[108:111], v8 offset:22528
  v_mfma_f32_16x16x32_bf16 v[152:155], v[72:75], v[120:123], v[152:155]
  s_add_u32 s66, s66, 36864
  v_mfma_f32_16x16x32_bf16 v[156:159], v[72:75], v[124:127], v[156:159]
  buffer_load_dwordx4 v[68:71], v24, s[56:59], s66 offen offset:0 sc1
  v_mfma_f32_16x16x32_bf16 v[160:163], v[72:75], v[128:131], v[160:163]
  ds_read_b128 v[112:115], v9 offset:4096
  v_mfma_f32_16x16x32_bf16 v[164:167], v[72:75], v[132:135], v[164:167]
  ds_read_b128 v[116:119], v9 offset:22528
  v_mfma_f32_16x16x32_bf16 v[168:171], v[76:79], v[120:123], v[168:171]
  v_mfma_f32_16x16x32_bf16 v[172:175], v[76:79], v[124:127], v[172:175]
  buffer_load_dwordx4 v[72:75], v25, s[56:59], s66 offen offset:0 sc1
  v_mfma_f32_16x16x32_bf16 v[176:179], v[76:79], v[128:131], v[176:179]
  v_mfma_f32_16x16x32_bf16 v[180:183], v[76:79], v[132:135], v[180:183]
  s_waitcnt vmcnt(20) lgkmcnt(0)
  v_mfma_f32_16x16x32_bf16 v[136:139], v[80:83], v[104:107], v[136:139]
  v_mfma_f32_16x16x32_bf16 v[140:143], v[80:83], v[108:111], v[140:143]
  buffer_load_dwordx4 v[76:79], v26, s[56:59], s66 offen offset:0 sc1
  v_mfma_f32_16x16x32_bf16 v[144:147], v[80:83], v[112:115], v[144:147]
  ds_read_b128 v[120:123], v8 offset:5120
  v_mfma_f32_16x16x32_bf16 v[148:151], v[80:83], v[116:119], v[148:151]
  ds_read_b128 v[124:127], v8 offset:23552
  v_mfma_f32_16x16x32_bf16 v[152:155], v[84:87], v[104:107], v[152:155]
  s_add_u32 s66, s66, 36864
  v_mfma_f32_16x16x32_bf16 v[156:159], v[84:87], v[108:111], v[156:159]
  buffer_load_dwordx4 v[80:83], v24, s[56:59], s66 offen offset:0 sc1
  v_mfma_f32_16x16x32_bf16 v[160:163], v[84:87], v[112:115], v[160:163]
  ds_read_b128 v[128:131], v9 offset:5120
  v_mfma_f32_16x16x32_bf16 v[164:167], v[84:87], v[116:119], v[164:167]
  ds_read_b128 v[132:135], v9 offset:23552
  v_mfma_f32_16x16x32_bf16 v[168:171], v[88:91], v[104:107], v[168:171]
  v_mfma_f32_16x16x32_bf16 v[172:175], v[88:91], v[108:111], v[172:175]
  buffer_load_dwordx4 v[84:87], v25, s[56:59], s66 offen offset:0 sc1
  v_mfma_f32_16x16x32_bf16 v[176:179], v[88:91], v[112:115], v[176:179]
  v_mfma_f32_16x16x32_bf16 v[180:183], v[88:91], v[116:119], v[180:183]
  s_waitcnt vmcnt(20) lgkmcnt(0)
  v_mfma_f32_16x16x32_bf16 v[136:139], v[92:95], v[120:123], v[136:139]
  v_mfma_f32_16x16x32_bf16 v[140:143], v[92:95], v[124:127], v[140:143]
  buffer_load_dwordx4 v[88:91], v26, s[56:59], s66 offen offset:0 sc1
  v_mfma_f32_16x16x32_bf16 v[144:147], v[92:95], v[128:131], v[144:147]
  ds_read_b128 v[104:107], v8 offset:6144
  v_mfma_f32_16x16x32_bf16 v[148:151], v[92:95], v[132:135], v[148:151]
  ds_read_b128 v[108:111], v8 offset:24576
  v_mfma_f32_16x16x32_bf16 v[152:155], v[96:99], v[120:123], v[152:155]
  s_add_u32 s66, s66, 36864
  v_mfma_f32_16x16x32_bf16 v[156:159], v[96:99], v[124:127], v[156:159]
  buffer_load_dwordx4 v[92:95], v24, s[56:59], s66 offen offset:0 sc1
  v_mfma_f32_16x16x32_bf16 v[160:163], v[96:99], v[128:131], v[160:163]
  ds_read_b128 v[112:115], v9 offset:6144
  v_mfma_f32_16x16x32_bf16 v[164:167], v[96:99], v[132:135], v[164:167]
  ds_read_b128 v[116:119], v9 offset:24576
  v_mfma_f32_16x16x32_bf16 v[168:171], v[100:103], v[120:123], v[168:171]
  v_mfma_f32_16x16x32_bf16 v[172:175], v[100:103], v[124:127], v[172:175]
  buffer_load_dwordx4 v[96:99], v25, s[56:59], s66 offen offset:0 sc1
  v_mfma_f32_16x16x32_bf16 v[176:179], v[100:103], v[128:131], v[176:179]
  v_mfma_f32_16x16x32_bf16 v[180:183], v[100:103], v[132:135], v[180:183]
  s_waitcnt vmcnt(14) lgkmcnt(0)
  v_mfma_f32_16x16x32_bf16 v[136:139], v[32:35], v[104:107], v[136:139]
  v_mfma_f32_16x16x32_bf16 v[140:143], v[32:35], v[108:111], v[140:143]
  buffer_load_dwordx4 v[100:103], v26, s[56:59], s66 offen offset:0 sc1
  v_mfma_f32_16x16x32_bf16 v[144:147], v[32:35], v[112:115], v[144:147]
  ds_read_b128 v[120:123], v8 offset:7168
  v_mfma_f32_16x16x32_bf16 v[148:151], v[32:35], v[116:119], v[148:151]
  ds_read_b128 v[124:127], v8 offset:25600
  v_mfma_f32_16x16x32_bf16 v[152:155], v[36:39], v[104:107], v[152:155]
  s_add_u32 s66, s66, 36864
  v_mfma_f32_16x16x32_bf16 v[156:159], v[36:39], v[108:111], v[156:159]
  buffer_load_dwordx4 v[32:35], v24, s[56:59], s66 offen offset:0 sc1
  v_mfma_f32_16x16x32_bf16 v[160:163], v[36:39], v[112:115], v[160:163]
  ds_read_b128 v[128:131], v9 offset:7168
  v_mfma_f32_16x16x32_bf16 v[164:167], v[36:39], v[116:119], v[164:167]
  ds_read_b128 v[132:135], v9 offset:25600
  v_mfma_f32_16x16x32_bf16 v[168:171], v[40:43], v[104:107], v[168:171]
  v_mfma_f32_16x16x32_bf16 v[172:175], v[40:43], v[108:111], v[172:175]
  buffer_load_dwordx4 v[36:39], v25, s[56:59], s66 offen offset:0 sc1
  v_mfma_f32_16x16x32_bf16 v[176:179], v[40:43], v[112:115], v[176:179]
  v_mfma_f32_16x16x32_bf16 v[180:183], v[40:43], v[116:119], v[180:183]
  s_waitcnt vmcnt(14) lgkmcnt(0)
  v_mfma_f32_16x16x32_bf16 v[136:139], v[44:47], v[120:123], v[136:139]
  v_mfma_f32_16x16x32_bf16 v[140:143], v[44:47], v[124:127], v[140:143]
  buffer_load_dwordx4 v[40:43], v26, s[56:59], s66 offen offset:0 sc1
  v_mfma_f32_16x16x32_bf16 v[144:147], v[44:47], v[128:131], v[144:147]
  ds_read_b128 v[104:107], v8 offset:8192
  v_mfma_f32_16x16x32_bf16 v[148:151], v[44:47], v[132:135], v[148:151]
  ds_read_b128 v[108:111], v8 offset:26624
  v_mfma_f32_16x16x32_bf16 v[152:155], v[48:51], v[120:123], v[152:155]
  s_add_u32 s66, s66, 36864
  v_mfma_f32_16x16x32_bf16 v[156:159], v[48:51], v[124:127], v[156:159]
  buffer_load_dwordx4 v[44:47], v24, s[56:59], s66 offen offset:0 sc1
  v_mfma_f32_16x16x32_bf16 v[160:163], v[48:51], v[128:131], v[160:163]
  ds_read_b128 v[112:115], v9 offset:8192
  v_mfma_f32_16x16x32_bf16 v[164:167], v[48:51], v[132:135], v[164:167]
  ds_read_b128 v[116:119], v9 offset:26624
  v_mfma_f32_16x16x32_bf16 v[168:171], v[52:55], v[120:123], v[168:171]
  v_mfma_f32_16x16x32_bf16 v[172:175], v[52:55], v[124:127], v[172:175]
  buffer_load_dwordx4 v[48:51], v25, s[56:59], s66 offen offset:0 sc1
  v_mfma_f32_16x16x32_bf16 v[176:179], v[52:55], v[128:131], v[176:179]
  v_mfma_f32_16x16x32_bf16 v[180:183], v[52:55], v[132:135], v[180:183]
  s_waitcnt vmcnt(14) lgkmcnt(0)
  v_mfma_f32_16x16x32_bf16 v[136:139], v[56:59], v[104:107], v[136:139]
  v_mfma_f32_16x16x32_bf16 v[140:143], v[56:59], v[108:111], v[140:143]
  buffer_load_dwordx4 v[52:55], v26, s[56:59], s66 offen offset:0 sc1
  v_mfma_f32_16x16x32_bf16 v[144:147], v[56:59], v[112:115], v[144:147]
  ds_read_b128 v[120:123], v8 offset:9216
  v_mfma_f32_16x16x32_bf16 v[148:151], v[56:59], v[116:119], v[148:151]
  ds_read_b128 v[124:127], v8 offset:27648
  v_mfma_f32_16x16x32_bf16 v[152:155], v[60:63], v[104:107], v[152:155]
  s_add_u32 s66, s66, 36864
  v_mfma_f32_16x16x32_bf16 v[156:159], v[60:63], v[108:111], v[156:159]
  buffer_load_dwordx4 v[56:59], v24, s[56:59], s66 offen offset:0 sc1
  v_mfma_f32_16x16x32_bf16 v[160:163], v[60:63], v[112:115], v[160:163]
  ds_read_b128 v[128:131], v9 offset:9216
  v_mfma_f32_16x16x32_bf16 v[164:167], v[60:63], v[116:119], v[164:167]
  ds_read_b128 v[132:135], v9 offset:27648
  v_mfma_f32_16x16x32_bf16 v[168:171], v[64:67], v[104:107], v[168:171]
  v_mfma_f32_16x16x32_bf16 v[172:175], v[64:67], v[108:111], v[172:175]
  buffer_load_dwordx4 v[60:63], v25, s[56:59], s66 offen offset:0 sc1
  v_mfma_f32_16x16x32_bf16 v[176:179], v[64:67], v[112:115], v[176:179]
  v_mfma_f32_16x16x32_bf16 v[180:183], v[64:67], v[116:119], v[180:183]
  s_waitcnt vmcnt(14) lgkmcnt(0)
  v_mfma_f32_16x16x32_bf16 v[136:139], v[68:71], v[120:123], v[136:139]
  v_mfma_f32_16x16x32_bf16 v[140:143], v[68:71], v[124:127], v[140:143]
  buffer_load_dwordx4 v[64:67], v26, s[56:59], s66 offen offset:0 sc1
  v_mfma_f32_16x16x32_bf16 v[144:147], v[68:71], v[128:131], v[144:147]
  ds_read_b128 v[104:107], v8 offset:10240
  v_mfma_f32_16x16x32_bf16 v[148:151], v[68:71], v[132:135], v[148:151]
  ds_read_b128 v[108:111], v8 offset:28672
  v_mfma_f32_16x16x32_bf16 v[152:155], v[72:75], v[120:123], v[152:155]
  s_add_u32 s66, s66, 36864
  v_mfma_f32_16x16x32_bf16 v[156:159], v[72:75], v[124:127], v[156:159]
  buffer_load_dwordx4 v[68:71], v24, s[56:59], s66 offen offset:0 sc1
  v_mfma_f32_16x16x32_bf16 v[160:163], v[72:75], v[128:131], v[160:163]
  ds_read_b128 v[112:115], v9 offset:10240
  v_mfma_f32_16x16x32_bf16 v[164:167], v[72:75], v[132:135], v[164:167]
  ds_read_b128 v[116:119], v9 offset:28672
  v_mfma_f32_16x16x32_bf16 v[168:171], v[76:79], v[120:123], v[168:171]
  v_mfma_f32_16x16x32_bf16 v[172:175], v[76:79], v[124:127], v[172:175]
  buffer_load_dwordx4 v[72:75], v25, s[56:59], s66 offen offset:0 sc1
  v_mfma_f32_16x16x32_bf16 v[176:179], v[76:79], v[128:131], v[176:179]
  v_mfma_f32_16x16x32_bf16 v[180:183], v[76:79], v[132:135], v[180:183]
  s_waitcnt vmcnt(14) lgkmcnt(0)
  v_mfma_f32_16x16x32_bf16 v[136:139], v[80:83], v[104:107], v[136:139]
  v_mfma_f32_16x16x32_bf16 v[140:143], v[80:83], v[108:111], v[140:143]
  buffer_load_dwordx4 v[76:79], v26, s[56:59], s66 offen offset:0 sc1
  v_mfma_f32_16x16x32_bf16 v[144:147], v[80:83], v[112:115], v[144:147]
  ds_read_b128 v[120:123], v8 offset:11264
  v_mfma_f32_16x16x32_bf16 v[148:151], v[80:83], v[116:119], v[148:151]
  ds_read_b128 v[124:127], v8 offset:29696
  v_mfma_f32_16x16x32_bf16 v[152:155], v[84:87], v[104:107], v[152:155]
  s_add_u32 s66, s66, 36864
  v_mfma_f32_16x16x32_bf16 v[156:159], v[84:87], v[108:111], v[156:159]
  buffer_load_dwordx4 v[80:83], v24, s[56:59], s66 offen offset:0 sc1
  v_mfma_f32_16x16x32_bf16 v[160:163], v[84:87], v[112:115], v[160:163]
  ds_read_b128 v[128:131], v9 offset:11264
  v_mfma_f32_16x16x32_bf16 v[164:167], v[84:87], v[116:119], v[164:167]
  ds_read_b128 v[132:135], v9 offset:29696
  v_mfma_f32_16x16x32_bf16 v[168:171], v[88:91], v[104:107], v[168:171]
  v_mfma_f32_16x16x32_bf16 v[172:175], v[88:91], v[108:111], v[172:175]
  buffer_load_dwordx4 v[84:87], v25, s[56:59], s66 offen offset:0 sc1
  v_mfma_f32_16x16x32_bf16 v[176:179], v[88:91], v[112:115], v[176:179]
  v_mfma_f32_16x16x32_bf16 v[180:183], v[88:91], v[116:119], v[180:183]
  s_waitcnt vmcnt(14) lgkmcnt(0)
  v_mfma_f32_16x16x32_bf16 v[136:139], v[92:95], v[120:123], v[136:139]
  v_mfma_f32_16x16x32_bf16 v[140:143], v[92:95], v[124:127], v[140:143]
  buffer_load_dwordx4 v[88:91], v26, s[56:59], s66 offen offset:0 sc1
  v_mfma_f32_16x16x32_bf16 v[144:147], v[92:95], v[128:131], v[144:147]
  ds_read_b128 v[104:107], v8 offset:12288
  v_mfma_f32_16x16x32_bf16 v[148:151], v[92:95], v[132:135], v[148:151]
  ds_read_b128 v[108:111], v8 offset:30720
  v_mfma_f32_16x16x32_bf16 v[152:155], v[96:99], v[120:123], v[152:155]
  s_add_u32 s66, s66, 36864
  v_mfma_f32_16x16x32_bf16 v[156:159], v[96:99], v[124:127], v[156:159]
  buffer_load_dwordx4 v[92:95], v24, s[56:59], s66 offen offset:0 sc1
  v_mfma_f32_16x16x32_bf16 v[160:163], v[96:99], v[128:131], v[160:163]
  ds_read_b128 v[112:115], v9 offset:12288
  v_mfma_f32_16x16x32_bf16 v[164:167], v[96:99], v[132:135], v[164:167]
  ds_read_b128 v[116:119], v9 offset:30720
  v_mfma_f32_16x16x32_bf16 v[168:171], v[100:103], v[120:123], v[168:171]
  v_mfma_f32_16x16x32_bf16 v[172:175], v[100:103], v[124:127], v[172:175]
  buffer_load_dwordx4 v[96:99], v25, s[56:59], s66 offen offset:0 sc1
  v_mfma_f32_16x16x32_bf16 v[176:179], v[100:103], v[128:131], v[176:179]
  v_mfma_f32_16x16x32_bf16 v[180:183], v[100:103], v[132:135], v[180:183]
  s_waitcnt vmcnt(14) lgkmcnt(0)
  v_mfma_f32_16x16x32_bf16 v[136:139], v[32:35], v[104:107], v[136:139]
  v_mfma_f32_16x16x32_bf16 v[140:143], v[32:35], v[108:111], v[140:143]
  buffer_load_dwordx4 v[100:103], v26, s[56:59], s66 offen offset:0 sc1
  v_mfma_f32_16x16x32_bf16 v[144:147], v[32:35], v[112:115], v[144:147]
  ds_read_b128 v[120:123], v8 offset:13312
  v_mfma_f32_16x16x32_bf16 v[148:151], v[32:35], v[116:119], v[148:151]
  ds_read_b128 v[124:127], v8 offset:31744
  v_mfma_f32_16x16x32_bf16 v[152:155], v[36:39], v[104:107], v[152:155]
  v_mfma_f32_16x16x32_bf16 v[156:159], v[36:39], v[108:111], v[156:159]
  buffer_load_dwordx4 v[32:35], v27, s[56:59], s68 offen offset:0 sc1
  v_mfma_f32_16x16x32_bf16 v[160:163], v[36:39], v[112:115], v[160:163]
  ds_read_b128 v[128:131], v9 offset:13312
  v_mfma_f32_16x16x32_bf16 v[164:167], v[36:39], v[116:119], v[164:167]
  ds_read_b128 v[132:135], v9 offset:31744
  v_mfma_f32_16x16x32_bf16 v[168:171], v[40:43], v[104:107], v[168:171]
  s_add_u32 s68, s68, 36864
  v_mfma_f32_16x16x32_bf16 v[172:175], v[40:43], v[108:111], v[172:175]
  buffer_load_dwordx4 v[36:39], v27, s[56:59], s68 offen offset:0 sc1
  v_mfma_f32_16x16x32_bf16 v[176:179], v[40:43], v[112:115], v[176:179]
  v_mfma_f32_16x16x32_bf16 v[180:183], v[40:43], v[116:119], v[180:183]
  s_waitcnt vmcnt(14) lgkmcnt(0)
  v_mfma_f32_16x16x32_bf16 v[136:139], v[44:47], v[120:123], v[136:139]
  s_add_u32 s68, s68, 36864
  v_mfma_f32_16x16x32_bf16 v[140:143], v[44:47], v[124:127], v[140:143]
  buffer_load_dwordx4 v[40:43], v27, s[56:59], s68 offen offset:0 sc1
  v_mfma_f32_16x16x32_bf16 v[144:147], v[44:47], v[128:131], v[144:147]
  ds_read_b128 v[104:107], v8 offset:14336
  v_mfma_f32_16x16x32_bf16 v[148:151], v[44:47], v[132:135], v[148:151]
  ds_read_b128 v[108:111], v8 offset:32768
  v_mfma_f32_16x16x32_bf16 v[152:155], v[48:51], v[120:123], v[152:155]
  s_add_u32 s68, s68, 36864
  v_mfma_f32_16x16x32_bf16 v[156:159], v[48:51], v[124:127], v[156:159]
  buffer_load_dwordx4 v[44:47], v27, s[56:59], s68 offen offset:0 sc1
  v_mfma_f32_16x16x32_bf16 v[160:163], v[48:51], v[128:131], v[160:163]
  ds_read_b128 v[112:115], v9 offset:14336
  v_mfma_f32_16x16x32_bf16 v[164:167], v[48:51], v[132:135], v[164:167]
  ds_read_b128 v[116:119], v9 offset:32768
  v_mfma_f32_16x16x32_bf16 v[168:171], v[52:55], v[120:123], v[168:171]
  s_add_u32 s68, s68, 36864
  v_mfma_f32_16x16x32_bf16 v[172:175], v[52:55], v[124:127], v[172:175]
  buffer_load_dwordx4 v[48:51], v27, s[56:59], s68 offen offset:0 sc1
  v_mfma_f32_16x16x32_bf16 v[176:179], v[52:55], v[128:131], v[176:179]
  v_mfma_f32_16x16x32_bf16 v[180:183], v[52:55], v[132:135], v[180:183]
  s_waitcnt vmcnt(14) lgkmcnt(0)
  v_mfma_f32_16x16x32_bf16 v[136:139], v[56:59], v[104:107], v[136:139]
  s_add_u32 s68, s68, 36864
  v_mfma_f32_16x16x32_bf16 v[140:143], v[56:59], v[108:111], v[140:143]
  buffer_load_dwordx4 v[52:55], v27, s[56:59], s68 offen offset:0 sc1
  v_mfma_f32_16x16x32_bf16 v[144:147], v[56:59], v[112:115], v[144:147]
  ds_read_b128 v[120:123], v8 offset:15360
  v_mfma_f32_16x16x32_bf16 v[148:151], v[56:59], v[116:119], v[148:151]
  ds_read_b128 v[124:127], v8 offset:33792
  v_mfma_f32_16x16x32_bf16 v[152:155], v[60:63], v[104:107], v[152:155]
  s_add_u32 s68, s68, 36864
  v_mfma_f32_16x16x32_bf16 v[156:159], v[60:63], v[108:111], v[156:159]
  buffer_load_dwordx4 v[56:59], v27, s[56:59], s68 offen offset:0 sc1
  v_mfma_f32_16x16x32_bf16 v[160:163], v[60:63], v[112:115], v[160:163]
  ds_read_b128 v[128:131], v9 offset:15360
  v_mfma_f32_16x16x32_bf16 v[164:167], v[60:63], v[116:119], v[164:167]
  ds_read_b128 v[132:135], v9 offset:33792
  v_mfma_f32_16x16x32_bf16 v[168:171], v[64:67], v[104:107], v[168:171]
  s_add_u32 s68, s68, 36864
  v_mfma_f32_16x16x32_bf16 v[172:175], v[64:67], v[108:111], v[172:175]
  buffer_load_dwordx4 v[60:63], v27, s[56:59], s68 offen offset:0 sc1
  v_mfma_f32_16x16x32_bf16 v[176:179], v[64:67], v[112:115], v[176:179]
  v_mfma_f32_16x16x32_bf16 v[180:183], v[64:67], v[116:119], v[180:183]
  s_waitcnt vmcnt(14) lgkmcnt(0)
  v_mfma_f32_16x16x32_bf16 v[136:139], v[68:71], v[120:123], v[136:139]
  s_add_u32 s68, s68, 36864
  v_mfma_f32_16x16x32_bf16 v[140:143], v[68:71], v[124:127], v[140:143]
  buffer_load_dwordx4 v[64:67], v27, s[56:59], s68 offen offset:0 sc1
  v_mfma_f32_16x16x32_bf16 v[144:147], v[68:71], v[128:131], v[144:147]
  ds_read_b128 v[104:107], v8 offset:16384
  v_mfma_f32_16x16x32_bf16 v[148:151], v[68:71], v[132:135], v[148:151]
  ds_read_b128 v[108:111], v8 offset:34816
  v_mfma_f32_16x16x32_bf16 v[152:155], v[72:75], v[120:123], v[152:155]
  s_add_u32 s68, s68, 36864
  v_mfma_f32_16x16x32_bf16 v[156:159], v[72:75], v[124:127], v[156:159]
  buffer_load_dwordx4 v[68:71], v27, s[56:59], s68 offen offset:0 sc1
  v_mfma_f32_16x16x32_bf16 v[160:163], v[72:75], v[128:131], v[160:163]
  ds_read_b128 v[112:115], v9 offset:16384
  v_mfma_f32_16x16x32_bf16 v[164:167], v[72:75], v[132:135], v[164:167]
  ds_read_b128 v[116:119], v9 offset:34816
  v_mfma_f32_16x16x32_bf16 v[168:171], v[76:79], v[120:123], v[168:171]
  s_add_u32 s68, s68, 36864
  v_mfma_f32_16x16x32_bf16 v[172:175], v[76:79], v[124:127], v[172:175]
  buffer_load_dwordx4 v[72:75], v27, s[56:59], s68 offen offset:0 sc1
  v_mfma_f32_16x16x32_bf16 v[176:179], v[76:79], v[128:131], v[176:179]
  v_mfma_f32_16x16x32_bf16 v[180:183], v[76:79], v[132:135], v[180:183]
  s_waitcnt vmcnt(14) lgkmcnt(0)
  v_mfma_f32_16x16x32_bf16 v[136:139], v[80:83], v[104:107], v[136:139]
  s_add_u32 s68, s68, 36864
  v_mfma_f32_16x16x32_bf16 v[140:143], v[80:83], v[108:111], v[140:143]
  buffer_load_dwordx4 v[76:79], v27, s[56:59], s68 offen offset:0 sc1
  v_mfma_f32_16x16x32_bf16 v[144:147], v[80:83], v[112:115], v[144:147]
  ds_read_b128 v[120:123], v8 offset:17408
  v_mfma_f32_16x16x32_bf16 v[148:151], v[80:83], v[116:119], v[148:151]
  ds_read_b128 v[124:127], v8 offset:35840
  v_mfma_f32_16x16x32_bf16 v[152:155], v[84:87], v[104:107], v[152:155]
  s_add_u32 s68, s68, 36864
  v_mfma_f32_16x16x32_bf16 v[156:159], v[84:87], v[108:111], v[156:159]
  buffer_load_dwordx4 v[80:83], v27, s[56:59], s68 offen offset:0 sc1
  v_mfma_f32_16x16x32_bf16 v[160:163], v[84:87], v[112:115], v[160:163]
  ds_read_b128 v[128:131], v9 offset:17408
  v_mfma_f32_16x16x32_bf16 v[164:167], v[84:87], v[116:119], v[164:167]
  ds_read_b128 v[132:135], v9 offset:35840
  v_mfma_f32_16x16x32_bf16 v[168:171], v[88:91], v[104:107], v[168:171]
  s_add_u32 s68, s68, 36864
  v_mfma_f32_16x16x32_bf16 v[172:175], v[88:91], v[108:111], v[172:175]
  buffer_load_dwordx4 v[84:87], v27, s[56:59], s68 offen offset:0 sc1
  v_mfma_f32_16x16x32_bf16 v[176:179], v[88:91], v[112:115], v[176:179]
  v_mfma_f32_16x16x32_bf16 v[180:183], v[88:91], v[116:119], v[180:183]
  s_waitcnt vmcnt(14) lgkmcnt(0)
  v_mfma_f32_16x16x32_bf16 v[136:139], v[92:95], v[120:123], v[136:139]
  s_add_u32 s68, s68, 36864
  v_mfma_f32_16x16x32_bf16 v[140:143], v[92:95], v[124:127], v[140:143]
  buffer_load_dwordx4 v[88:91], v27, s[56:59], s68 offen offset:0 sc1
  v_mfma_f32_16x16x32_bf16 v[144:147], v[92:95], v[128:131], v[144:147]
  v_mfma_f32_16x16x32_bf16 v[148:151], v[92:95], v[132:135], v[148:151]
  v_mfma_f32_16x16x32_bf16 v[152:155], v[96:99], v[120:123], v[152:155]
  s_add_u32 s68, s68, 36864
  v_mfma_f32_16x16x32_bf16 v[156:159], v[96:99], v[124:127], v[156:159]
  buffer_load_dwordx4 v[92:95], v27, s[56:59], s68 offen offset:0 sc1
  v_mfma_f32_16x16x32_bf16 v[160:163], v[96:99], v[128:131], v[160:163]
  v_mfma_f32_16x16x32_bf16 v[164:167], v[96:99], v[132:135], v[164:167]
  v_mfma_f32_16x16x32_bf16 v[168:171], v[100:103], v[120:123], v[168:171]
  s_add_u32 s68, s68, 36864
  v_mfma_f32_16x16x32_bf16 v[172:175], v[100:103], v[124:127], v[172:175]
  buffer_load_dwordx4 v[96:99], v27, s[56:59], s68 offen offset:0 sc1
  v_mfma_f32_16x16x32_bf16 v[176:179], v[100:103], v[128:131], v[176:179]
  v_mfma_f32_16x16x32_bf16 v[180:183], v[100:103], v[132:135], v[180:183]
  s_add_u32 s68, s68, 36864
  buffer_load_dwordx4 v[100:103], v27, s[56:59], s68 offen offset:0 sc1
  s_setprio 0
  s_setprio 3
  s_nop 7
  s_lshl_b32 s6, s44, 1
  s_add_u32 s6, s6, s67
  v_cvt_pk_bf16_f32 v224, v136, v137
  v_cvt_pk_bf16_f32 v225, v138, v139
  v_cvt_pk_bf16_f32 v226, v140, v141
  v_cvt_pk_bf16_f32 v227, v142, v143
  buffer_store_dwordx4 v[224:227], v2, s[56:59], s6 offen offset:0 sc1
  v_cvt_pk_bf16_f32 v228, v144, v145
  v_cvt_pk_bf16_f32 v229, v146, v147
  v_cvt_pk_bf16_f32 v230, v148, v149
  v_cvt_pk_bf16_f32 v231, v150, v151
  buffer_store_dwordx4 v[228:231], v2, s[56:59], s6 offen offset:1024 sc1
  s_lshl_b32 s6, s45, 1
  s_add_u32 s6, s6, s67
  v_cvt_pk_bf16_f32 v232, v152, v153
  v_cvt_pk_bf16_f32 v233, v154, v155
  v_cvt_pk_bf16_f32 v234, v156, v157
  v_cvt_pk_bf16_f32 v235, v158, v159
  buffer_store_dwordx4 v[232:235], v2, s[56:59], s6 offen offset:0 sc1
  v_cvt_pk_bf16_f32 v236, v160, v161
  v_cvt_pk_bf16_f32 v237, v162, v163
  v_cvt_pk_bf16_f32 v238, v164, v165
  v_cvt_pk_bf16_f32 v239, v166, v167
  buffer_store_dwordx4 v[236:239], v2, s[56:59], s6 offen offset:1024 sc1
  s_lshl_b32 s6, s46, 1
  s_add_u32 s6, s6, s67
  v_cvt_pk_bf16_f32 v224, v168, v169
  v_cvt_pk_bf16_f32 v225, v170, v171
  v_cvt_pk_bf16_f32 v226, v172, v173
  v_cvt_pk_bf16_f32 v227, v174, v175
  buffer_store_dwordx4 v[224:227], v2, s[56:59], s6 offen offset:0 sc1
  v_cvt_pk_bf16_f32 v228, v176, v177
  v_cvt_pk_bf16_f32 v229, v178, v179
  v_cvt_pk_bf16_f32 v230, v180, v181
  v_cvt_pk_bf16_f32 v231, v182, v183
  buffer_store_dwordx4 v[228:231], v2, s[56:59], s6 offen offset:1024 sc1
  s_setprio 0
LW_63:
  ds_read_b32 v5, v16 offset:24
  s_waitcnt lgkmcnt(0)
  v_readfirstlane_b32 s7, v5
  s_cmp_ge_u32 s7, 4
  s_cbranch_scc1 LD_64
  s_sleep 1
  s_branch LW_63
LD_64:
  s_nop 1
  s_mov_b32 s48, s38
  s_mov_b32 s49, s39
  s_mov_b32 s50, 2359296
  s_mov_b32 s51, 0x20000
  v_and_b32 v5, 15, v1
  v_lshrrev_b32 v6, 4, v1
  s_lshl_b32 s65, s3, 5
  s_add_u32 s6, s65, s53
  v_mul_u32_u24 v7, 160, v5
  v_lshl_add_u32 v7, v6, 3, v7
  v_add_u32 v7, s6, v7
  v_add_u32 v10, 36864, v7
  v_lshrrev_b32 v15, 1, v6
  v_mul_u32_u24 v15, 18432, v15
  v_bfe_u32 v14, v1, 2, 3
  v_lshl_add_u32 v15, v14, 7, v15
  v_and_b32 v14, 3, v1
  v_lshl_add_u32 v15, v14, 3, v15
  s_and_b32 s10, s3, 1
  s_mul_i32 s10, s10, 36864
  s_lshr_b32 s11, s3, 1
  s_lshl_b32 s11, s11, 10
  s_add_u32 s10, s10, s11
  s_add_u32 s10, s10, s53
  s_add_u32 s10, s10, 3072
  v_add_u32 v15, s10, v15
  v_lshlrev_b32 v14, 4, v5
  v_add_u32 v14, 158720, v14
  s_add_u32 s8, s3, s52
  s_lshr_b32 s10, s8, 1
  s_lshl_b32 s10, s10, 10
  s_and_b32 s11, s8, 1
  s_lshl_b32 s11, s11, 3
  s_add_u32 s10, s10, s11
  v_add_u32 v12, s10, v2
  v_add_u32 v13, 36864, v12
  ds_read_b64 v[216:217], v12 offset:0
  ds_read_b64 v[224:225], v7 offset:0
  ds_read_b64_tr_b16 v[232:233], v15 offset:0
  ds_read_b128 v[240:243], v14 offset:0
  ds_read_b64 v[218:219], v12 offset:18432
  ds_read_b64 v[226:227], v7 offset:18432
  ds_read_b64_tr_b16 v[234:235], v15 offset:32
  ds_read_b128 v[244:247], v14 offset:256
  ds_read_b64 v[220:221], v13 offset:0
  ds_read_b64 v[228:229], v10 offset:0
  ds_read_b64_tr_b16 v[236:237], v15 offset:64
  ds_read_b128 v[248:251], v14 offset:512
  ds_read_b64 v[222:223], v13 offset:18432
  ds_read_b64 v[230:231], v10 offset:18432
  ds_read_b64_tr_b16 v[238:239], v15 offset:96
  ds_read_b128 v[252:255], v14 offset:768
  s_lshl_b32 s9, s8, 11
  s_add_u32 s9, s9, s54
  s_add_u32 s70, s9, 21102592
  s_lshl_b32 s9, s8, 5
  s_add_u32 s71, s9, s69
  s_add_u32 s65, s65, s55
  s_add_u32 s66, s65, 36864
  v_lshrrev_b32 v5, 5, v1
  v_bfe_u32 v6, v1, 1, 4
  v_and_b32 v11, 1, v1
  v_mul_u32_u24 v18, 18432, v5
  v_lshl_add_u32 v18, v11, 4, v18
  v_mul_u32_u24 v19, 160, v6
  v_add3_u32 v19, v19, v18, s6
  v_mul_u32_u24 v6, 1152, v6
  v_add_u32 v18, v18, v6
  s_waitcnt lgkmcnt(0)
  v_mov_b32 v20, v240
  v_rcp_f32 v240, v240
  v_mov_b32 v21, v244
  v_rcp_f32 v244, v244
  v_mov_b32 v22, v248
  v_rcp_f32 v248, v248
  v_mov_b32 v23, v252
  v_rcp_f32 v252, v252
  v_lshlrev_b32 v168, 16, v224
  v_and_b32 v169, 0xffff0000, v224
  v_lshlrev_b32 v200, 16, v216
  v_and_b32 v201, 0xffff0000, v216
  v_lshlrev_b32 v184, 16, v232
  v_and_b32 v185, 0xffff0000, v232
  v_fma_f32 v5, v168, v242, v243
  v_fma_f32 v6, v169, v242, v243
  v_add_f32 v200, v200, v241
  v_add_f32 v201, v201, v241
  v_mul_f32 v184, v184, v5
  v_mul_f32 v185, v185, v6
  v_mul_f32 v200, v200, v240
  v_mul_f32 v201, v201, v240
  v_lshlrev_b32 v170, 16, v225
  v_and_b32 v171, 0xffff0000, v225
  v_lshlrev_b32 v202, 16, v217
  v_and_b32 v203, 0xffff0000, v217
  v_lshlrev_b32 v186, 16, v233
  v_and_b32 v187, 0xffff0000, v233
  v_fma_f32 v5, v170, v242, v243
  v_fma_f32 v6, v171, v242, v243
  v_add_f32 v202, v202, v241
  v_add_f32 v203, v203, v241
  v_mul_f32 v186, v186, v5
  v_mul_f32 v187, v187, v6
  v_mul_f32 v202, v202, v240
  v_mul_f32 v203, v203, v240
  v_lshlrev_b32 v172, 16, v226
  v_and_b32 v173, 0xffff0000, v226
  v_lshlrev_b32 v204, 16, v218
  v_and_b32 v205, 0xffff0000, v218
  v_lshlrev_b32 v188, 16, v234
  v_and_b32 v189, 0xffff0000, v234
  v_fma_f32 v5, v172, v246, v247
  v_fma_f32 v6, v173, v246, v247
  v_add_f32 v204, v204, v245
  v_add_f32 v205, v205, v245
  v_mul_f32 v188, v188, v5
  v_mul_f32 v189, v189, v6
  v_mul_f32 v204, v204, v244
  v_mul_f32 v205, v205, v244
  v_lshlrev_b32 v174, 16, v227
  v_and_b32 v175, 0xffff0000, v227
  v_lshlrev_b32 v206, 16, v219
  v_and_b32 v207, 0xffff0000, v219
  v_lshlrev_b32 v190, 16, v235
  v_and_b32 v191, 0xffff0000, v235
  v_fma_f32 v5, v174, v246, v247
  v_fma_f32 v6, v175, v246, v247
  v_add_f32 v206, v206, v245
  v_add_f32 v207, v207, v245
  v_mul_f32 v190, v190, v5
  v_mul_f32 v191, v191, v6
  v_mul_f32 v206, v206, v244
  v_mul_f32 v207, v207, v244
  v_lshlrev_b32 v176, 16, v228
  v_and_b32 v177, 0xffff0000, v228
  v_lshlrev_b32 v208, 16, v220
  v_and_b32 v209, 0xffff0000, v220
  v_lshlrev_b32 v192, 16, v236
  v_and_b32 v193, 0xffff0000, v236
  v_fma_f32 v5, v176, v250, v251
  v_fma_f32 v6, v177, v250, v251
  v_add_f32 v208, v208, v249
  v_add_f32 v209, v209, v249
  v_mul_f32 v192, v192, v5
  v_mul_f32 v193, v193, v6
  v_mul_f32 v208, v208, v248
  v_mul_f32 v209, v209, v248
  v_lshlrev_b32 v178, 16, v229
  v_and_b32 v179, 0xffff0000, v229
  v_lshlrev_b32 v210, 16, v221
  v_and_b32 v211, 0xffff0000, v221
  v_lshlrev_b32 v194, 16, v237
  v_and_b32 v195, 0xffff0000, v237
  v_fma_f32 v5, v178, v250, v251
  v_fma_f32 v6, v179, v250, v251
  v_add_f32 v210, v210, v249
  v_add_f32 v211, v211, v249
  v_mul_f32 v194, v194, v5
  v_mul_f32 v195, v195, v6
  v_mul_f32 v210, v210, v248
  v_mul_f32 v211, v211, v248
  v_lshlrev_b32 v180, 16, v230
  v_and_b32 v181, 0xffff0000, v230
  v_lshlrev_b32 v212, 16, v222
  v_and_b32 v213, 0xffff0000, v222
  v_lshlrev_b32 v196, 16, v238
  v_and_b32 v197, 0xffff0000, v238
  v_fma_f32 v5, v180, v254, v255
  v_fma_f32 v6, v181, v254, v255
  v_add_f32 v212, v212, v253
  v_add_f32 v213, v213, v253
  v_mul_f32 v196, v196, v5
  v_mul_f32 v197, v197, v6
  v_mul_f32 v212, v212, v252
  v_mul_f32 v213, v213, v252
  v_lshlrev_b32 v182, 16, v231
  v_and_b32 v183, 0xffff0000, v231
  v_lshlrev_b32 v214, 16, v223
  v_and_b32 v215, 0xffff0000, v223
  v_lshlrev_b32 v198, 16, v239
  v_and_b32 v199, 0xffff0000, v239
  v_fma_f32 v5, v182, v254, v255
  v_fma_f32 v6, v183, v254, v255
  v_add_f32 v214, v214, v253
  v_add_f32 v215, v215, v253
  v_mul_f32 v198, v198, v5
  v_mul_f32 v199, v199, v6
  v_mul_f32 v214, v214, v252
  v_mul_f32 v215, v215, v252
  s_waitcnt vmcnt(0)
  s_mov_b64 exec, 7
  buffer_store_dword v17, v29, s[56:59], s69 offen sc1
  s_mov_b64 exec, -1
  s_mov_b32 s13, 0x40000
FP_65:
  s_load_dwordx8 s[16:23], s[42:43], s71 glc
  s_waitcnt lgkmcnt(0)
  s_and_b32 s17, s17, s18
  s_cbranch_scc1 FD_66
  s_sleep 1
  s_sub_u32 s13, s13, 1
  s_cbranch_scc0 FP_65
FD_66:
  s_sub_u32 s6, s4, 1
  s_and_b32 s6, s6, 7
  s_mul_i32 s6, s6, 2359296
  s_add_u32 s6, s6, s70
  buffer_load_dwordx4 v[104:107], v2, s[56:59], s6 offen offset:0 sc1
  buffer_load_dwordx4 v[108:111], v2, s[56:59], s6 offen offset:1024 sc1
  s_sub_u32 s6, s4, 2
  s_and_b32 s6, s6, 7
  s_mul_i32 s6, s6, 2359296
  s_add_u32 s6, s6, s70
  buffer_load_dwordx4 v[112:115], v2, s[56:59], s6 offen offset:0 sc1
  buffer_load_dwordx4 v[116:119], v2, s[56:59], s6 offen offset:1024 sc1
  s_waitcnt vmcnt(0)
  v_lshlrev_b32 v216, 16, v104
  v_and_b32 v217, 0xffff0000, v104
  v_lshlrev_b32 v218, 16, v105
  v_and_b32 v219, 0xffff0000, v105
  v_lshlrev_b32 v220, 16, v106
  v_and_b32 v221, 0xffff0000, v106
  v_lshlrev_b32 v222, 16, v107
  v_and_b32 v223, 0xffff0000, v107
  v_lshlrev_b32 v224, 16, v108
  v_and_b32 v225, 0xffff0000, v108
  v_lshlrev_b32 v226, 16, v109
  v_and_b32 v227, 0xffff0000, v109
  v_lshlrev_b32 v228, 16, v110
  v_and_b32 v229, 0xffff0000, v110
  v_lshlrev_b32 v230, 16, v111
  v_and_b32 v231, 0xffff0000, v111
  v_add_f32 v200, v200, v216
  v_add_f32 v201, v201, v217
  v_add_f32 v202, v202, v218
  v_add_f32 v203, v203, v219
  v_add_f32 v204, v204, v220
  v_add_f32 v205, v205, v221
  v_add_f32 v206, v206, v222
  v_add_f32 v207, v207, v223
  v_add_f32 v208, v208, v224
  v_add_f32 v209, v209, v225
  v_add_f32 v210, v210, v226
  v_add_f32 v211, v211, v227
  v_add_f32 v212, v212, v228
  v_add_f32 v213, v213, v229
  v_add_f32 v214, v214, v230
  v_add_f32 v215, v215, v231
  v_lshlrev_b32 v216, 16, v112
  v_and_b32 v217, 0xffff0000, v112
  v_lshlrev_b32 v218, 16, v113
  v_and_b32 v219, 0xffff0000, v113
  v_lshlrev_b32 v220, 16, v114
  v_and_b32 v221, 0xffff0000, v114
  v_lshlrev_b32 v222, 16, v115
  v_and_b32 v223, 0xffff0000, v115
  v_lshlrev_b32 v224, 16, v116
  v_and_b32 v225, 0xffff0000, v116
  v_lshlrev_b32 v226, 16, v117
  v_and_b32 v227, 0xffff0000, v117
  v_lshlrev_b32 v228, 16, v118
  v_and_b32 v229, 0xffff0000, v118
  v_lshlrev_b32 v230, 16, v119
  v_and_b32 v231, 0xffff0000, v119
  v_add_f32 v200, v200, v216
  v_add_f32 v201, v201, v217
  v_add_f32 v202, v202, v218
  v_add_f32 v203, v203, v219
  v_add_f32 v204, v204, v220
  v_add_f32 v205, v205, v221
  v_add_f32 v206, v206, v222
  v_add_f32 v207, v207, v223
  v_add_f32 v208, v208, v224
  v_add_f32 v209, v209, v225
  v_add_f32 v210, v210, v226
  v_add_f32 v211, v211, v227
  v_add_f32 v212, v212, v228
  v_add_f32 v213, v213, v229
  v_add_f32 v214, v214, v230
  v_add_f32 v215, v215, v231
  s_setprio 0
  ds_read_b128 v[104:107], v8 offset:0
  ds_read_b128 v[108:111], v8 offset:18432
  ds_read_b128 v[112:115], v9 offset:0
  ds_read_b128 v[116:119], v9 offset:18432
  ds_read_b128 v[120:123], v8 offset:1024
  ds_read_b128 v[124:127], v8 offset:19456
  ds_read_b128 v[128:131], v9 offset:1024
  ds_read_b128 v[132:135], v9 offset:19456
  ds_read_b128 v[136:139], v8 offset:2048
  ds_read_b128 v[140:143], v8 offset:20480
  ds_read_b128 v[144:147], v9 offset:2048
  ds_read_b128 v[148:151], v9 offset:20480
  s_waitcnt vmcnt(23) lgkmcnt(8)
  v_mfma_f32_16x16x32_bf16 v[200:203], v[32:35], v[104:107], v[200:203]
  ds_read_b128 v[152:155], v8 offset:3072
  v_mfma_f32_16x16x32_bf16 v[204:207], v[32:35], v[108:111], v[204:207]
  ds_read_b128 v[156:159], v8 offset:21504
  v_mfma_f32_16x16x32_bf16 v[208:211], v[32:35], v[112:115], v[208:211]
  ds_read_b128 v[160:163], v9 offset:3072
  v_mfma_f32_16x16x32_bf16 v[212:215], v[32:35], v[116:119], v[212:215]
  ds_read_b128 v[164:167], v9 offset:21504
  s_waitcnt vmcnt(22) lgkmcnt(8)
  v_mfma_f32_16x16x32_bf16 v[200:203], v[36:39], v[120:123], v[200:203]
  ds_read_b128 v[104:107], v8 offset:4096
  v_mfma_f32_16x16x32_bf16 v[204:207], v[36:39], v[124:127], v[204:207]
  ds_read_b128 v[108:111], v8 offset:22528
  v_mfma_f32_16x16x32_bf16 v[208:211], v[36:39], v[128:131], v[208:211]
  ds_read_b128 v[112:115], v9 offset:4096
  v_mfma_f32_16x16x32_bf16 v[212:215], v[36:39], v[132:135], v[212:215]
  ds_read_b128 v[116:119], v9 offset:22528
  s_waitcnt vmcnt(21) lgkmcnt(8)
  v_mfma_f32_16x16x32_bf16 v[200:203], v[40:43], v[136:139], v[200:203]
  ds_read_b128 v[120:123], v8 offset:5120
  v_mfma_f32_16x16x32_bf16 v[204:207], v[40:43], v[140:143], v[204:207]
  ds_read_b128 v[124:127], v8 offset:23552
  v_mfma_f32_16x16x32_bf16 v[208:211], v[40:43], v[144:147], v[208:211]
  ds_read_b128 v[128:131], v9 offset:5120
  v_mfma_f32_16x16x32_bf16 v[212:215], v[40:43], v[148:151], v[212:215]
  ds_read_b128 v[132:135], v9 offset:23552
  s_waitcnt vmcnt(20) lgkmcnt(8)
  v_mfma_f32_16x16x32_bf16 v[200:203], v[44:47], v[152:155], v[200:203]
  ds_read_b128 v[136:139], v8 offset:6144
  v_mfma_f32_16x16x32_bf16 v[204:207], v[44:47], v[156:159], v[204:207]
  ds_read_b128 v[140:143], v8 offset:24576
  v_mfma_f32_16x16x32_bf16 v[208:211], v[44:47], v[160:163], v[208:211]
  ds_read_b128 v[144:147], v9 offset:6144
  v_mfma_f32_16x16x32_bf16 v[212:215], v[44:47], v[164:167], v[212:215]
  ds_read_b128 v[148:151], v9 offset:24576
  s_waitcnt vmcnt(19) lgkmcnt(8)
  v_mfma_f32_16x16x32_bf16 v[200:203], v[48:51], v[104:107], v[200:203]
  ds_read_b128 v[152:155], v8 offset:7168
  v_mfma_f32_16x16x32_bf16 v[204:207], v[48:51], v[108:111], v[204:207]
  ds_read_b128 v[156:159], v8 offset:25600
  v_mfma_f32_16x16x32_bf16 v[208:211], v[48:51], v[112:115], v[208:211]
  ds_read_b128 v[160:163], v9 offset:7168
  v_mfma_f32_16x16x32_bf16 v[212:215], v[48:51], v[116:119], v[212:215]
  ds_read_b128 v[164:167], v9 offset:25600
  s_waitcnt vmcnt(18) lgkmcnt(8)
  v_mfma_f32_16x16x32_bf16 v[200:203], v[52:55], v[120:123], v[200:203]
  ds_read_b128 v[104:107], v8 offset:8192
  v_mfma_f32_16x16x32_bf16 v[204:207], v[52:55], v[124:127], v[204:207]
  ds_read_b128 v[108:111], v8 offset:26624
  v_mfma_f32_16x16x32_bf16 v[208:211], v[52:55], v[128:131], v[208:211]
  ds_read_b128 v[112:115], v9 offset:8192
  v_mfma_f32_16x16x32_bf16 v[212:215], v[52:55], v[132:135], v[212:215]
  ds_read_b128 v[116:119], v9 offset:26624
  s_waitcnt vmcnt(17) lgkmcnt(8)
  v_mfma_f32_16x16x32_bf16 v[200:203], v[56:59], v[136:139], v[200:203]
  ds_read_b128 v[120:123], v8 offset:9216
  v_mfma_f32_16x16x32_bf16 v[204:207], v[56:59], v[140:143], v[204:207]
  ds_read_b128 v[124:127], v8 offset:27648
  v_mfma_f32_16x16x32_bf16 v[208:211], v[56:59], v[144:147], v[208:211]
  ds_read_b128 v[128:131], v9 offset:9216
  v_mfma_f32_16x16x32_bf16 v[212:215], v[56:59], v[148:151], v[212:215]
  ds_read_b128 v[132:135], v9 offset:27648
  s_waitcnt vmcnt(16) lgkmcnt(8)
  v_mfma_f32_16x16x32_bf16 v[200:203], v[60:63], v[152:155], v[200:203]
  ds_read_b128 v[136:139], v8 offset:10240
  v_mfma_f32_16x16x32_bf16 v[204:207], v[60:63], v[156:159], v[204:207]
  ds_read_b128 v[140:143], v8 offset:28672
  v_mfma_f32_16x16x32_bf16 v[208:211], v[60:63], v[160:163], v[208:211]
  ds_read_b128 v[144:147], v9 offset:10240
  v_mfma_f32_16x16x32_bf16 v[212:215], v[60:63], v[164:167], v[212:215]
  ds_read_b128 v[148:151], v9 offset:28672
  s_waitcnt vmcnt(15) lgkmcnt(8)
  v_mfma_f32_16x16x32_bf16 v[200:203], v[64:67], v[104:107], v[200:203]
  ds_read_b128 v[152:155], v8 offset:11264
  v_mfma_f32_16x16x32_bf16 v[204:207], v[64:67], v[108:111], v[204:207]
  ds_read_b128 v[156:159], v8 offset:29696
  v_mfma_f32_16x16x32_bf16 v[208:211], v[64:67], v[112:115], v[208:211]
  ds_read_b128 v[160:163], v9 offset:11264
  v_mfma_f32_16x16x32_bf16 v[212:215], v[64:67], v[116:119], v[212:215]
  ds_read_b128 v[164:167], v9 offset:29696
  s_waitcnt vmcnt(14) lgkmcnt(8)
  v_mfma_f32_16x16x32_bf16 v[200:203], v[68:71], v[120:123], v[200:203]
  ds_read_b128 v[104:107], v8 offset:12288
  v_mfma_f32_16x16x32_bf16 v[204:207], v[68:71], v[124:127], v[204:207]
  ds_read_b128 v[108:111], v8 offset:30720
  v_mfma_f32_16x16x32_bf16 v[208:211], v[68:71], v[128:131], v[208:211]
  ds_read_b128 v[112:115], v9 offset:12288
  v_mfma_f32_16x16x32_bf16 v[212:215], v[68:71], v[132:135], v[212:215]
  ds_read_b128 v[116:119], v9 offset:30720
  s_waitcnt vmcnt(13) lgkmcnt(8)
  v_mfma_f32_16x16x32_bf16 v[200:203], v[72:75], v[136:139], v[200:203]
  ds_read_b128 v[120:123], v8 offset:13312
  v_mfma_f32_16x16x32_bf16 v[204:207], v[72:75], v[140:143], v[204:207]
  ds_read_b128 v[124:127], v8 offset:31744
  v_mfma_f32_16x16x32_bf16 v[208:211], v[72:75], v[144:147], v[208:211]
  ds_read_b128 v[128:131], v9 offset:13312
  v_mfma_f32_16x16x32_bf16 v[212:215], v[72:75], v[148:151], v[212:215]
  ds_read_b128 v[132:135], v9 offset:31744
  s_waitcnt vmcnt(12) lgkmcnt(8)
  v_mfma_f32_16x16x32_bf16 v[200:203], v[76:79], v[152:155], v[200:203]
  ds_read_b128 v[136:139], v8 offset:14336
  v_mfma_f32_16x16x32_bf16 v[204:207], v[76:79], v[156:159], v[204:207]
  ds_read_b128 v[140:143], v8 offset:32768
  v_mfma_f32_16x16x32_bf16 v[208:211], v[76:79], v[160:163], v[208:211]
  ds_read_b128 v[144:147], v9 offset:14336
  v_mfma_f32_16x16x32_bf16 v[212:215], v[76:79], v[164:167], v[212:215]
  ds_read_b128 v[148:151], v9 offset:32768
  s_waitcnt vmcnt(11) lgkmcnt(8)
  v_mfma_f32_16x16x32_bf16 v[200:203], v[80:83], v[104:107], v[200:203]
  ds_read_b128 v[152:155], v8 offset:15360
  v_mfma_f32_16x16x32_bf16 v[204:207], v[80:83], v[108:111], v[204:207]
  ds_read_b128 v[156:159], v8 offset:33792
  v_mfma_f32_16x16x32_bf16 v[208:211], v[80:83], v[112:115], v[208:211]
  ds_read_b128 v[160:163], v9 offset:15360
  v_mfma_f32_16x16x32_bf16 v[212:215], v[80:83], v[116:119], v[212:215]
  ds_read_b128 v[164:167], v9 offset:33792
  s_waitcnt vmcnt(10) lgkmcnt(8)
  v_mfma_f32_16x16x32_bf16 v[200:203], v[84:87], v[120:123], v[200:203]
  ds_read_b128 v[104:107], v8 offset:16384
  v_mfma_f32_16x16x32_bf16 v[204:207], v[84:87], v[124:127], v[204:207]
  ds_read_b128 v[108:111], v8 offset:34816
  v_mfma_f32_16x16x32_bf16 v[208:211], v[84:87], v[128:131], v[208:211]
  ds_read_b128 v[112:115], v9 offset:16384
  v_mfma_f32_16x16x32_bf16 v[212:215], v[84:87], v[132:135], v[212:215]
  ds_read_b128 v[116:119], v9 offset:34816
  s_waitcnt vmcnt(9) lgkmcnt(8)
  v_mfma_f32_16x16x32_bf16 v[200:203], v[88:91], v[136:139], v[200:203]
  ds_read_b128 v[120:123], v8 offset:17408
  v_mfma_f32_16x16x32_bf16 v[204:207], v[88:91], v[140:143], v[204:207]
  ds_read_b128 v[124:127], v8 offset:35840
  v_mfma_f32_16x16x32_bf16 v[208:211], v[88:91], v[144:147], v[208:211]
  ds_read_b128 v[128:131], v9 offset:17408
  v_mfma_f32_16x16x32_bf16 v[212:215], v[88:91], v[148:151], v[212:215]
  ds_read_b128 v[132:135], v9 offset:35840
  s_waitcnt vmcnt(8) lgkmcnt(8)
  v_mfma_f32_16x16x32_bf16 v[200:203], v[92:95], v[152:155], v[200:203]
  v_mfma_f32_16x16x32_bf16 v[204:207], v[92:95], v[156:159], v[204:207]
  v_mfma_f32_16x16x32_bf16 v[208:211], v[92:95], v[160:163], v[208:211]
  v_mfma_f32_16x16x32_bf16 v[212:215], v[92:95], v[164:167], v[212:215]
  s_waitcnt vmcnt(7) lgkmcnt(4)
  v_mfma_f32_16x16x32_bf16 v[200:203], v[96:99], v[104:107], v[200:203]
  v_mfma_f32_16x16x32_bf16 v[204:207], v[96:99], v[108:111], v[204:207]
  v_mfma_f32_16x16x32_bf16 v[208:211], v[96:99], v[112:115], v[208:211]
  v_mfma_f32_16x16x32_bf16 v[212:215], v[96:99], v[116:119], v[212:215]
  s_waitcnt vmcnt(6) lgkmcnt(0)
  v_mfma_f32_16x16x32_bf16 v[200:203], v[100:103], v[120:123], v[200:203]
  v_mfma_f32_16x16x32_bf16 v[204:207], v[100:103], v[124:127], v[204:207]
  v_mfma_f32_16x16x32_bf16 v[208:211], v[100:103], v[128:131], v[208:211]
  v_mfma_f32_16x16x32_bf16 v[212:215], v[100:103], v[132:135], v[212:215]
  s_setprio 0
  s_setprio 2
  s_mov_b32 s13, 0x40000
FP_67:
  s_load_dwordx8 s[16:23], s[42:43], s71 glc
  s_waitcnt lgkmcnt(0)
  s_and_b32 s19, s19, s20
  s_and_b32 s19, s19, s21
  s_and_b32 s19, s19, s22
  s_and_b32 s19, s19, s23
  s_cbranch_scc1 FD_68
  s_sleep 1
  s_sub_u32 s13, s13, 1
  s_cbranch_scc0 FP_67
FD_68:
  s_sub_u32 s6, s4, 3
  s_and_b32 s6, s6, 7
  s_mul_i32 s6, s6, 2359296
  s_add_u32 s6, s6, s70
  buffer_load_dwordx4 v[32:35], v2, s[56:59], s6 offen offset:0 sc1
  buffer_load_dwordx4 v[36:39], v2, s[56:59], s6 offen offset:1024 sc1
  s_sub_u32 s6, s4, 4
  s_and_b32 s6, s6, 7
  s_mul_i32 s6, s6, 2359296
  s_add_u32 s6, s6, s70
  buffer_load_dwordx4 v[40:43], v2, s[56:59], s6 offen offset:0 sc1
  buffer_load_dwordx4 v[44:47], v2, s[56:59], s6 offen offset:1024 sc1
  s_sub_u32 s6, s4, 5
  s_and_b32 s6, s6, 7
  s_mul_i32 s6, s6, 2359296
  s_add_u32 s6, s6, s70
  buffer_load_dwordx4 v[48:51], v2, s[56:59], s6 offen offset:0 sc1
  buffer_load_dwordx4 v[52:55], v2, s[56:59], s6 offen offset:1024 sc1
  s_sub_u32 s6, s4, 6
  s_and_b32 s6, s6, 7
  s_mul_i32 s6, s6, 2359296
  s_add_u32 s6, s6, s70
  buffer_load_dwordx4 v[56:59], v2, s[56:59], s6 offen offset:0 sc1
  buffer_load_dwordx4 v[60:63], v2, s[56:59], s6 offen offset:1024 sc1
  s_sub_u32 s6, s4, 7
  s_and_b32 s6, s6, 7
  s_mul_i32 s6, s6, 2359296
  s_add_u32 s6, s6, s70
  buffer_load_dwordx4 v[64:67], v2, s[56:59], s6 offen offset:0 sc1
  buffer_load_dwordx4 v[68:71], v2, s[56:59], s6 offen offset:1024 sc1
  s_waitcnt vmcnt(8)
  v_lshlrev_b32 v216, 16, v32
  v_and_b32 v217, 0xffff0000, v32
  v_lshlrev_b32 v218, 16, v33
  v_and_b32 v219, 0xffff0000, v33
  v_lshlrev_b32 v220, 16, v34
  v_and_b32 v221, 0xffff0000, v34
  v_lshlrev_b32 v222, 16, v35
  v_and_b32 v223, 0xffff0000, v35
  v_lshlrev_b32 v224, 16, v36
  v_and_b32 v225, 0xffff0000, v36
  v_lshlrev_b32 v226, 16, v37
  v_and_b32 v227, 0xffff0000, v37
  v_lshlrev_b32 v228, 16, v38
  v_and_b32 v229, 0xffff0000, v38
  v_lshlrev_b32 v230, 16, v39
  v_and_b32 v231, 0xffff0000, v39
  v_pk_add_f32 v[200:201], v[200:201], v[216:217]
  v_pk_add_f32 v[202:203], v[202:203], v[218:219]
  v_pk_add_f32 v[204:205], v[204:205], v[220:221]
  v_pk_add_f32 v[206:207], v[206:207], v[222:223]
  v_pk_add_f32 v[208:209], v[208:209], v[224:225]
  v_pk_add_f32 v[210:211], v[210:211], v[226:227]
  v_pk_add_f32 v[212:213], v[212:213], v[228:229]
  v_pk_add_f32 v[214:215], v[214:215], v[230:231]
  s_waitcnt vmcnt(6)
  v_lshlrev_b32 v216, 16, v40
  v_and_b32 v217, 0xffff0000, v40
  v_lshlrev_b32 v218, 16, v41
  v_and_b32 v219, 0xffff0000, v41
  v_lshlrev_b32 v220, 16, v42
  v_and_b32 v221, 0xffff0000, v42
  v_lshlrev_b32 v222, 16, v43
  v_and_b32 v223, 0xffff0000, v43
  v_lshlrev_b32 v224, 16, v44
  v_and_b32 v225, 0xffff0000, v44
  v_lshlrev_b32 v226, 16, v45
  v_and_b32 v227, 0xffff0000, v45
  v_lshlrev_b32 v228, 16, v46
  v_and_b32 v229, 0xffff0000, v46
  v_lshlrev_b32 v230, 16, v47
  v_and_b32 v231, 0xffff0000, v47
  v_pk_add_f32 v[200:201], v[200:201], v[216:217]
  v_pk_add_f32 v[202:203], v[202:203], v[218:219]
  v_pk_add_f32 v[204:205], v[204:205], v[220:221]
  v_pk_add_f32 v[206:207], v[206:207], v[222:223]
  v_pk_add_f32 v[208:209], v[208:209], v[224:225]
  v_pk_add_f32 v[210:211], v[210:211], v[226:227]
  v_pk_add_f32 v[212:213], v[212:213], v[228:229]
  v_pk_add_f32 v[214:215], v[214:215], v[230:231]
  s_waitcnt vmcnt(4)
  v_lshlrev_b32 v216, 16, v48
  v_and_b32 v217, 0xffff0000, v48
  v_lshlrev_b32 v218, 16, v49
  v_and_b32 v219, 0xffff0000, v49
  v_lshlrev_b32 v220, 16, v50
  v_and_b32 v221, 0xffff0000, v50
  v_lshlrev_b32 v222, 16, v51
  v_and_b32 v223, 0xffff0000, v51
  v_lshlrev_b32 v224, 16, v52
  v_and_b32 v225, 0xffff0000, v52
  v_lshlrev_b32 v226, 16, v53
  v_and_b32 v227, 0xffff0000, v53
  v_lshlrev_b32 v228, 16, v54
  v_and_b32 v229, 0xffff0000, v54
  v_lshlrev_b32 v230, 16, v55
  v_and_b32 v231, 0xffff0000, v55
  v_pk_add_f32 v[200:201], v[200:201], v[216:217]
  v_pk_add_f32 v[202:203], v[202:203], v[218:219]
  v_pk_add_f32 v[204:205], v[204:205], v[220:221]
  v_pk_add_f32 v[206:207], v[206:207], v[222:223]
  v_pk_add_f32 v[208:209], v[208:209], v[224:225]
  v_pk_add_f32 v[210:211], v[210:211], v[226:227]
  v_pk_add_f32 v[212:213], v[212:213], v[228:229]
  v_pk_add_f32 v[214:215], v[214:215], v[230:231]
  s_waitcnt vmcnt(2)
  v_lshlrev_b32 v216, 16, v56
  v_and_b32 v217, 0xffff0000, v56
  v_lshlrev_b32 v218, 16, v57
  v_and_b32 v219, 0xffff0000, v57
  v_lshlrev_b32 v220, 16, v58
  v_and_b32 v221, 0xffff0000, v58
  v_lshlrev_b32 v222, 16, v59
  v_and_b32 v223, 0xffff0000, v59
  v_lshlrev_b32 v224, 16, v60
  v_and_b32 v225, 0xffff0000, v60
  v_lshlrev_b32 v226, 16, v61
  v_and_b32 v227, 0xffff0000, v61
  v_lshlrev_b32 v228, 16, v62
  v_and_b32 v229, 0xffff0000, v62
  v_lshlrev_b32 v230, 16, v63
  v_and_b32 v231, 0xffff0000, v63
  v_pk_add_f32 v[200:201], v[200:201], v[216:217]
  v_pk_add_f32 v[202:203], v[202:203], v[218:219]
  v_pk_add_f32 v[204:205], v[204:205], v[220:221]
  v_pk_add_f32 v[206:207], v[206:207], v[222:223]
  v_pk_add_f32 v[208:209], v[208:209], v[224:225]
  v_pk_add_f32 v[210:211], v[210:211], v[226:227]
  v_pk_add_f32 v[212:213], v[212:213], v[228:229]
  v_pk_add_f32 v[214:215], v[214:215], v[230:231]
  s_waitcnt vmcnt(0)
  v_lshlrev_b32 v216, 16, v64
  v_and_b32 v217, 0xffff0000, v64
  v_lshlrev_b32 v218, 16, v65
  v_and_b32 v219, 0xffff0000, v65
  v_lshlrev_b32 v220, 16, v66
  v_and_b32 v221, 0xffff0000, v66
  v_lshlrev_b32 v222, 16, v67
  v_and_b32 v223, 0xffff0000, v67
  v_lshlrev_b32 v224, 16, v68
  v_and_b32 v225, 0xffff0000, v68
  v_lshlrev_b32 v226, 16, v69
  v_and_b32 v227, 0xffff0000, v69
  v_lshlrev_b32 v228, 16, v70
  v_and_b32 v229, 0xffff0000, v70
  v_lshlrev_b32 v230, 16, v71
  v_and_b32 v231, 0xffff0000, v71
  v_pk_add_f32 v[200:201], v[200:201], v[216:217]
  v_pk_add_f32 v[202:203], v[202:203], v[218:219]
  v_pk_add_f32 v[204:205], v[204:205], v[220:221]
  v_pk_add_f32 v[206:207], v[206:207], v[222:223]
  v_pk_add_f32 v[208:209], v[208:209], v[224:225]
  v_pk_add_f32 v[210:211], v[210:211], v[226:227]
  v_pk_add_f32 v[212:213], v[212:213], v[228:229]
  v_pk_add_f32 v[214:215], v[214:215], v[230:231]
  v_mul_f32 v200, v200, v20
  v_mul_f32 v201, v201, v20
  v_mul_f32 v202, v202, v20
  v_mul_f32 v203, v203, v20
  v_mul_f32 v204, v204, v21
  v_mul_f32 v205, v205, v21
  v_mul_f32 v206, v206, v21
  v_mul_f32 v207, v207, v21
  v_mul_f32 v208, v208, v22
  v_mul_f32 v209, v209, v22
  v_mul_f32 v210, v210, v22
  v_mul_f32 v211, v211, v22
  v_mul_f32 v212, v212, v23
  v_mul_f32 v213, v213, v23
  v_mul_f32 v214, v214, v23
  v_mul_f32 v215, v215, v23
  v_mul_f32 v216, 0xbfb8aa3b, v200
  v_mul_f32 v217, 0xbfb8aa3b, v201
  v_mul_f32 v218, 0xbfb8aa3b, v202
  v_mul_f32 v219, 0xbfb8aa3b, v203
  v_mul_f32 v220, 0xbfb8aa3b, v204
  v_mul_f32 v221, 0xbfb8aa3b, v205
  v_mul_f32 v222, 0xbfb8aa3b, v206
  v_mul_f32 v223, 0xbfb8aa3b, v207
  v_mul_f32 v224, 0xbfb8aa3b, v208
  v_mul_f32 v225, 0xbfb8aa3b, v209
  v_mul_f32 v226, 0xbfb8aa3b, v210
  v_mul_f32 v227, 0xbfb8aa3b, v211
  v_mul_f32 v228, 0xbfb8aa3b, v212
  v_mul_f32 v229, 0xbfb8aa3b, v213
  v_mul_f32 v230, 0xbfb8aa3b, v214
  v_mul_f32 v231, 0xbfb8aa3b, v215
  v_exp_f32 v216, v216
  v_exp_f32 v217, v217
  v_exp_f32 v218, v218
  v_exp_f32 v219, v219
  v_exp_f32 v220, v220
  v_exp_f32 v221, v221
  v_exp_f32 v222, v222
  v_exp_f32 v223, v223
  v_exp_f32 v224, v224
  v_exp_f32 v225, v225
  v_exp_f32 v226, v226
  v_exp_f32 v227, v227
  v_exp_f32 v228, v228
  v_exp_f32 v229, v229
  v_exp_f32 v230, v230
  v_exp_f32 v231, v231
  v_pk_mul_f32 v[200:201], v[200:201], v[184:185]
  v_pk_mul_f32 v[202:203], v[202:203], v[186:187]
  v_pk_mul_f32 v[204:205], v[204:205], v[188:189]
  v_pk_mul_f32 v[206:207], v[206:207], v[190:191]
  v_pk_mul_f32 v[208:209], v[208:209], v[192:193]
  v_pk_mul_f32 v[210:211], v[210:211], v[194:195]
  v_pk_mul_f32 v[212:213], v[212:213], v[196:197]
  v_pk_mul_f32 v[214:215], v[214:215], v[198:199]
  v_add_f32 v216, 1.0, v216
  v_add_f32 v217, 1.0, v217
  v_add_f32 v218, 1.0, v218
  v_add_f32 v219, 1.0, v219
  v_add_f32 v220, 1.0, v220
  v_add_f32 v221, 1.0, v221
  v_add_f32 v222, 1.0, v222
  v_add_f32 v223, 1.0, v223
  v_add_f32 v224, 1.0, v224
  v_add_f32 v225, 1.0, v225
  v_add_f32 v226, 1.0, v226
  v_add_f32 v227, 1.0, v227
  v_add_f32 v228, 1.0, v228
  v_add_f32 v229, 1.0, v229
  v_add_f32 v230, 1.0, v230
  v_add_f32 v231, 1.0, v231
  v_rcp_f32 v216, v216
  v_rcp_f32 v217, v217
  v_rcp_f32 v218, v218
  v_rcp_f32 v219, v219
  v_rcp_f32 v220, v220
  v_rcp_f32 v221, v221
  v_rcp_f32 v222, v222
  v_rcp_f32 v223, v223
  v_rcp_f32 v224, v224
  v_rcp_f32 v225, v225
  v_rcp_f32 v226, v226
  v_rcp_f32 v227, v227
  v_rcp_f32 v228, v228
  v_rcp_f32 v229, v229
  v_rcp_f32 v230, v230
  v_rcp_f32 v231, v231
  s_nop 0
  v_pk_fma_f32 v[200:201], v[200:201], v[216:217], v[168:169]
  v_pk_fma_f32 v[202:203], v[202:203], v[218:219], v[170:171]
  v_pk_fma_f32 v[204:205], v[204:205], v[220:221], v[172:173]
  v_pk_fma_f32 v[206:207], v[206:207], v[222:223], v[174:175]
  v_pk_fma_f32 v[208:209], v[208:209], v[224:225], v[176:177]
  v_pk_fma_f32 v[210:211], v[210:211], v[226:227], v[178:179]
  v_pk_fma_f32 v[212:213], v[212:213], v[228:229], v[180:181]
  v_pk_fma_f32 v[214:215], v[214:215], v[230:231], v[182:183]
  v_cvt_pk_bf16_f32 v232, v200, v201
  v_cvt_pk_bf16_f32 v233, v202, v203
  v_cvt_pk_bf16_f32 v234, v204, v205
  v_cvt_pk_bf16_f32 v235, v206, v207
  v_cvt_pk_bf16_f32 v236, v208, v209
  v_cvt_pk_bf16_f32 v237, v210, v211
  v_cvt_pk_bf16_f32 v238, v212, v213
  v_cvt_pk_bf16_f32 v239, v214, v215
  ds_write_b64 v7, v[232:233] offset:0
  ds_write_b64 v7, v[234:235] offset:18432
  ds_write_b64 v10, v[236:237] offset:0
  ds_write_b64 v10, v[238:239] offset:18432
  ds_read_b128 v[240:243], v19 offset:0
  ds_read_b128 v[244:247], v19 offset:36864
  s_waitcnt lgkmcnt(1)
  buffer_store_dwordx4 v[240:243], v18, s[48:51], s65 offen
  s_waitcnt lgkmcnt(0)
  buffer_store_dwordx4 v[244:247], v18, s[48:51], s66 offen
  s_endpgm
K6_q:
  s_setprio 0
  s_mov_b64 exec, 1
  ds_add_u32 v16, v17 offset:16
  s_mov_b64 exec, -1
  s_cmp_lg_u32 s3, 7
  s_cbranch_scc1 KB_q3
  s_add_u32 s8, s70, 256
  s_load_dword s44, s[42:43], s8
  s_waitcnt lgkmcnt(0)
  s_cmp_lg_u32 s44, 0
  s_cbranch_scc1 DP_69
  s_mov_b32 s13, 0x40000
CP_70:
  s_load_dword s44, s[42:43], s8 glc
  s_waitcnt lgkmcnt(0)
  s_cmp_ge_u32 s44, 1
  s_cbranch_scc1 CD_71
  s_sleep 8
  s_sub_u32 s13, s13, 1
  s_cbranch_scc0 CP_70
CD_71:
DP_69:
  s_mov_b64 exec, 1
  ds_add_u32 v16, v17 offset:80
  s_mov_b64 exec, -1
KB_q3:
LW_72:
  ds_read_b32 v5, v16 offset:80
  s_waitcnt lgkmcnt(0)
  v_readfirstlane_b32 s7, v5
  s_cmp_ge_u32 s7, 1
  s_cbranch_scc1 LD_73
  s_sleep 2
  s_branch LW_72
LD_73:
  buffer_load_dwordx4 v[32:35], v2, s[56:59], s64 offen offset:0 sc1
  buffer_load_dwordx4 v[36:39], v2, s[56:59], s64 offen offset:1024 sc1
  buffer_load_dwordx4 v[40:43], v2, s[56:59], s64 offen offset:2048 sc1
  s_add_u32 s64, s64, 36864
  buffer_load_dwordx4 v[44:47], v2, s[56:59], s64 offen offset:0 sc1
  s_waitcnt vmcnt(3)
  buffer_load_dwordx4 v[48:51], v2, s[56:59], s64 offen offset:1024 sc1
  s_waitcnt vmcnt(3)
  buffer_load_dwordx4 v[52:55], v2, s[56:59], s64 offen offset:2048 sc1
  s_waitcnt vmcnt(3)
  s_add_u32 s64, s64, 36864
  buffer_load_dwordx4 v[56:59], v2, s[56:59], s64 offen offset:0 sc1
  s_waitcnt vmcnt(3)
  buffer_load_dwordx4 v[60:63], v2, s[56:59], s64 offen offset:1024 sc1
  s_waitcnt vmcnt(3)
  buffer_load_dwordx4 v[64:67], v2, s[56:59], s64 offen offset:2048 sc1
  s_waitcnt vmcnt(3)
  s_add_u32 s64, s64, 36864
  buffer_load_dwordx4 v[68:71], v2, s[56:59], s64 offen offset:0 sc1
  s_waitcnt vmcnt(3)
  buffer_load_dwordx4 v[72:75], v2, s[56:59], s64 offen offset:1024 sc1
  s_waitcnt vmcnt(3)
  buffer_load_dwordx4 v[76:79], v2, s[56:59], s64 offen offset:2048 sc1
  s_waitcnt vmcnt(3)
  s_add_u32 s64, s64, 36864
  buffer_load_dwordx4 v[80:83], v2, s[56:59], s64 offen offset:0 sc1
  s_waitcnt vmcnt(3)
  buffer_load_dwordx4 v[84:87], v2, s[56:59], s64 offen offset:1024 sc1
  s_waitcnt vmcnt(3)
  buffer_load_dwordx4 v[88:91], v2, s[56:59], s64 offen offset:2048 sc1
  s_waitcnt vmcnt(3)
  s_add_u32 s64, s64, 36864
  buffer_load_dwordx4 v[92:95], v2, s[56:59], s64 offen offset:0 sc1
K6_q2:
  s_setprio 0
  buffer_load_dwordx4 v[96:99], v2, s[56:59], s64 offen offset:1024 sc1
  buffer_load_dwordx4 v[100:103], v2, s[56:59], s64 offen offset:2048 sc1
  v_mov_b32 v6, v2
  v_add_u32 v7, 36864, v2
  v_add_u32 v8, 73728, v2
  v_add_u32 v9, 110592, v2
  s_add_u32 s12, s71, 0
  s_lshr_b32 s13, s12, 1
  s_lshl_b32 s13, s13, 10
  s_and_b32 s12, s12, 1
  s_lshl_b32 s12, s12, 3
  s_add_u32 s12, s12, s13
  s_add_u32 s12, s12, 73728
  v_add_u32 v10, s12, v2
  v_add_u32 v11, 36864, v10
  s_add_u32 s12, s71, 1
  s_lshr_b32 s13, s12, 1
  s_lshl_b32 s13, s13, 10
  s_and_b32 s12, s12, 1
  s_lshl_b32 s12, s12, 3
  s_add_u32 s12, s12, s13
  s_add_u32 s12, s12, 73728
  v_add_u32 v12, s12, v2
  v_add_u32 v13, 36864, v12
  s_cmp_lg_u32 s3, 5
  s_cbranch_scc1 KB_w3c
  s_add_u32 s8, s70, 384
  s_load_dword s52, s[42:43], s8
  s_waitcnt lgkmcnt(0)
  s_cmp_lg_u32 s52, 0
  s_cbranch_scc1 DP_74
  s_mov_b32 s13, 0x40000
CP_75:
  s_load_dword s52, s[42:43], s8 glc
  s_waitcnt lgkmcnt(0)
  s_cmp_ge_u32 s52, 1
  s_cbranch_scc1 CD_76
  s_sleep 8
  s_sub_u32 s13, s13, 1
  s_cbranch_scc0 CP_75
CD_76:
DP_74:
  s_mov_b64 exec, 1
  ds_add_u32 v16, v17 offset:48
  s_mov_b64 exec, -1
KB_w3c:
  s_cmp_lg_u32 s3, 6
  s_cbranch_scc1 KB_rs
LW_77:
  ds_read_b32 v5, v16 offset:12
  s_waitcnt lgkmcnt(0)
  v_readfirstlane_b32 s7, v5
  s_cmp_ge_u32 s7, 1
  s_cbranch_scc1 LD_78
  s_sleep 1
  s_branch LW_77
LD_78:
  s_lshr_b32 s11, s5, 1
  s_mul_i32 s6, s11, 4608
  s_and_b32 s8, s5, 1
  s_lshl_b32 s8, s8, 8
  s_add_u32 s6, s6, s8
  s_add_u32 s6, s6, 9764864
  s_add_u32 s11, s6, 4096
  s_lshl_b32 s8, s5, 8
  s_add_u32 s8, s8, 9863168
  s_lshl_b32 s9, s5, 10
  s_add_u32 s9, s9, 10354688
  s_setprio 3
  buffer_load_dword v224, v4, s[56:59], s6 offen offset:0 sc1
  buffer_load_dword v225, v4, s[56:59], s6 offen offset:512 sc1
  buffer_load_dword v226, v4, s[56:59], s6 offen offset:1024 sc1
  buffer_load_dword v227, v4, s[56:59], s6 offen offset:1536 sc1
  buffer_load_dword v228, v4, s[56:59], s6 offen offset:2048 sc1
  buffer_load_dword v229, v4, s[56:59], s6 offen offset:2560 sc1
  buffer_load_dword v230, v4, s[56:59], s6 offen offset:3072 sc1
  buffer_load_dword v231, v4, s[56:59], s6 offen offset:3584 sc1
  buffer_load_dword v232, v4, s[56:59], s11 offen sc1
  buffer_load_dword v237, v4, s[56:59], s8 offen sc1
  buffer_load_dwordx2 v[238:239], v2, s[56:59], s9 offen sc1
  s_waitcnt vmcnt(0)
  v_add_f32 v224, v224, v225
  v_add_f32 v224, v224, v226
  v_add_f32 v224, v224, v227
  v_add_f32 v224, v224, v228
  v_add_f32 v224, v224, v229
  v_add_f32 v224, v224, v230
  v_add_f32 v224, v224, v231
  v_add_f32 v224, v224, v232
  v_mov_b32 v225, 0x3ae38e39
  v_fmaak_f32 v224, v225, v224, 0x3727c5ac
  v_rsq_f32 v236, v224
  v_add_u32 v5, 158720, v2
  s_nop 0
  ds_write_b128 v5, v[236:239]
  s_mov_b64 exec, 1
  ds_add_u32 v16, v17 offset:16
  s_mov_b64 exec, -1
KB_rs:
  s_mul_i32 s6, s4, 9
  s_lshr_b32 s6, s6, 1
  s_and_b32 s7, s3, 3
  s_mul_i32 s8, s7, 3
  s_add_u32 s8, s8, 4
  s_mul_i32 s9, s7, 5
  s_add_u32 s9, s9, 16
  s_cmp_ge_u32 s3, 4
  s_cselect_b32 s8, s9, s8
  s_add_u32 s8, s8, s6
  v_add_u32 v29, s8, v1
  v_subrev_u32 v5, 36, v29
  v_min_u32 v29, v29, v5
  s_add_u32 s9, s8, 0
  s_sub_u32 s10, s9, 36
  s_min_u32 s9, s9, s10
  s_lshl_b32 s44, s9, 10
  v_add_u32 v24, s44, v2
  s_add_u32 s9, s8, 1
  s_sub_u32 s10, s9, 36
  s_min_u32 s9, s9, s10
  s_lshl_b32 s45, s9, 10
  v_add_u32 v25, s45, v2
  s_add_u32 s9, s8, 2
  s_sub_u32 s10, s9, 36
  s_min_u32 s9, s9, s10
  s_lshl_b32 s46, s9, 10
  v_add_u32 v26, s46, v2
  s_add_u32 s9, s8, 3
  s_add_u32 s10, s6, s7
  s_cmp_lt_u32 s3, 4
  s_cselect_b32 s9, s10, s9
  s_sub_u32 s10, s9, 36
  s_min_u32 s9, s9, s10
  s_lshl_b32 s47, s9, 10
  v_add_u32 v27, s47, v2
  s_add_u32 s9, s8, 4
  s_sub_u32 s10, s9, 36
  s_min_u32 s9, s9, s10
  s_lshl_b32 s48, s9, 10
  v_add_u32 v28, s48, v2
  v_lshl_add_u32 v5, v29, 1, 1
  v_mul_u32_u24 v5, 57, v5
  v_lshrrev_b32 v5, 9, v5
  v_subrev_u32 v5, s4, v5
  v_and_b32 v5, 7, v5
  v_lshlrev_b32 v5, 2, v5
  v_lshl_add_u32 v29, v29, 5, v5
  s_mul_i32 s66, s4, 663552
  s_add_u32 s66, s66, 15794176
  s_mov_b32 s68, s66
  s_lshl_b32 s10, s4, 5
  s_add_u32 s10, s10, s5
  s_mul_i32 s67, s10, 73728
  s_add_u32 s67, s67, 21102592
  s_mul_i32 s69, s5, 1152
  s_add_u32 s69, s69, 9702400
LW_79:
  ds_read_b32 v5, v16 offset:8
  s_waitcnt lgkmcnt(0)
  v_readfirstlane_b32 s7, v5
  s_cmp_ge_u32 s7, 4
  s_cbranch_scc1 LD_80
  s_sleep 1
  s_branch LW_79
LD_80:
  s_setprio 2
  ds_read_b128 v[104:107], v6 offset:0
  ds_read_b128 v[108:111], v6 offset:18432
  ds_read_b128 v[112:115], v7 offset:0
  ds_read_b128 v[116:119], v7 offset:18432
  s_waitcnt vmcnt(15) lgkmcnt(0)
  v_mfma_f32_16x16x32_bf16 v[136:139], v[32:35], v[104:107], 0
  v_mfma_f32_16x16x32_bf16 v[140:143], v[32:35], v[108:111], 0
  v_mfma_f32_16x16x32_bf16 v[144:147], v[32:35], v[112:115], 0
  ds_read_b128 v[120:123], v6 offset:1024
  v_mfma_f32_16x16x32_bf16 v[148:151], v[32:35], v[116:119], 0
  ds_read_b128 v[124:127], v6 offset:19456
  v_mfma_f32_16x16x32_bf16 v[152:155], v[36:39], v[104:107], 0
  s_add_u32 s64, s64, 36864
  v_mfma_f32_16x16x32_bf16 v[156:159], v[36:39], v[108:111], 0
  buffer_load_dwordx4 v[32:35], v2, s[56:59], s64 offen offset:0 sc1
  v_mfma_f32_16x16x32_bf16 v[160:163], v[36:39], v[112:115], 0
  ds_read_b128 v[128:131], v7 offset:1024
  v_mfma_f32_16x16x32_bf16 v[164:167], v[36:39], v[116:119], 0
  ds_read_b128 v[132:135], v7 offset:19456
  v_mfma_f32_16x16x32_bf16 v[168:171], v[40:43], v[104:107], 0
  v_mfma_f32_16x16x32_bf16 v[172:175], v[40:43], v[108:111], 0
  buffer_load_dwordx4 v[36:39], v2, s[56:59], s64 offen offset:1024 sc1
  v_mfma_f32_16x16x32_bf16 v[176:179], v[40:43], v[112:115], 0
  v_mfma_f32_16x16x32_bf16 v[180:183], v[40:43], v[116:119], 0
  s_waitcnt vmcnt(14) lgkmcnt(0)
  v_mfma_f32_16x16x32_bf16 v[136:139], v[44:47], v[120:123], v[136:139]
  v_mfma_f32_16x16x32_bf16 v[140:143], v[44:47], v[124:127], v[140:143]
  buffer_load_dwordx4 v[40:43], v2, s[56:59], s64 offen offset:2048 sc1
  v_mfma_f32_16x16x32_bf16 v[144:147], v[44:47], v[128:131], v[144:147]
  ds_read_b128 v[104:107], v6 offset:2048
  v_mfma_f32_16x16x32_bf16 v[148:151], v[44:47], v[132:135], v[148:151]
  ds_read_b128 v[108:111], v6 offset:20480
  v_mfma_f32_16x16x32_bf16 v[152:155], v[48:51], v[120:123], v[152:155]
  s_add_u32 s64, s64, 36864
  v_mfma_f32_16x16x32_bf16 v[156:159], v[48:51], v[124:127], v[156:159]
  buffer_load_dwordx4 v[44:47], v2, s[56:59], s64 offen offset:0 sc1
  v_mfma_f32_16x16x32_bf16 v[160:163], v[48:51], v[128:131], v[160:163]
  ds_read_b128 v[112:115], v7 offset:2048
  v_mfma_f32_16x16x32_bf16 v[164:167], v[48:51], v[132:135], v[164:167]
  ds_read_b128 v[116:119], v7 offset:20480
  v_mfma_f32_16x16x32_bf16 v[168:171], v[52:55], v[120:123], v[168:171]
  v_mfma_f32_16x16x32_bf16 v[172:175], v[52:55], v[124:127], v[172:175]
  buffer_load_dwordx4 v[48:51], v2, s[56:59], s64 offen offset:1024 sc1
  v_mfma_f32_16x16x32_bf16 v[176:179], v[52:55], v[128:131], v[176:179]
  v_mfma_f32_16x16x32_bf16 v[180:183], v[52:55], v[132:135], v[180:183]
  s_waitcnt vmcnt(14) lgkmcnt(0)
  v_mfma_f32_16x16x32_bf16 v[136:139], v[56:59], v[104:107], v[136:139]
  v_mfma_f32_16x16x32_bf16 v[140:143], v[56:59], v[108:111], v[140:143]
  buffer_load_dwordx4 v[52:55], v2, s[56:59], s64 offen offset:2048 sc1
  v_mfma_f32_16x16x32_bf16 v[144:147], v[56:59], v[112:115], v[144:147]
  ds_read_b128 v[120:123], v6 offset:3072
  v_mfma_f32_16x16x32_bf16 v[148:151], v[56:59], v[116:119], v[148:151]
  ds_read_b128 v[124:127], v6 offset:21504
  v_mfma_f32_16x16x32_bf16 v[152:155], v[60:63], v[104:107], v[152:155]
  s_add_u32 s64, s64, 36864
  v_mfma_f32_16x16x32_bf16 v[156:159], v[60:63], v[108:111], v[156:159]
  buffer_load_dwordx4 v[56:59], v2, s[56:59], s64 offen offset:0 sc1
  v_mfma_f32_16x16x32_bf16 v[160:163], v[60:63], v[112:115], v[160:163]
  ds_read_b128 v[128:131], v7 offset:3072
  v_mfma_f32_16x16x32_bf16 v[164:167], v[60:63], v[116:119], v[164:167]
  ds_read_b128 v[132:135], v7 offset:21504
  v_mfma_f32_16x16x32_bf16 v[168:171], v[64:67], v[104:107], v[168:171]
  v_mfma_f32_16x16x32_bf16 v[172:175], v[64:67], v[108:111], v[172:175]
  buffer_load_dwordx4 v[60:63], v2, s[56:59], s64 offen offset:1024 sc1
  v_mfma_f32_16x16x32_bf16 v[176:179], v[64:67], v[112:115], v[176:179]
  v_mfma_f32_16x16x32_bf16 v[180:183], v[64:67], v[116:119], v[180:183]
  s_waitcnt vmcnt(14) lgkmcnt(0)
  v_mfma_f32_16x16x32_bf16 v[136:139], v[68:71], v[120:123], v[136:139]
  v_mfma_f32_16x16x32_bf16 v[140:143], v[68:71], v[124:127], v[140:143]
  buffer_load_dwordx4 v[64:67], v2, s[56:59], s64 offen offset:2048 sc1
  v_mfma_f32_16x16x32_bf16 v[144:147], v[68:71], v[128:131], v[144:147]
  ds_read_b128 v[104:107], v6 offset:4096
  v_mfma_f32_16x16x32_bf16 v[148:151], v[68:71], v[132:135], v[148:151]
  ds_read_b128 v[108:111], v6 offset:22528
  v_mfma_f32_16x16x32_bf16 v[152:155], v[72:75], v[120:123], v[152:155]
  s_add_u32 s64, s64, 36864
  v_mfma_f32_16x16x32_bf16 v[156:159], v[72:75], v[124:127], v[156:159]
  buffer_load_dwordx4 v[68:71], v2, s[56:59], s64 offen offset:0 sc1
  v_mfma_f32_16x16x32_bf16 v[160:163], v[72:75], v[128:131], v[160:163]
  ds_read_b128 v[112:115], v7 offset:4096
  v_mfma_f32_16x16x32_bf16 v[164:167], v[72:75], v[132:135], v[164:167]
  ds_read_b128 v[116:119], v7 offset:22528
  v_mfma_f32_16x16x32_bf16 v[168:171], v[76:79], v[120:123], v[168:171]
  v_mfma_f32_16x16x32_bf16 v[172:175], v[76:79], v[124:127], v[172:175]
  buffer_load_dwordx4 v[72:75], v2, s[56:59], s64 offen offset:1024 sc1
  v_mfma_f32_16x16x32_bf16 v[176:179], v[76:79], v[128:131], v[176:179]
  v_mfma_f32_16x16x32_bf16 v[180:183], v[76:79], v[132:135], v[180:183]
  s_waitcnt vmcnt(14) lgkmcnt(0)
  v_mfma_f32_16x16x32_bf16 v[136:139], v[80:83], v[104:107], v[136:139]
  v_mfma_f32_16x16x32_bf16 v[140:143], v[80:83], v[108:111], v[140:143]
  buffer_load_dwordx4 v[76:79], v2, s[56:59], s64 offen offset:2048 sc1
  v_mfma_f32_16x16x32_bf16 v[144:147], v[80:83], v[112:115], v[144:147]
  ds_read_b128 v[120:123], v6 offset:5120
  v_mfma_f32_16x16x32_bf16 v[148:151], v[80:83], v[116:119], v[148:151]
  ds_read_b128 v[124:127], v6 offset:23552
  v_mfma_f32_16x16x32_bf16 v[152:155], v[84:87], v[104:107], v[152:155]
  s_add_u32 s64, s64, 36864
  v_mfma_f32_16x16x32_bf16 v[156:159], v[84:87], v[108:111], v[156:159]
  buffer_load_dwordx4 v[80:83], v2, s[56:59], s64 offen offset:0 sc1
  v_mfma_f32_16x16x32_bf16 v[160:163], v[84:87], v[112:115], v[160:163]
  ds_read_b128 v[128:131], v7 offset:5120
  v_mfma_f32_16x16x32_bf16 v[164:167], v[84:87], v[116:119], v[164:167]
  ds_read_b128 v[132:135], v7 offset:23552
  v_mfma_f32_16x16x32_bf16 v[168:171], v[88:91], v[104:107], v[168:171]
  v_mfma_f32_16x16x32_bf16 v[172:175], v[88:91], v[108:111], v[172:175]
  buffer_load_dwordx4 v[84:87], v2, s[56:59], s64 offen offset:1024 sc1
  v_mfma_f32_16x16x32_bf16 v[176:179], v[88:91], v[112:115], v[176:179]
  v_mfma_f32_16x16x32_bf16 v[180:183], v[88:91], v[116:119], v[180:183]
  s_waitcnt vmcnt(14) lgkmcnt(0)
  v_mfma_f32_16x16x32_bf16 v[136:139], v[92:95], v[120:123], v[136:139]
  v_mfma_f32_16x16x32_bf16 v[140:143], v[92:95], v[124:127], v[140:143]
  buffer_load_dwordx4 v[88:91], v2, s[56:59], s64 offen offset:2048 sc1
  v_mfma_f32_16x16x32_bf16 v[144:147], v[92:95], v[128:131], v[144:147]
  ds_read_b128 v[104:107], v6 offset:6144
  v_mfma_f32_16x16x32_bf16 v[148:151], v[92:95], v[132:135], v[148:151]
  ds_read_b128 v[108:111], v6 offset:24576
  v_mfma_f32_16x16x32_bf16 v[152:155], v[96:99], v[120:123], v[152:155]
  s_add_u32 s64, s64, 36864
  v_mfma_f32_16x16x32_bf16 v[156:159], v[96:99], v[124:127], v[156:159]
  buffer_load_dwordx4 v[92:95], v2, s[56:59], s64 offen offset:0 sc1
  v_mfma_f32_16x16x32_bf16 v[160:163], v[96:99], v[128:131], v[160:163]
  ds_read_b128 v[112:115], v7 offset:6144
  v_mfma_f32_16x16x32_bf16 v[164:167], v[96:99], v[132:135], v[164:167]
  ds_read_b128 v[116:119], v7 offset:24576
  v_mfma_f32_16x16x32_bf16 v[168:171], v[100:103], v[120:123], v[168:171]
  v_mfma_f32_16x16x32_bf16 v[172:175], v[100:103], v[124:127], v[172:175]
  buffer_load_dwordx4 v[96:99], v2, s[56:59], s64 offen offset:1024 sc1
  v_mfma_f32_16x16x32_bf16 v[176:179], v[100:103], v[128:131], v[176:179]
  v_mfma_f32_16x16x32_bf16 v[180:183], v[100:103], v[132:135], v[180:183]
  s_waitcnt vmcnt(14) lgkmcnt(0)
  v_mfma_f32_16x16x32_bf16 v[136:139], v[32:35], v[104:107], v[136:139]
  v_mfma_f32_16x16x32_bf16 v[140:143], v[32:35], v[108:111], v[140:143]
  buffer_load_dwordx4 v[100:103], v2, s[56:59], s64 offen offset:2048 sc1
  v_mfma_f32_16x16x32_bf16 v[144:147], v[32:35], v[112:115], v[144:147]
  ds_read_b128 v[120:123], v6 offset:7168
  v_mfma_f32_16x16x32_bf16 v[148:151], v[32:35], v[116:119], v[148:151]
  ds_read_b128 v[124:127], v6 offset:25600
  v_mfma_f32_16x16x32_bf16 v[152:155], v[36:39], v[104:107], v[152:155]
  s_add_u32 s64, s64, 36864
  v_mfma_f32_16x16x32_bf16 v[156:159], v[36:39], v[108:111], v[156:159]
  buffer_load_dwordx4 v[32:35], v2, s[56:59], s64 offen offset:0 sc1
  v_mfma_f32_16x16x32_bf16 v[160:163], v[36:39], v[112:115], v[160:163]
  ds_read_b128 v[128:131], v7 offset:7168
  v_mfma_f32_16x16x32_bf16 v[164:167], v[36:39], v[116:119], v[164:167]
  ds_read_b128 v[132:135], v7 offset:25600
  v_mfma_f32_16x16x32_bf16 v[168:171], v[40:43], v[104:107], v[168:171]
  v_mfma_f32_16x16x32_bf16 v[172:175], v[40:43], v[108:111], v[172:175]
  buffer_load_dwordx4 v[36:39], v2, s[56:59], s64 offen offset:1024 sc1
  v_mfma_f32_16x16x32_bf16 v[176:179], v[40:43], v[112:115], v[176:179]
  v_mfma_f32_16x16x32_bf16 v[180:183], v[40:43], v[116:119], v[180:183]
  s_waitcnt vmcnt(14) lgkmcnt(0)
  v_mfma_f32_16x16x32_bf16 v[136:139], v[44:47], v[120:123], v[136:139]
  v_mfma_f32_16x16x32_bf16 v[140:143], v[44:47], v[124:127], v[140:143]
  buffer_load_dwordx4 v[40:43], v2, s[56:59], s64 offen offset:2048 sc1
  v_mfma_f32_16x16x32_bf16 v[144:147], v[44:47], v[128:131], v[144:147]
  ds_read_b128 v[104:107], v6 offset:8192
  v_mfma_f32_16x16x32_bf16 v[148:151], v[44:47], v[132:135], v[148:151]
  ds_read_b128 v[108:111], v6 offset:26624
  v_mfma_f32_16x16x32_bf16 v[152:155], v[48:51], v[120:123], v[152:155]
  s_add_u32 s64, s64, 36864
  v_mfma_f32_16x16x32_bf16 v[156:159], v[48:51], v[124:127], v[156:159]
  buffer_load_dwordx4 v[44:47], v2, s[56:59], s64 offen offset:0 sc1
  v_mfma_f32_16x16x32_bf16 v[160:163], v[48:51], v[128:131], v[160:163]
  ds_read_b128 v[112:115], v7 offset:8192
  v_mfma_f32_16x16x32_bf16 v[164:167], v[48:51], v[132:135], v[164:167]
  ds_read_b128 v[116:119], v7 offset:26624
  v_mfma_f32_16x16x32_bf16 v[168:171], v[52:55], v[120:123], v[168:171]
  v_mfma_f32_16x16x32_bf16 v[172:175], v[52:55], v[124:127], v[172:175]
  buffer_load_dwordx4 v[48:51], v2, s[56:59], s64 offen offset:1024 sc1
  v_mfma_f32_16x16x32_bf16 v[176:179], v[52:55], v[128:131], v[176:179]
  v_mfma_f32_16x16x32_bf16 v[180:183], v[52:55], v[132:135], v[180:183]
  s_waitcnt vmcnt(14) lgkmcnt(0)
  v_mfma_f32_16x16x32_bf16 v[136:139], v[56:59], v[104:107], v[136:139]
  v_mfma_f32_16x16x32_bf16 v[140:143], v[56:59], v[108:111], v[140:143]
  buffer_load_dwordx4 v[52:55], v2, s[56:59], s64 offen offset:2048 sc1
  v_mfma_f32_16x16x32_bf16 v[144:147], v[56:59], v[112:115], v[144:147]
  ds_read_b128 v[120:123], v6 offset:9216
  v_mfma_f32_16x16x32_bf16 v[148:151], v[56:59], v[116:119], v[148:151]
  ds_read_b128 v[124:127], v6 offset:27648
  v_mfma_f32_16x16x32_bf16 v[152:155], v[60:63], v[104:107], v[152:155]
  s_add_u32 s64, s64, 36864
  v_mfma_f32_16x16x32_bf16 v[156:159], v[60:63], v[108:111], v[156:159]
  buffer_load_dwordx4 v[56:59], v2, s[56:59], s64 offen offset:0 sc1
  v_mfma_f32_16x16x32_bf16 v[160:163], v[60:63], v[112:115], v[160:163]
  ds_read_b128 v[128:131], v7 offset:9216
  v_mfma_f32_16x16x32_bf16 v[164:167], v[60:63], v[116:119], v[164:167]
  ds_read_b128 v[132:135], v7 offset:27648
  v_mfma_f32_16x16x32_bf16 v[168:171], v[64:67], v[104:107], v[168:171]
  v_mfma_f32_16x16x32_bf16 v[172:175], v[64:67], v[108:111], v[172:175]
  buffer_load_dwordx4 v[60:63], v2, s[56:59], s64 offen offset:1024 sc1
  v_mfma_f32_16x16x32_bf16 v[176:179], v[64:67], v[112:115], v[176:179]
  s_cmp_lg_u32 s3, 7
  s_cbranch_scc1 KB_q2a
  s_load_dword s53, s[42:43], s70
KB_q2a:
  v_mfma_f32_16x16x32_bf16 v[180:183], v[64:67], v[116:119], v[180:183]
  s_waitcnt vmcnt(14) lgkmcnt(0)
  v_mfma_f32_16x16x32_bf16 v[136:139], v[68:71], v[120:123], v[136:139]
  v_mfma_f32_16x16x32_bf16 v[140:143], v[68:71], v[124:127], v[140:143]
  buffer_load_dwordx4 v[64:67], v2, s[56:59], s64 offen offset:2048 sc1
  v_mfma_f32_16x16x32_bf16 v[144:147], v[68:71], v[128:131], v[144:147]
  ds_read_b128 v[104:107], v6 offset:10240
  v_mfma_f32_16x16x32_bf16 v[148:151], v[68:71], v[132:135], v[148:151]
  ds_read_b128 v[108:111], v6 offset:28672
  v_mfma_f32_16x16x32_bf16 v[152:155], v[72:75], v[120:123], v[152:155]
  s_add_u32 s64, s64, 36864
  v_mfma_f32_16x16x32_bf16 v[156:159], v[72:75], v[124:127], v[156:159]
  buffer_load_dwordx4 v[68:71], v2, s[56:59], s64 offen offset:0 sc1
  v_mfma_f32_16x16x32_bf16 v[160:163], v[72:75], v[128:131], v[160:163]
  ds_read_b128 v[112:115], v7 offset:10240
  v_mfma_f32_16x16x32_bf16 v[164:167], v[72:75], v[132:135], v[164:167]
  ds_read_b128 v[116:119], v7 offset:28672
  v_mfma_f32_16x16x32_bf16 v[168:171], v[76:79], v[120:123], v[168:171]
  v_mfma_f32_16x16x32_bf16 v[172:175], v[76:79], v[124:127], v[172:175]
  buffer_load_dwordx4 v[72:75], v2, s[56:59], s64 offen offset:1024 sc1
  v_mfma_f32_16x16x32_bf16 v[176:179], v[76:79], v[128:131], v[176:179]
  s_cmp_lg_u32 s3, 7
  s_cbranch_scc1 KB_q2c
  s_cmp_lg_u32 s53, 0
  s_cbranch_scc1 KB_q2b
  s_mov_b32 s13, 0x40000
CP_81:
  s_load_dword s53, s[42:43], s70 glc
  s_waitcnt lgkmcnt(0)
  s_cmp_ge_u32 s53, 1
  s_cbranch_scc1 CD_82
  s_sleep 8
  s_sub_u32 s13, s13, 1
  s_cbranch_scc0 CP_81
CD_82:
KB_q2b:
  s_mov_b64 exec, 1
  ds_add_u32 v16, v17 offset:32
  s_mov_b64 exec, -1
KB_q2c:
  v_mfma_f32_16x16x32_bf16 v[180:183], v[76:79], v[132:135], v[180:183]
  s_waitcnt vmcnt(14) lgkmcnt(0)
  v_mfma_f32_16x16x32_bf16 v[136:139], v[80:83], v[104:107], v[136:139]
  v_mfma_f32_16x16x32_bf16 v[140:143], v[80:83], v[108:111], v[140:143]
  buffer_load_dwordx4 v[76:79], v2, s[56:59], s64 offen offset:2048 sc1
  v_mfma_f32_16x16x32_bf16 v[144:147], v[80:83], v[112:115], v[144:147]
  ds_read_b128 v[120:123], v6 offset:11264
  v_mfma_f32_16x16x32_bf16 v[148:151], v[80:83], v[116:119], v[148:151]
  ds_read_b128 v[124:127], v6 offset:29696
  v_mfma_f32_16x16x32_bf16 v[152:155], v[84:87], v[104:107], v[152:155]
  s_add_u32 s64, s64, 36864
  v_mfma_f32_16x16x32_bf16 v[156:159], v[84:87], v[108:111], v[156:159]
  buffer_load_dwordx4 v[80:83], v2, s[56:59], s64 offen offset:0 sc1
  v_mfma_f32_16x16x32_bf16 v[160:163], v[84:87], v[112:115], v[160:163]
  ds_read_b128 v[128:131], v7 offset:11264
  v_mfma_f32_16x16x32_bf16 v[164:167], v[84:87], v[116:119], v[164:167]
  ds_read_b128 v[132:135], v7 offset:29696
  v_mfma_f32_16x16x32_bf16 v[168:171], v[88:91], v[104:107], v[168:171]
  v_mfma_f32_16x16x32_bf16 v[172:175], v[88:91], v[108:111], v[172:175]
  buffer_load_dwordx4 v[84:87], v2, s[56:59], s64 offen offset:1024 sc1
  v_mfma_f32_16x16x32_bf16 v[176:179], v[88:91], v[112:115], v[176:179]
  v_mfma_f32_16x16x32_bf16 v[180:183], v[88:91], v[116:119], v[180:183]
  s_waitcnt vmcnt(14) lgkmcnt(0)
  v_mfma_f32_16x16x32_bf16 v[136:139], v[92:95], v[120:123], v[136:139]
  v_mfma_f32_16x16x32_bf16 v[140:143], v[92:95], v[124:127], v[140:143]
  buffer_load_dwordx4 v[88:91], v2, s[56:59], s64 offen offset:2048 sc1
  v_mfma_f32_16x16x32_bf16 v[144:147], v[92:95], v[128:131], v[144:147]
  ds_read_b128 v[104:107], v6 offset:12288
  v_mfma_f32_16x16x32_bf16 v[148:151], v[92:95], v[132:135], v[148:151]
  ds_read_b128 v[108:111], v6 offset:30720
  v_mfma_f32_16x16x32_bf16 v[152:155], v[96:99], v[120:123], v[152:155]
  s_add_u32 s64, s64, 36864
  v_mfma_f32_16x16x32_bf16 v[156:159], v[96:99], v[124:127], v[156:159]
  buffer_load_dwordx4 v[92:95], v2, s[56:59], s64 offen offset:0 sc1
  v_mfma_f32_16x16x32_bf16 v[160:163], v[96:99], v[128:131], v[160:163]
  ds_read_b128 v[112:115], v7 offset:12288
  v_mfma_f32_16x16x32_bf16 v[164:167], v[96:99], v[132:135], v[164:167]
  ds_read_b128 v[116:119], v7 offset:30720
  v_mfma_f32_16x16x32_bf16 v[168:171], v[100:103], v[120:123], v[168:171]
  v_mfma_f32_16x16x32_bf16 v[172:175], v[100:103], v[124:127], v[172:175]
  buffer_load_dwordx4 v[96:99], v2, s[56:59], s64 offen offset:1024 sc1
  v_mfma_f32_16x16x32_bf16 v[176:179], v[100:103], v[128:131], v[176:179]
LW_83:
  ds_read_b32 v5, v16 offset:32
  s_waitcnt lgkmcnt(0)
  v_readfirstlane_b32 s7, v5
  s_cmp_ge_u32 s7, 1
  s_cbranch_scc1 LD_84
  s_sleep 1
  s_branch LW_83
LD_84:
  v_mfma_f32_16x16x32_bf16 v[180:183], v[100:103], v[132:135], v[180:183]
  s_waitcnt vmcnt(14) lgkmcnt(0)
  v_mfma_f32_16x16x32_bf16 v[136:139], v[32:35], v[104:107], v[136:139]
  v_mfma_f32_16x16x32_bf16 v[140:143], v[32:35], v[108:111], v[140:143]
  buffer_load_dwordx4 v[100:103], v2, s[56:59], s64 offen offset:2048 sc1
  v_mfma_f32_16x16x32_bf16 v[144:147], v[32:35], v[112:115], v[144:147]
  ds_read_b128 v[120:123], v6 offset:13312
  v_mfma_f32_16x16x32_bf16 v[148:151], v[32:35], v[116:119], v[148:151]
  ds_read_b128 v[124:127], v6 offset:31744
  v_mfma_f32_16x16x32_bf16 v[152:155], v[36:39], v[104:107], v[152:155]
  v_mfma_f32_16x16x32_bf16 v[156:159], v[36:39], v[108:111], v[156:159]
  buffer_load_dwordx4 v[32:35], v24, s[56:59], s66 offen offset:0 sc1
  v_mfma_f32_16x16x32_bf16 v[160:163], v[36:39], v[112:115], v[160:163]
  ds_read_b128 v[128:131], v7 offset:13312
  v_mfma_f32_16x16x32_bf16 v[164:167], v[36:39], v[116:119], v[164:167]
  ds_read_b128 v[132:135], v7 offset:31744
  v_mfma_f32_16x16x32_bf16 v[168:171], v[40:43], v[104:107], v[168:171]
  v_mfma_f32_16x16x32_bf16 v[172:175], v[40:43], v[108:111], v[172:175]
  buffer_load_dwordx4 v[36:39], v25, s[56:59], s66 offen offset:0 sc1
  v_mfma_f32_16x16x32_bf16 v[176:179], v[40:43], v[112:115], v[176:179]
  v_mfma_f32_16x16x32_bf16 v[180:183], v[40:43], v[116:119], v[180:183]
  s_waitcnt vmcnt(14) lgkmcnt(0)
  v_mfma_f32_16x16x32_bf16 v[136:139], v[44:47], v[120:123], v[136:139]
  v_mfma_f32_16x16x32_bf16 v[140:143], v[44:47], v[124:127], v[140:143]
  buffer_load_dwordx4 v[40:43], v26, s[56:59], s66 offen offset:0 sc1
  v_mfma_f32_16x16x32_bf16 v[144:147], v[44:47], v[128:131], v[144:147]
  ds_read_b128 v[104:107], v6 offset:14336
  v_mfma_f32_16x16x32_bf16 v[148:151], v[44:47], v[132:135], v[148:151]
  ds_read_b128 v[108:111], v6 offset:32768
  v_mfma_f32_16x16x32_bf16 v[152:155], v[48:51], v[120:123], v[152:155]
  v_mfma_f32_16x16x32_bf16 v[156:159], v[48:51], v[124:127], v[156:159]
  buffer_load_dwordx4 v[44:47], v27, s[56:59], s66 offen offset:0 sc1
  v_mfma_f32_16x16x32_bf16 v[160:163], v[48:51], v[128:131], v[160:163]
  ds_read_b128 v[112:115], v7 offset:14336
  v_mfma_f32_16x16x32_bf16 v[164:167], v[48:51], v[132:135], v[164:167]
  ds_read_b128 v[116:119], v7 offset:32768
  v_mfma_f32_16x16x32_bf16 v[168:171], v[52:55], v[120:123], v[168:171]
  v_mfma_f32_16x16x32_bf16 v[172:175], v[52:55], v[124:127], v[172:175]
  buffer_load_dwordx4 v[48:51], v28, s[56:59], s66 offen offset:0 sc1
  v_mfma_f32_16x16x32_bf16 v[176:179], v[52:55], v[128:131], v[176:179]
  v_mfma_f32_16x16x32_bf16 v[180:183], v[52:55], v[132:135], v[180:183]
  s_waitcnt vmcnt(14) lgkmcnt(0)
  v_mfma_f32_16x16x32_bf16 v[136:139], v[56:59], v[104:107], v[136:139]
  s_add_u32 s66, s66, 36864
  v_mfma_f32_16x16x32_bf16 v[140:143], v[56:59], v[108:111], v[140:143]
  buffer_load_dwordx4 v[52:55], v24, s[56:59], s66 offen offset:0 sc1
  v_mfma_f32_16x16x32_bf16 v[144:147], v[56:59], v[112:115], v[144:147]
  ds_read_b128 v[120:123], v6 offset:15360
  v_mfma_f32_16x16x32_bf16 v[148:151], v[56:59], v[116:119], v[148:151]
  ds_read_b128 v[124:127], v6 offset:33792
  v_mfma_f32_16x16x32_bf16 v[152:155], v[60:63], v[104:107], v[152:155]
  v_mfma_f32_16x16x32_bf16 v[156:159], v[60:63], v[108:111], v[156:159]
  buffer_load_dwordx4 v[56:59], v25, s[56:59], s66 offen offset:0 sc1
  v_mfma_f32_16x16x32_bf16 v[160:163], v[60:63], v[112:115], v[160:163]
  ds_read_b128 v[128:131], v7 offset:15360
  v_mfma_f32_16x16x32_bf16 v[164:167], v[60:63], v[116:119], v[164:167]
  ds_read_b128 v[132:135], v7 offset:33792
  v_mfma_f32_16x16x32_bf16 v[168:171], v[64:67], v[104:107], v[168:171]
  v_mfma_f32_16x16x32_bf16 v[172:175], v[64:67], v[108:111], v[172:175]
  buffer_load_dwordx4 v[60:63], v26, s[56:59], s66 offen offset:0 sc1
  v_mfma_f32_16x16x32_bf16 v[176:179], v[64:67], v[112:115], v[176:179]
  v_mfma_f32_16x16x32_bf16 v[180:183], v[64:67], v[116:119], v[180:183]
  s_waitcnt vmcnt(14) lgkmcnt(0)
  v_mfma_f32_16x16x32_bf16 v[136:139], v[68:71], v[120:123], v[136:139]
  v_mfma_f32_16x16x32_bf16 v[140:143], v[68:71], v[124:127], v[140:143]
  buffer_load_dwordx4 v[64:67], v27, s[56:59], s66 offen offset:0 sc1
  v_mfma_f32_16x16x32_bf16 v[144:147], v[68:71], v[128:131], v[144:147]
  ds_read_b128 v[104:107], v6 offset:16384
  v_mfma_f32_16x16x32_bf16 v[148:151], v[68:71], v[132:135], v[148:151]
  ds_read_b128 v[108:111], v6 offset:34816
  v_mfma_f32_16x16x32_bf16 v[152:155], v[72:75], v[120:123], v[152:155]
  v_mfma_f32_16x16x32_bf16 v[156:159], v[72:75], v[124:127], v[156:159]
  buffer_load_dwordx4 v[68:71], v28, s[56:59], s66 offen offset:0 sc1
  v_mfma_f32_16x16x32_bf16 v[160:163], v[72:75], v[128:131], v[160:163]
  ds_read_b128 v[112:115], v7 offset:16384
  v_mfma_f32_16x16x32_bf16 v[164:167], v[72:75], v[132:135], v[164:167]
  ds_read_b128 v[116:119], v7 offset:34816
  v_mfma_f32_16x16x32_bf16 v[168:171], v[76:79], v[120:123], v[168:171]
  s_add_u32 s66, s66, 36864
  v_mfma_f32_16x16x32_bf16 v[172:175], v[76:79], v[124:127], v[172:175]
  buffer_load_dwordx4 v[72:75], v24, s[56:59], s66 offen offset:0 sc1
  v_mfma_f32_16x16x32_bf16 v[176:179], v[76:79], v[128:131], v[176:179]
  v_mfma_f32_16x16x32_bf16 v[180:183], v[76:79], v[132:135], v[180:183]
  s_waitcnt vmcnt(14) lgkmcnt(0)
  v_mfma_f32_16x16x32_bf16 v[136:139], v[80:83], v[104:107], v[136:139]
  v_mfma_f32_16x16x32_bf16 v[140:143], v[80:83], v[108:111], v[140:143]
  buffer_load_dwordx4 v[76:79], v25, s[56:59], s66 offen offset:0 sc1
  v_mfma_f32_16x16x32_bf16 v[144:147], v[80:83], v[112:115], v[144:147]
  ds_read_b128 v[120:123], v6 offset:17408
  v_mfma_f32_16x16x32_bf16 v[148:151], v[80:83], v[116:119], v[148:151]
  ds_read_b128 v[124:127], v6 offset:35840
  v_mfma_f32_16x16x32_bf16 v[152:155], v[84:87], v[104:107], v[152:155]
  v_mfma_f32_16x16x32_bf16 v[156:159], v[84:87], v[108:111], v[156:159]
  buffer_load_dwordx4 v[80:83], v26, s[56:59], s66 offen offset:0 sc1
  v_mfma_f32_16x16x32_bf16 v[160:163], v[84:87], v[112:115], v[160:163]
  ds_read_b128 v[128:131], v7 offset:17408
  v_mfma_f32_16x16x32_bf16 v[164:167], v[84:87], v[116:119], v[164:167]
  ds_read_b128 v[132:135], v7 offset:35840
  v_mfma_f32_16x16x32_bf16 v[168:171], v[88:91], v[104:107], v[168:171]
  v_mfma_f32_16x16x32_bf16 v[172:175], v[88:91], v[108:111], v[172:175]
  buffer_load_dwordx4 v[84:87], v27, s[56:59], s66 offen offset:0 sc1
  v_mfma_f32_16x16x32_bf16 v[176:179], v[88:91], v[112:115], v[176:179]
  v_mfma_f32_16x16x32_bf16 v[180:183], v[88:91], v[116:119], v[180:183]
  s_waitcnt vmcnt(14) lgkmcnt(0)
  v_mfma_f32_16x16x32_bf16 v[136:139], v[92:95], v[120:123], v[136:139]
  v_mfma_f32_16x16x32_bf16 v[140:143], v[92:95], v[124:127], v[140:143]
  buffer_load_dwordx4 v[88:91], v28, s[56:59], s66 offen offset:0 sc1
  v_mfma_f32_16x16x32_bf16 v[144:147], v[92:95], v[128:131], v[144:147]
  v_mfma_f32_16x16x32_bf16 v[148:151], v[92:95], v[132:135], v[148:151]
  v_mfma_f32_16x16x32_bf16 v[152:155], v[96:99], v[120:123], v[152:155]
  s_add_u32 s66, s66, 36864
  v_mfma_f32_16x16x32_bf16 v[156:159], v[96:99], v[124:127], v[156:159]
  buffer_load_dwordx4 v[92:95], v24, s[56:59], s66 offen offset:0 sc1
  v_mfma_f32_16x16x32_bf16 v[160:163], v[96:99], v[128:131], v[160:163]
  v_mfma_f32_16x16x32_bf16 v[164:167], v[96:99], v[132:135], v[164:167]
  v_mfma_f32_16x16x32_bf16 v[168:171], v[100:103], v[120:123], v[168:171]
  v_mfma_f32_16x16x32_bf16 v[172:175], v[100:103], v[124:127], v[172:175]
  buffer_load_dwordx4 v[96:99], v25, s[56:59], s66 offen offset:0 sc1
  v_mfma_f32_16x16x32_bf16 v[176:179], v[100:103], v[128:131], v[176:179]
  v_mfma_f32_16x16x32_bf16 v[180:183], v[100:103], v[132:135], v[180:183]
  buffer_load_dwordx4 v[100:103], v26, s[56:59], s66 offen offset:0 sc1
  s_setprio 0
LW_85:
  ds_read_b32 v5, v16 offset:16
  s_waitcnt lgkmcnt(0)
  v_readfirstlane_b32 s7, v5
  s_cmp_ge_u32 s7, 5
  s_cbranch_scc1 LD_86
  s_sleep 1
  s_branch LW_85
LD_86:
  v_and_b32 v5, 15, v1
  v_lshlrev_b32 v5, 4, v5
  v_add_u32 v5, 158720, v5
  ds_read_b32 v224, v5 offset:0
  ds_read_b32 v225, v5 offset:256
  ds_read_b32 v226, v5 offset:512
  ds_read_b32 v227, v5 offset:768
  s_waitcnt lgkmcnt(0)
  v_mul_f32 v216, 0xc0135761, v224
  v_mul_f32 v224, v224, v224
  v_mul_f32 v224, 0x3d372713, v224
  v_mul_f32 v217, v224, v216
  v_mul_f32 v218, 0xc0135761, v225
  v_mul_f32 v225, v225, v225
  v_mul_f32 v225, 0x3d372713, v225
  v_mul_f32 v219, v225, v218
  v_mul_f32 v220, 0xc0135761, v226
  v_mul_f32 v226, v226, v226
  v_mul_f32 v226, 0x3d372713, v226
  v_mul_f32 v221, v226, v220
  v_mul_f32 v222, 0xc0135761, v227
  v_mul_f32 v227, v227, v227
  v_mul_f32 v227, 0x3d372713, v227
  v_mul_f32 v223, v227, v222
  s_nop 7
  v_mul_f32 v224, v136, v136
  v_mul_f32 v225, v137, v137
  v_mul_f32 v226, v138, v138
  v_mul_f32 v227, v139, v139
  v_mul_f32 v228, v140, v140
  v_mul_f32 v229, v141, v141
  v_mul_f32 v230, v142, v142
  v_mul_f32 v231, v143, v143
  v_fma_f32 v224, v224, v217, v216
  v_fma_f32 v225, v225, v217, v216
  v_fma_f32 v226, v226, v217, v216
  v_fma_f32 v227, v227, v217, v216
  v_fma_f32 v228, v228, v219, v218
  v_fma_f32 v229, v229, v219, v218
  v_fma_f32 v230, v230, v219, v218
  v_fma_f32 v231, v231, v219, v218
  v_mul_f32 v224, v224, v136
  v_mul_f32 v225, v225, v137
  v_mul_f32 v226, v226, v138
  v_mul_f32 v227, v227, v139
  v_mul_f32 v228, v228, v140
  v_mul_f32 v229, v229, v141
  v_mul_f32 v230, v230, v142
  v_mul_f32 v231, v231, v143
  v_exp_f32 v224, v224
  v_exp_f32 v225, v225
  v_exp_f32 v226, v226
  v_exp_f32 v227, v227
  v_exp_f32 v228, v228
  v_exp_f32 v229, v229
  v_exp_f32 v230, v230
  v_exp_f32 v231, v231
  v_add_f32 v224, 1.0, v224
  v_add_f32 v225, 1.0, v225
  v_add_f32 v226, 1.0, v226
  v_add_f32 v227, 1.0, v227
  v_add_f32 v228, 1.0, v228
  v_add_f32 v229, 1.0, v229
  v_add_f32 v230, 1.0, v230
  v_add_f32 v231, 1.0, v231
  v_rcp_f32 v224, v224
  v_rcp_f32 v225, v225
  v_rcp_f32 v226, v226
  v_rcp_f32 v227, v227
  v_rcp_f32 v228, v228
  v_rcp_f32 v229, v229
  v_rcp_f32 v230, v230
  v_rcp_f32 v231, v231
  v_mul_f32 v136, v224, v136
  v_mul_f32 v137, v225, v137
  v_mul_f32 v138, v226, v138
  v_mul_f32 v139, v227, v139
  v_mul_f32 v140, v228, v140
  v_mul_f32 v141, v229, v141
  v_mul_f32 v142, v230, v142
  v_mul_f32 v143, v231, v143
  v_cvt_pk_bf16_f32 v232, v136, v137
  v_cvt_pk_bf16_f32 v233, v138, v139
  v_cvt_pk_bf16_f32 v234, v140, v141
  v_cvt_pk_bf16_f32 v235, v142, v143
  ds_write_b64 v10, v[232:233] offset:0
  ds_write_b64 v10, v[234:235] offset:18432
  s_mul_i32 s8, s4, 9
  s_lshr_b32 s8, s8, 1
  s_lshl_b32 s8, s8, 9
  s_add_u32 s8, s8, 9739264
  v_min_u32 v14, 39, v1
  v_lshlrev_b32 v14, 5, v14
  s_cmp_lg_u32 s3, 7
  s_cbranch_scc1 KB_y0
  buffer_load_dword v18, v14, s[56:59], s8 offen sc1
  buffer_load_dword v19, v14, s[56:59], s8 offen offset:1280 sc1
KB_y0:
  v_mul_f32 v224, v144, v144
  v_mul_f32 v225, v145, v145
  v_mul_f32 v226, v146, v146
  v_mul_f32 v227, v147, v147
  v_mul_f32 v228, v148, v148
  v_mul_f32 v229, v149, v149
  v_mul_f32 v230, v150, v150
  v_mul_f32 v231, v151, v151
  v_fma_f32 v224, v224, v221, v220
  v_fma_f32 v225, v225, v221, v220
  v_fma_f32 v226, v226, v221, v220
  v_fma_f32 v227, v227, v221, v220
  v_fma_f32 v228, v228, v223, v222
  v_fma_f32 v229, v229, v223, v222
  v_fma_f32 v230, v230, v223, v222
  v_fma_f32 v231, v231, v223, v222
  v_mul_f32 v224, v224, v144
  v_mul_f32 v225, v225, v145
  v_mul_f32 v226, v226, v146
  v_mul_f32 v227, v227, v147
  v_mul_f32 v228, v228, v148
  v_mul_f32 v229, v229, v149
  v_mul_f32 v230, v230, v150
  v_mul_f32 v231, v231, v151
  v_exp_f32 v224, v224
  v_exp_f32 v225, v225
  v_exp_f32 v226, v226
  v_exp_f32 v227, v227
  v_exp_f32 v228, v228
  v_exp_f32 v229, v229
  v_exp_f32 v230, v230
  v_exp_f32 v231, v231
  v_add_f32 v224, 1.0, v224
  v_add_f32 v225, 1.0, v225
  v_add_f32 v226, 1.0, v226
  v_add_f32 v227, 1.0, v227
  v_add_f32 v228, 1.0, v228
  v_add_f32 v229, 1.0, v229
  v_add_f32 v230, 1.0, v230
  v_add_f32 v231, 1.0, v231
  v_rcp_f32 v224, v224
  v_rcp_f32 v225, v225
  v_rcp_f32 v226, v226
  v_rcp_f32 v227, v227
  v_rcp_f32 v228, v228
  v_rcp_f32 v229, v229
  v_rcp_f32 v230, v230
  v_rcp_f32 v231, v231
  v_mul_f32 v144, v224, v144
  v_mul_f32 v145, v225, v145
  v_mul_f32 v146, v226, v146
  v_mul_f32 v147, v227, v147
  v_mul_f32 v148, v228, v148
  v_mul_f32 v149, v229, v149
  v_mul_f32 v150, v230, v150
  v_mul_f32 v151, v231, v151
  v_cvt_pk_bf16_f32 v236, v144, v145
  v_cvt_pk_bf16_f32 v237, v146, v147
  v_cvt_pk_bf16_f32 v238, v148, v149
  v_cvt_pk_bf16_f32 v239, v150, v151
  ds_write_b64 v11, v[236:237] offset:0
  ds_write_b64 v11, v[238:239] offset:18432
  v_mul_f32 v224, v152, v152
  v_mul_f32 v225, v153, v153
  v_mul_f32 v226, v154, v154
  v_mul_f32 v227, v155, v155
  v_mul_f32 v228, v156, v156
  v_mul_f32 v229, v157, v157
  v_mul_f32 v230, v158, v158
  v_mul_f32 v231, v159, v159
  v_fma_f32 v224, v224, v217, v216
  v_fma_f32 v225, v225, v217, v216
  v_fma_f32 v226, v226, v217, v216
  v_fma_f32 v227, v227, v217, v216
  v_fma_f32 v228, v228, v219, v218
  v_fma_f32 v229, v229, v219, v218
  v_fma_f32 v230, v230, v219, v218
  v_fma_f32 v231, v231, v219, v218
  v_mul_f32 v224, v224, v152
  v_mul_f32 v225, v225, v153
  v_mul_f32 v226, v226, v154
  v_mul_f32 v227, v227, v155
  v_mul_f32 v228, v228, v156
  v_mul_f32 v229, v229, v157
  v_mul_f32 v230, v230, v158
  v_mul_f32 v231, v231, v159
  v_exp_f32 v224, v224
  v_exp_f32 v225, v225
  v_exp_f32 v226, v226
  v_exp_f32 v227, v227
  v_exp_f32 v228, v228
  v_exp_f32 v229, v229
  v_exp_f32 v230, v230
  v_exp_f32 v231, v231
  v_add_f32 v224, 1.0, v224
  v_add_f32 v225, 1.0, v225
  v_add_f32 v226, 1.0, v226
  v_add_f32 v227, 1.0, v227
  v_add_f32 v228, 1.0, v228
  v_add_f32 v229, 1.0, v229
  v_add_f32 v230, 1.0, v230
  v_add_f32 v231, 1.0, v231
  v_rcp_f32 v224, v224
  v_rcp_f32 v225, v225
  v_rcp_f32 v226, v226
  v_rcp_f32 v227, v227
  v_rcp_f32 v228, v228
  v_rcp_f32 v229, v229
  v_rcp_f32 v230, v230
  v_rcp_f32 v231, v231
  v_mul_f32 v152, v224, v152
  v_mul_f32 v153, v225, v153
  v_mul_f32 v154, v226, v154
  v_mul_f32 v155, v227, v155
  v_mul_f32 v156, v228, v156
  v_mul_f32 v157, v229, v157
  v_mul_f32 v158, v230, v158
  v_mul_f32 v159, v231, v159
  v_cvt_pk_bf16_f32 v232, v152, v153
  v_cvt_pk_bf16_f32 v233, v154, v155
  v_cvt_pk_bf16_f32 v234, v156, v157
  v_cvt_pk_bf16_f32 v235, v158, v159
  ds_write_b64 v12, v[232:233] offset:0
  ds_write_b64 v12, v[234:235] offset:18432
  v_mul_f32 v224, v160, v160
  v_mul_f32 v225, v161, v161
  v_mul_f32 v226, v162, v162
  v_mul_f32 v227, v163, v163
  v_mul_f32 v228, v164, v164
  v_mul_f32 v229, v165, v165
  v_mul_f32 v230, v166, v166
  v_mul_f32 v231, v167, v167
  v_fma_f32 v224, v224, v221, v220
  v_fma_f32 v225, v225, v221, v220
  v_fma_f32 v226, v226, v221, v220
  v_fma_f32 v227, v227, v221, v220
  v_fma_f32 v228, v228, v223, v222
  v_fma_f32 v229, v229, v223, v222
  v_fma_f32 v230, v230, v223, v222
  v_fma_f32 v231, v231, v223, v222
  v_mul_f32 v224, v224, v160
  v_mul_f32 v225, v225, v161
  v_mul_f32 v226, v226, v162
  v_mul_f32 v227, v227, v163
  v_mul_f32 v228, v228, v164
  v_mul_f32 v229, v229, v165
  v_mul_f32 v230, v230, v166
  v_mul_f32 v231, v231, v167
  v_exp_f32 v224, v224
  v_exp_f32 v225, v225
  v_exp_f32 v226, v226
  v_exp_f32 v227, v227
  v_exp_f32 v228, v228
  v_exp_f32 v229, v229
  v_exp_f32 v230, v230
  v_exp_f32 v231, v231
  v_add_f32 v224, 1.0, v224
  v_add_f32 v225, 1.0, v225
  v_add_f32 v226, 1.0, v226
  v_add_f32 v227, 1.0, v227
  v_add_f32 v228, 1.0, v228
  v_add_f32 v229, 1.0, v229
  v_add_f32 v230, 1.0, v230
  v_add_f32 v231, 1.0, v231
  v_rcp_f32 v224, v224
  v_rcp_f32 v225, v225
  v_rcp_f32 v226, v226
  v_rcp_f32 v227, v227
  v_rcp_f32 v228, v228
  v_rcp_f32 v229, v229
  v_rcp_f32 v230, v230
  v_rcp_f32 v231, v231
  v_mul_f32 v160, v224, v160
  v_mul_f32 v161, v225, v161
  v_mul_f32 v162, v226, v162
  v_mul_f32 v163, v227, v163
  v_mul_f32 v164, v228, v164
  v_mul_f32 v165, v229, v165
  v_mul_f32 v166, v230, v166
  v_mul_f32 v167, v231, v167
  v_cvt_pk_bf16_f32 v236, v160, v161
  v_cvt_pk_bf16_f32 v237, v162, v163
  v_cvt_pk_bf16_f32 v238, v164, v165
  v_cvt_pk_bf16_f32 v239, v166, v167
  ds_write_b64 v13, v[236:237] offset:0
  ds_write_b64 v13, v[238:239] offset:18432
  v_mul_f32 v224, v168, v168
  v_mul_f32 v225, v169, v169
  v_mul_f32 v226, v170, v170
  v_mul_f32 v227, v171, v171
  v_mul_f32 v228, v172, v172
  v_mul_f32 v229, v173, v173
  v_mul_f32 v230, v174, v174
  v_mul_f32 v231, v175, v175
  v_fma_f32 v224, v224, v217, v216
  v_fma_f32 v225, v225, v217, v216
  v_fma_f32 v226, v226, v217, v216
  v_fma_f32 v227, v227, v217, v216
  v_fma_f32 v228, v228, v219, v218
  v_fma_f32 v229, v229, v219, v218
  v_fma_f32 v230, v230, v219, v218
  v_fma_f32 v231, v231, v219, v218
  v_mul_f32 v224, v224, v168
  v_mul_f32 v225, v225, v169
  v_mul_f32 v226, v226, v170
  v_mul_f32 v227, v227, v171
  v_mul_f32 v228, v228, v172
  v_mul_f32 v229, v229, v173
  v_mul_f32 v230, v230, v174
  v_mul_f32 v231, v231, v175
  v_exp_f32 v224, v224
  v_exp_f32 v225, v225
  v_exp_f32 v226, v226
  v_exp_f32 v227, v227
  v_exp_f32 v228, v228
  v_exp_f32 v229, v229
  v_exp_f32 v230, v230
  v_exp_f32 v231, v231
  v_add_f32 v224, 1.0, v224
  v_add_f32 v225, 1.0, v225
  v_add_f32 v226, 1.0, v226
  v_add_f32 v227, 1.0, v227
  v_add_f32 v228, 1.0, v228
  v_add_f32 v229, 1.0, v229
  v_add_f32 v230, 1.0, v230
  v_add_f32 v231, 1.0, v231
  v_rcp_f32 v224, v224
  v_rcp_f32 v225, v225
  v_rcp_f32 v226, v226
  v_rcp_f32 v227, v227
  v_rcp_f32 v228, v228
  v_rcp_f32 v229, v229
  v_rcp_f32 v230, v230
  v_rcp_f32 v231, v231
  v_mul_f32 v168, v224, v168
  v_mul_f32 v169, v225, v169
  v_mul_f32 v170, v226, v170
  v_mul_f32 v171, v227, v171
  v_mul_f32 v172, v228, v172
  v_mul_f32 v173, v229, v173
  v_mul_f32 v174, v230, v174
  v_mul_f32 v175, v231, v175
  v_cvt_pk_bf16_f32 v232, v168, v169
  v_cvt_pk_bf16_f32 v233, v170, v171
  v_cvt_pk_bf16_f32 v234, v172, v173
  v_cvt_pk_bf16_f32 v235, v174, v175
  ds_write_b64 v10, v[232:233] offset:1024
  ds_write_b64 v10, v[234:235] offset:19456
  s_cmp_lg_u32 s3, 7
  s_cbranch_scc1 KB_ys
  s_mov_b32 s13, 0x20000
KB_y1:
  s_waitcnt vmcnt(0)
  v_and_b32 v18, v18, v19
  v_cmp_ne_u32 vcc, 1, v18
  s_cbranch_vccz KB_ys
  s_sleep 16
  buffer_load_dword v18, v14, s[56:59], s8 offen sc1
  buffer_load_dword v19, v14, s[56:59], s8 offen offset:1280 sc1
  s_sub_u32 s13, s13, 1
  s_cbranch_scc0 KB_y1
KB_ys:
  v_mul_f32 v224, v176, v176
  v_mul_f32 v225, v177, v177
  v_mul_f32 v226, v178, v178
  v_mul_f32 v227, v179, v179
  v_mul_f32 v228, v180, v180
  v_mul_f32 v229, v181, v181
  v_mul_f32 v230, v182, v182
  v_mul_f32 v231, v183, v183
  v_fma_f32 v224, v224, v221, v220
  v_fma_f32 v225, v225, v221, v220
  v_fma_f32 v226, v226, v221, v220
  v_fma_f32 v227, v227, v221, v220
  v_fma_f32 v228, v228, v223, v222
  v_fma_f32 v229, v229, v223, v222
  v_fma_f32 v230, v230, v223, v222
  v_fma_f32 v231, v231, v223, v222
  v_mul_f32 v224, v224, v176
  v_mul_f32 v225, v225, v177
  v_mul_f32 v226, v226, v178
  v_mul_f32 v227, v227, v179
  v_mul_f32 v228, v228, v180
  v_mul_f32 v229, v229, v181
  v_mul_f32 v230, v230, v182
  v_mul_f32 v231, v231, v183
  v_exp_f32 v224, v224
  v_exp_f32 v225, v225
  v_exp_f32 v226, v226
  v_exp_f32 v227, v227
  v_exp_f32 v228, v228
  v_exp_f32 v229, v229
  v_exp_f32 v230, v230
  v_exp_f32 v231, v231
  v_add_f32 v224, 1.0, v224
  v_add_f32 v225, 1.0, v225
  v_add_f32 v226, 1.0, v226
  v_add_f32 v227, 1.0, v227
  v_add_f32 v228, 1.0, v228
  v_add_f32 v229, 1.0, v229
  v_add_f32 v230, 1.0, v230
  v_add_f32 v231, 1.0, v231
  v_rcp_f32 v224, v224
  v_rcp_f32 v225, v225
  v_rcp_f32 v226, v226
  v_rcp_f32 v227, v227
  v_rcp_f32 v228, v228
  v_rcp_f32 v229, v229
  v_rcp_f32 v230, v230
  v_rcp_f32 v231, v231
  v_mul_f32 v176, v224, v176
  v_mul_f32 v177, v225, v177
  v_mul_f32 v178, v226, v178
  v_mul_f32 v179, v227, v179
  v_mul_f32 v180, v228, v180
  v_mul_f32 v181, v229, v181
  v_mul_f32 v182, v230, v182
  v_mul_f32 v183, v231, v183
  v_cvt_pk_bf16_f32 v236, v176, v177
  v_cvt_pk_bf16_f32 v237, v178, v179
  v_cvt_pk_bf16_f32 v238, v180, v181
  v_cvt_pk_bf16_f32 v239, v182, v183
  ds_write_b64 v11, v[236:237] offset:1024
  ds_write_b64 v11, v[238:239] offset:19456
  s_mov_b64 exec, 1
  v_mov_b32 v5, 1
  ds_add_u32 v16, v5 offset:20
  s_mov_b64 exec, -1
LW_87:
  ds_read_b32 v5, v16 offset:20
  s_waitcnt lgkmcnt(0)
  v_readfirstlane_b32 s7, v5
  s_cmp_ge_u32 s7, 8
  s_cbranch_scc1 LD_88
  s_sleep 1
  s_branch LW_87
LD_88:
  s_setprio 1
  ds_read_b128 v[104:107], v8 offset:0
  ds_read_b128 v[108:111], v8 offset:18432
  ds_read_b128 v[112:115], v9 offset:0
  ds_read_b128 v[116:119], v9 offset:18432
  s_waitcnt vmcnt(13) lgkmcnt(0)
  v_mfma_f32_16x16x32_bf16 v[136:139], v[32:35], v[104:107], 0
  v_mfma_f32_16x16x32_bf16 v[140:143], v[32:35], v[108:111], 0
  v_mfma_f32_16x16x32_bf16 v[144:147], v[32:35], v[112:115], 0
  ds_read_b128 v[120:123], v8 offset:1024
  v_mfma_f32_16x16x32_bf16 v[148:151], v[32:35], v[116:119], 0
  v_mfma_f32_16x16x32_bf16 v[152:155], v[36:39], v[104:107], 0
  v_mfma_f32_16x16x32_bf16 v[156:159], v[36:39], v[108:111], 0
  buffer_load_dwordx4 v[32:35], v27, s[56:59], s66 offen offset:0 sc1
  v_mfma_f32_16x16x32_bf16 v[160:163], v[36:39], v[112:115], 0
  ds_read_b128 v[124:127], v8 offset:19456
  v_mfma_f32_16x16x32_bf16 v[164:167], v[36:39], v[116:119], 0
  v_mfma_f32_16x16x32_bf16 v[168:171], v[40:43], v[104:107], 0
  v_mfma_f32_16x16x32_bf16 v[172:175], v[40:43], v[108:111], 0
  buffer_load_dwordx4 v[36:39], v28, s[56:59], s66 offen offset:0 sc1
  v_mfma_f32_16x16x32_bf16 v[176:179], v[40:43], v[112:115], 0
  ds_read_b128 v[128:131], v9 offset:1024
  v_mfma_f32_16x16x32_bf16 v[180:183], v[40:43], v[116:119], 0
  v_mfma_f32_16x16x32_bf16 v[184:187], v[44:47], v[104:107], 0
  s_add_u32 s66, s66, 36864
  v_mfma_f32_16x16x32_bf16 v[188:191], v[44:47], v[108:111], 0
  buffer_load_dwordx4 v[40:43], v24, s[56:59], s66 offen offset:0 sc1
  v_mfma_f32_16x16x32_bf16 v[192:195], v[44:47], v[112:115], 0
  ds_read_b128 v[132:135], v9 offset:19456
  v_mfma_f32_16x16x32_bf16 v[196:199], v[44:47], v[116:119], 0
  v_mfma_f32_16x16x32_bf16 v[200:203], v[48:51], v[104:107], 0
  v_mfma_f32_16x16x32_bf16 v[204:207], v[48:51], v[108:111], 0
  buffer_load_dwordx4 v[44:47], v25, s[56:59], s66 offen offset:0 sc1
  v_mfma_f32_16x16x32_bf16 v[208:211], v[48:51], v[112:115], 0
  v_mfma_f32_16x16x32_bf16 v[212:215], v[48:51], v[116:119], 0
  s_waitcnt vmcnt(12) lgkmcnt(0)
  v_mfma_f32_16x16x32_bf16 v[136:139], v[52:55], v[120:123], v[136:139]
  v_mfma_f32_16x16x32_bf16 v[140:143], v[52:55], v[124:127], v[140:143]
  buffer_load_dwordx4 v[48:51], v26, s[56:59], s66 offen offset:0 sc1
  v_mfma_f32_16x16x32_bf16 v[144:147], v[52:55], v[128:131], v[144:147]
  ds_read_b128 v[104:107], v8 offset:2048
  v_mfma_f32_16x16x32_bf16 v[148:151], v[52:55], v[132:135], v[148:151]
  v_mfma_f32_16x16x32_bf16 v[152:155], v[56:59], v[120:123], v[152:155]
  v_mfma_f32_16x16x32_bf16 v[156:159], v[56:59], v[124:127], v[156:159]
  buffer_load_dwordx4 v[52:55], v27, s[56:59], s66 offen offset:0 sc1
  v_mfma_f32_16x16x32_bf16 v[160:163], v[56:59], v[128:131], v[160:163]
  ds_read_b128 v[108:111], v8 offset:20480
  v_mfma_f32_16x16x32_bf16 v[164:167], v[56:59], v[132:135], v[164:167]
  v_mfma_f32_16x16x32_bf16 v[168:171], v[60:63], v[120:123], v[168:171]
  v_mfma_f32_16x16x32_bf16 v[172:175], v[60:63], v[124:127], v[172:175]
  buffer_load_dwordx4 v[56:59], v28, s[56:59], s66 offen offset:0 sc1
  v_mfma_f32_16x16x32_bf16 v[176:179], v[60:63], v[128:131], v[176:179]
  ds_read_b128 v[112:115], v9 offset:2048
  v_mfma_f32_16x16x32_bf16 v[180:183], v[60:63], v[132:135], v[180:183]
  v_mfma_f32_16x16x32_bf16 v[184:187], v[64:67], v[120:123], v[184:187]
  s_add_u32 s66, s66, 36864
  v_mfma_f32_16x16x32_bf16 v[188:191], v[64:67], v[124:127], v[188:191]
  buffer_load_dwordx4 v[60:63], v24, s[56:59], s66 offen offset:0 sc1
  v_mfma_f32_16x16x32_bf16 v[192:195], v[64:67], v[128:131], v[192:195]
  ds_read_b128 v[116:119], v9 offset:20480
  v_mfma_f32_16x16x32_bf16 v[196:199], v[64:67], v[132:135], v[196:199]
  v_mfma_f32_16x16x32_bf16 v[200:203], v[68:71], v[120:123], v[200:203]
  v_mfma_f32_16x16x32_bf16 v[204:207], v[68:71], v[124:127], v[204:207]
  buffer_load_dwordx4 v[64:67], v25, s[56:59], s66 offen offset:0 sc1
  v_mfma_f32_16x16x32_bf16 v[208:211], v[68:71], v[128:131], v[208:211]
  v_mfma_f32_16x16x32_bf16 v[212:215], v[68:71], v[132:135], v[212:215]
  s_waitcnt vmcnt(12) lgkmcnt(0)
  v_mfma_f32_16x16x32_bf16 v[136:139], v[72:75], v[104:107], v[136:139]
  v_mfma_f32_16x16x32_bf16 v[140:143], v[72:75], v[108:111], v[140:143]
  buffer_load_dwordx4 v[68:71], v26, s[56:59], s66 offen offset:0 sc1
  v_mfma_f32_16x16x32_bf16 v[144:147], v[72:75], v[112:115], v[144:147]
  ds_read_b128 v[120:123], v8 offset:3072
  v_mfma_f32_16x16x32_bf16 v[148:151], v[72:75], v[116:119], v[148:151]
  v_mfma_f32_16x16x32_bf16 v[152:155], v[76:79], v[104:107], v[152:155]
  v_mfma_f32_16x16x32_bf16 v[156:159], v[76:79], v[108:111], v[156:159]
  buffer_load_dwordx4 v[72:75], v27, s[56:59], s66 offen offset:0 sc1
  v_mfma_f32_16x16x32_bf16 v[160:163], v[76:79], v[112:115], v[160:163]
  ds_read_b128 v[124:127], v8 offset:21504
  v_mfma_f32_16x16x32_bf16 v[164:167], v[76:79], v[116:119], v[164:167]
  v_mfma_f32_16x16x32_bf16 v[168:171], v[80:83], v[104:107], v[168:171]
  v_mfma_f32_16x16x32_bf16 v[172:175], v[80:83], v[108:111], v[172:175]
  buffer_load_dwordx4 v[76:79], v28, s[56:59], s66 offen offset:0 sc1
  v_mfma_f32_16x16x32_bf16 v[176:179], v[80:83], v[112:115], v[176:179]
  ds_read_b128 v[128:131], v9 offset:3072
  v_mfma_f32_16x16x32_bf16 v[180:183], v[80:83], v[116:119], v[180:183]
  v_mfma_f32_16x16x32_bf16 v[184:187], v[84:87], v[104:107], v[184:187]
  s_add_u32 s66, s66, 36864
  v_mfma_f32_16x16x32_bf16 v[188:191], v[84:87], v[108:111], v[188:191]
  buffer_load_dwordx4 v[80:83], v24, s[56:59], s66 offen offset:0 sc1
  v_mfma_f32_16x16x32_bf16 v[192:195], v[84:87], v[112:115], v[192:195]
  ds_read_b128 v[132:135], v9 offset:21504
  v_mfma_f32_16x16x32_bf16 v[196:199], v[84:87], v[116:119], v[196:199]
  v_mfma_f32_16x16x32_bf16 v[200:203], v[88:91], v[104:107], v[200:203]
  v_mfma_f32_16x16x32_bf16 v[204:207], v[88:91], v[108:111], v[204:207]
  buffer_load_dwordx4 v[84:87], v25, s[56:59], s66 offen offset:0 sc1
  v_mfma_f32_16x16x32_bf16 v[208:211], v[88:91], v[112:115], v[208:211]
  v_mfma_f32_16x16x32_bf16 v[212:215], v[88:91], v[116:119], v[212:215]
  s_waitcnt vmcnt(12) lgkmcnt(0)
  v_mfma_f32_16x16x32_bf16 v[136:139], v[92:95], v[120:123], v[136:139]
  v_mfma_f32_16x16x32_bf16 v[140:143], v[92:95], v[124:127], v[140:143]
  buffer_load_dwordx4 v[88:91], v26, s[56:59], s66 offen offset:0 sc1
  v_mfma_f32_16x16x32_bf16 v[144:147], v[92:95], v[128:131], v[144:147]
  ds_read_b128 v[104:107], v8 offset:4096
  v_mfma_f32_16x16x32_bf16 v[148:151], v[92:95], v[132:135], v[148:151]
  v_mfma_f32_16x16x32_bf16 v[152:155], v[96:99], v[120:123], v[152:155]
  v_mfma_f32_16x16x32_bf16 v[156:159], v[96:99], v[124:127], v[156:159]
  buffer_load_dwordx4 v[92:95], v27, s[56:59], s66 offen offset:0 sc1
  v_mfma_f32_16x16x32_bf16 v[160:163], v[96:99], v[128:131], v[160:163]
  ds_read_b128 v[108:111], v8 offset:22528
  v_mfma_f32_16x16x32_bf16 v[164:167], v[96:99], v[132:135], v[164:167]
  v_mfma_f32_16x16x32_bf16 v[168:171], v[100:103], v[120:123], v[168:171]
  v_mfma_f32_16x16x32_bf16 v[172:175], v[100:103], v[124:127], v[172:175]
  buffer_load_dwordx4 v[96:99], v28, s[56:59], s66 offen offset:0 sc1
  v_mfma_f32_16x16x32_bf16 v[176:179], v[100:103], v[128:131], v[176:179]
  ds_read_b128 v[112:115], v9 offset:4096
  v_mfma_f32_16x16x32_bf16 v[180:183], v[100:103], v[132:135], v[180:183]
  v_mfma_f32_16x16x32_bf16 v[184:187], v[32:35], v[120:123], v[184:187]
  s_add_u32 s66, s66, 36864
  v_mfma_f32_16x16x32_bf16 v[188:191], v[32:35], v[124:127], v[188:191]
  buffer_load_dwordx4 v[100:103], v24, s[56:59], s66 offen offset:0 sc1
  v_mfma_f32_16x16x32_bf16 v[192:195], v[32:35], v[128:131], v[192:195]
  ds_read_b128 v[116:119], v9 offset:22528
  v_mfma_f32_16x16x32_bf16 v[196:199], v[32:35], v[132:135], v[196:199]
  v_mfma_f32_16x16x32_bf16 v[200:203], v[36:39], v[120:123], v[200:203]
  v_mfma_f32_16x16x32_bf16 v[204:207], v[36:39], v[124:127], v[204:207]
  buffer_load_dwordx4 v[32:35], v25, s[56:59], s66 offen offset:0 sc1
  v_mfma_f32_16x16x32_bf16 v[208:211], v[36:39], v[128:131], v[208:211]
  v_mfma_f32_16x16x32_bf16 v[212:215], v[36:39], v[132:135], v[212:215]
  s_waitcnt vmcnt(12) lgkmcnt(0)
  v_mfma_f32_16x16x32_bf16 v[136:139], v[40:43], v[104:107], v[136:139]
  v_mfma_f32_16x16x32_bf16 v[140:143], v[40:43], v[108:111], v[140:143]
  buffer_load_dwordx4 v[36:39], v26, s[56:59], s66 offen offset:0 sc1
  v_mfma_f32_16x16x32_bf16 v[144:147], v[40:43], v[112:115], v[144:147]
  ds_read_b128 v[120:123], v8 offset:5120
  v_mfma_f32_16x16x32_bf16 v[148:151], v[40:43], v[116:119], v[148:151]
  v_mfma_f32_16x16x32_bf16 v[152:155], v[44:47], v[104:107], v[152:155]
  v_mfma_f32_16x16x32_bf16 v[156:159], v[44:47], v[108:111], v[156:159]
  buffer_load_dwordx4 v[40:43], v27, s[56:59], s66 offen offset:0 sc1
  v_mfma_f32_16x16x32_bf16 v[160:163], v[44:47], v[112:115], v[160:163]
  ds_read_b128 v[124:127], v8 offset:23552
  v_mfma_f32_16x16x32_bf16 v[164:167], v[44:47], v[116:119], v[164:167]
  v_mfma_f32_16x16x32_bf16 v[168:171], v[48:51], v[104:107], v[168:171]
  v_mfma_f32_16x16x32_bf16 v[172:175], v[48:51], v[108:111], v[172:175]
  buffer_load_dwordx4 v[44:47], v28, s[56:59], s66 offen offset:0 sc1
  v_mfma_f32_16x16x32_bf16 v[176:179], v[48:51], v[112:115], v[176:179]
  ds_read_b128 v[128:131], v9 offset:5120
  v_mfma_f32_16x16x32_bf16 v[180:183], v[48:51], v[116:119], v[180:183]
  v_mfma_f32_16x16x32_bf16 v[184:187], v[52:55], v[104:107], v[184:187]
  s_add_u32 s66, s66, 36864
  v_mfma_f32_16x16x32_bf16 v[188:191], v[52:55], v[108:111], v[188:191]
  buffer_load_dwordx4 v[48:51], v24, s[56:59], s66 offen offset:0 sc1
  v_mfma_f32_16x16x32_bf16 v[192:195], v[52:55], v[112:115], v[192:195]
  ds_read_b128 v[132:135], v9 offset:23552
  v_mfma_f32_16x16x32_bf16 v[196:199], v[52:55], v[116:119], v[196:199]
  v_mfma_f32_16x16x32_bf16 v[200:203], v[56:59], v[104:107], v[200:203]
  v_mfma_f32_16x16x32_bf16 v[204:207], v[56:59], v[108:111], v[204:207]
  buffer_load_dwordx4 v[52:55], v25, s[56:59], s66 offen offset:0 sc1
  v_mfma_f32_16x16x32_bf16 v[208:211], v[56:59], v[112:115], v[208:211]
  v_mfma_f32_16x16x32_bf16 v[212:215], v[56:59], v[116:119], v[212:215]
  s_waitcnt vmcnt(12) lgkmcnt(0)
  v_mfma_f32_16x16x32_bf16 v[136:139], v[60:63], v[120:123], v[136:139]
  v_mfma_f32_16x16x32_bf16 v[140:143], v[60:63], v[124:127], v[140:143]
  buffer_load_dwordx4 v[56:59], v26, s[56:59], s66 offen offset:0 sc1
  v_mfma_f32_16x16x32_bf16 v[144:147], v[60:63], v[128:131], v[144:147]
  ds_read_b128 v[104:107], v8 offset:6144
  v_mfma_f32_16x16x32_bf16 v[148:151], v[60:63], v[132:135], v[148:151]
  v_mfma_f32_16x16x32_bf16 v[152:155], v[64:67], v[120:123], v[152:155]
  v_mfma_f32_16x16x32_bf16 v[156:159], v[64:67], v[124:127], v[156:159]
  buffer_load_dwordx4 v[60:63], v27, s[56:59], s66 offen offset:0 sc1
  v_mfma_f32_16x16x32_bf16 v[160:163], v[64:67], v[128:131], v[160:163]
  ds_read_b128 v[108:111], v8 offset:24576
  v_mfma_f32_16x16x32_bf16 v[164:167], v[64:67], v[132:135], v[164:167]
  v_mfma_f32_16x16x32_bf16 v[168:171], v[68:71], v[120:123], v[168:171]
  v_mfma_f32_16x16x32_bf16 v[172:175], v[68:71], v[124:127], v[172:175]
  buffer_load_dwordx4 v[64:67], v28, s[56:59], s66 offen offset:0 sc1
  v_mfma_f32_16x16x32_bf16 v[176:179], v[68:71], v[128:131], v[176:179]
  ds_read_b128 v[112:115], v9 offset:6144
  v_mfma_f32_16x16x32_bf16 v[180:183], v[68:71], v[132:135], v[180:183]
  v_mfma_f32_16x16x32_bf16 v[184:187], v[72:75], v[120:123], v[184:187]
  s_add_u32 s66, s66, 36864
  v_mfma_f32_16x16x32_bf16 v[188:191], v[72:75], v[124:127], v[188:191]
  buffer_load_dwordx4 v[68:71], v24, s[56:59], s66 offen offset:0 sc1
  v_mfma_f32_16x16x32_bf16 v[192:195], v[72:75], v[128:131], v[192:195]
  ds_read_b128 v[116:119], v9 offset:24576
  v_mfma_f32_16x16x32_bf16 v[196:199], v[72:75], v[132:135], v[196:199]
  v_mfma_f32_16x16x32_bf16 v[200:203], v[76:79], v[120:123], v[200:203]
  v_mfma_f32_16x16x32_bf16 v[204:207], v[76:79], v[124:127], v[204:207]
  buffer_load_dwordx4 v[72:75], v25, s[56:59], s66 offen offset:0 sc1
  v_mfma_f32_16x16x32_bf16 v[208:211], v[76:79], v[128:131], v[208:211]
  v_mfma_f32_16x16x32_bf16 v[212:215], v[76:79], v[132:135], v[212:215]
  s_waitcnt vmcnt(12) lgkmcnt(0)
  v_mfma_f32_16x16x32_bf16 v[136:139], v[80:83], v[104:107], v[136:139]
  v_mfma_f32_16x16x32_bf16 v[140:143], v[80:83], v[108:111], v[140:143]
  buffer_load_dwordx4 v[76:79], v26, s[56:59], s66 offen offset:0 sc1
  v_mfma_f32_16x16x32_bf16 v[144:147], v[80:83], v[112:115], v[144:147]
  ds_read_b128 v[120:123], v8 offset:7168
  v_mfma_f32_16x16x32_bf16 v[148:151], v[80:83], v[116:119], v[148:151]
  v_mfma_f32_16x16x32_bf16 v[152:155], v[84:87], v[104:107], v[152:155]
  v_mfma_f32_16x16x32_bf16 v[156:159], v[84:87], v[108:111], v[156:159]
  buffer_load_dwordx4 v[80:83], v27, s[56:59], s66 offen offset:0 sc1
  v_mfma_f32_16x16x32_bf16 v[160:163], v[84:87], v[112:115], v[160:163]
  ds_read_b128 v[124:127], v8 offset:25600
  v_mfma_f32_16x16x32_bf16 v[164:167], v[84:87], v[116:119], v[164:167]
  v_mfma_f32_16x16x32_bf16 v[168:171], v[88:91], v[104:107], v[168:171]
  v_mfma_f32_16x16x32_bf16 v[172:175], v[88:91], v[108:111], v[172:175]
  buffer_load_dwordx4 v[84:87], v28, s[56:59], s66 offen offset:0 sc1
  v_mfma_f32_16x16x32_bf16 v[176:179], v[88:91], v[112:115], v[176:179]
  ds_read_b128 v[128:131], v9 offset:7168
  v_mfma_f32_16x16x32_bf16 v[180:183], v[88:91], v[116:119], v[180:183]
  v_mfma_f32_16x16x32_bf16 v[184:187], v[92:95], v[104:107], v[184:187]
  s_add_u32 s66, s66, 36864
  v_mfma_f32_16x16x32_bf16 v[188:191], v[92:95], v[108:111], v[188:191]
  buffer_load_dwordx4 v[88:91], v24, s[56:59], s66 offen offset:0 sc1
  v_mfma_f32_16x16x32_bf16 v[192:195], v[92:95], v[112:115], v[192:195]
  ds_read_b128 v[132:135], v9 offset:25600
  v_mfma_f32_16x16x32_bf16 v[196:199], v[92:95], v[116:119], v[196:199]
  v_mfma_f32_16x16x32_bf16 v[200:203], v[96:99], v[104:107], v[200:203]
  v_mfma_f32_16x16x32_bf16 v[204:207], v[96:99], v[108:111], v[204:207]
  buffer_load_dwordx4 v[92:95], v25, s[56:59], s66 offen offset:0 sc1
  v_mfma_f32_16x16x32_bf16 v[208:211], v[96:99], v[112:115], v[208:211]
  v_mfma_f32_16x16x32_bf16 v[212:215], v[96:99], v[116:119], v[212:215]
  s_waitcnt vmcnt(12) lgkmcnt(0)
  v_mfma_f32_16x16x32_bf16 v[136:139], v[100:103], v[120:123], v[136:139]
  v_mfma_f32_16x16x32_bf16 v[140:143], v[100:103], v[124:127], v[140:143]
  buffer_load_dwordx4 v[96:99], v26, s[56:59], s66 offen offset:0 sc1
  v_mfma_f32_16x16x32_bf16 v[144:147], v[100:103], v[128:131], v[144:147]
  ds_read_b128 v[104:107], v8 offset:8192
  v_mfma_f32_16x16x32_bf16 v[148:151], v[100:103], v[132:135], v[148:151]
  v_mfma_f32_16x16x32_bf16 v[152:155], v[32:35], v[120:123], v[152:155]
  v_mfma_f32_16x16x32_bf16 v[156:159], v[32:35], v[124:127], v[156:159]
  buffer_load_dwordx4 v[100:103], v27, s[56:59], s66 offen offset:0 sc1
  v_mfma_f32_16x16x32_bf16 v[160:163], v[32:35], v[128:131], v[160:163]
  ds_read_b128 v[108:111], v8 offset:26624
  v_mfma_f32_16x16x32_bf16 v[164:167], v[32:35], v[132:135], v[164:167]
  v_mfma_f32_16x16x32_bf16 v[168:171], v[36:39], v[120:123], v[168:171]
  v_mfma_f32_16x16x32_bf16 v[172:175], v[36:39], v[124:127], v[172:175]
  buffer_load_dwordx4 v[32:35], v28, s[56:59], s66 offen offset:0 sc1
  v_mfma_f32_16x16x32_bf16 v[176:179], v[36:39], v[128:131], v[176:179]
  ds_read_b128 v[112:115], v9 offset:8192
  v_mfma_f32_16x16x32_bf16 v[180:183], v[36:39], v[132:135], v[180:183]
  v_mfma_f32_16x16x32_bf16 v[184:187], v[40:43], v[120:123], v[184:187]
  s_add_u32 s66, s66, 36864
  v_mfma_f32_16x16x32_bf16 v[188:191], v[40:43], v[124:127], v[188:191]
  buffer_load_dwordx4 v[36:39], v24, s[56:59], s66 offen offset:0 sc1
  v_mfma_f32_16x16x32_bf16 v[192:195], v[40:43], v[128:131], v[192:195]
  ds_read_b128 v[116:119], v9 offset:26624
  v_mfma_f32_16x16x32_bf16 v[196:199], v[40:43], v[132:135], v[196:199]
  v_mfma_f32_16x16x32_bf16 v[200:203], v[44:47], v[120:123], v[200:203]
  v_mfma_f32_16x16x32_bf16 v[204:207], v[44:47], v[124:127], v[204:207]
  buffer_load_dwordx4 v[40:43], v25, s[56:59], s66 offen offset:0 sc1
  v_mfma_f32_16x16x32_bf16 v[208:211], v[44:47], v[128:131], v[208:211]
  v_mfma_f32_16x16x32_bf16 v[212:215], v[44:47], v[132:135], v[212:215]
  s_waitcnt vmcnt(12) lgkmcnt(0)
  v_mfma_f32_16x16x32_bf16 v[136:139], v[48:51], v[104:107], v[136:139]
  v_mfma_f32_16x16x32_bf16 v[140:143], v[48:51], v[108:111], v[140:143]
  buffer_load_dwordx4 v[44:47], v26, s[56:59], s66 offen offset:0 sc1
  v_mfma_f32_16x16x32_bf16 v[144:147], v[48:51], v[112:115], v[144:147]
  ds_read_b128 v[120:123], v8 offset:9216
  v_mfma_f32_16x16x32_bf16 v[148:151], v[48:51], v[116:119], v[148:151]
  v_mfma_f32_16x16x32_bf16 v[152:155], v[52:55], v[104:107], v[152:155]
  v_mfma_f32_16x16x32_bf16 v[156:159], v[52:55], v[108:111], v[156:159]
  buffer_load_dwordx4 v[48:51], v27, s[56:59], s66 offen offset:0 sc1
  v_mfma_f32_16x16x32_bf16 v[160:163], v[52:55], v[112:115], v[160:163]
  ds_read_b128 v[124:127], v8 offset:27648
  v_mfma_f32_16x16x32_bf16 v[164:167], v[52:55], v[116:119], v[164:167]
  v_mfma_f32_16x16x32_bf16 v[168:171], v[56:59], v[104:107], v[168:171]
  v_mfma_f32_16x16x32_bf16 v[172:175], v[56:59], v[108:111], v[172:175]
  buffer_load_dwordx4 v[52:55], v28, s[56:59], s66 offen offset:0 sc1
  v_mfma_f32_16x16x32_bf16 v[176:179], v[56:59], v[112:115], v[176:179]
  ds_read_b128 v[128:131], v9 offset:9216
  v_mfma_f32_16x16x32_bf16 v[180:183], v[56:59], v[116:119], v[180:183]
  v_mfma_f32_16x16x32_bf16 v[184:187], v[60:63], v[104:107], v[184:187]
  s_add_u32 s66, s66, 36864
  v_mfma_f32_16x16x32_bf16 v[188:191], v[60:63], v[108:111], v[188:191]
  buffer_load_dwordx4 v[56:59], v24, s[56:59], s66 offen offset:0 sc1
  v_mfma_f32_16x16x32_bf16 v[192:195], v[60:63], v[112:115], v[192:195]
  ds_read_b128 v[132:135], v9 offset:27648
  v_mfma_f32_16x16x32_bf16 v[196:199], v[60:63], v[116:119], v[196:199]
  v_mfma_f32_16x16x32_bf16 v[200:203], v[64:67], v[104:107], v[200:203]
  v_mfma_f32_16x16x32_bf16 v[204:207], v[64:67], v[108:111], v[204:207]
  buffer_load_dwordx4 v[60:63], v25, s[56:59], s66 offen offset:0 sc1
  v_mfma_f32_16x16x32_bf16 v[208:211], v[64:67], v[112:115], v[208:211]
  v_mfma_f32_16x16x32_bf16 v[212:215], v[64:67], v[116:119], v[212:215]
  s_waitcnt vmcnt(12) lgkmcnt(0)
  v_mfma_f32_16x16x32_bf16 v[136:139], v[68:71], v[120:123], v[136:139]
  v_mfma_f32_16x16x32_bf16 v[140:143], v[68:71], v[124:127], v[140:143]
  buffer_load_dwordx4 v[64:67], v26, s[56:59], s66 offen offset:0 sc1
  v_mfma_f32_16x16x32_bf16 v[144:147], v[68:71], v[128:131], v[144:147]
  ds_read_b128 v[104:107], v8 offset:10240
  v_mfma_f32_16x16x32_bf16 v[148:151], v[68:71], v[132:135], v[148:151]
  v_mfma_f32_16x16x32_bf16 v[152:155], v[72:75], v[120:123], v[152:155]
  v_mfma_f32_16x16x32_bf16 v[156:159], v[72:75], v[124:127], v[156:159]
  buffer_load_dwordx4 v[68:71], v27, s[56:59], s66 offen offset:0 sc1
  v_mfma_f32_16x16x32_bf16 v[160:163], v[72:75], v[128:131], v[160:163]
  ds_read_b128 v[108:111], v8 offset:28672
  v_mfma_f32_16x16x32_bf16 v[164:167], v[72:75], v[132:135], v[164:167]
  v_mfma_f32_16x16x32_bf16 v[168:171], v[76:79], v[120:123], v[168:171]
  v_mfma_f32_16x16x32_bf16 v[172:175], v[76:79], v[124:127], v[172:175]
  buffer_load_dwordx4 v[72:75], v28, s[56:59], s66 offen offset:0 sc1
  v_mfma_f32_16x16x32_bf16 v[176:179], v[76:79], v[128:131], v[176:179]
  ds_read_b128 v[112:115], v9 offset:10240
  v_mfma_f32_16x16x32_bf16 v[180:183], v[76:79], v[132:135], v[180:183]
  v_mfma_f32_16x16x32_bf16 v[184:187], v[80:83], v[120:123], v[184:187]
  s_add_u32 s66, s66, 36864
  v_mfma_f32_16x16x32_bf16 v[188:191], v[80:83], v[124:127], v[188:191]
  buffer_load_dwordx4 v[76:79], v24, s[56:59], s66 offen offset:0 sc1
  v_mfma_f32_16x16x32_bf16 v[192:195], v[80:83], v[128:131], v[192:195]
  ds_read_b128 v[116:119], v9 offset:28672
  v_mfma_f32_16x16x32_bf16 v[196:199], v[80:83], v[132:135], v[196:199]
  v_mfma_f32_16x16x32_bf16 v[200:203], v[84:87], v[120:123], v[200:203]
  v_mfma_f32_16x16x32_bf16 v[204:207], v[84:87], v[124:127], v[204:207]
  buffer_load_dwordx4 v[80:83], v25, s[56:59], s66 offen offset:0 sc1
  v_mfma_f32_16x16x32_bf16 v[208:211], v[84:87], v[128:131], v[208:211]
  v_mfma_f32_16x16x32_bf16 v[212:215], v[84:87], v[132:135], v[212:215]
  s_waitcnt vmcnt(12) lgkmcnt(0)
  v_mfma_f32_16x16x32_bf16 v[136:139], v[88:91], v[104:107], v[136:139]
  v_mfma_f32_16x16x32_bf16 v[140:143], v[88:91], v[108:111], v[140:143]
  buffer_load_dwordx4 v[84:87], v26, s[56:59], s66 offen offset:0 sc1
  v_mfma_f32_16x16x32_bf16 v[144:147], v[88:91], v[112:115], v[144:147]
  ds_read_b128 v[120:123], v8 offset:11264
  v_mfma_f32_16x16x32_bf16 v[148:151], v[88:91], v[116:119], v[148:151]
  v_mfma_f32_16x16x32_bf16 v[152:155], v[92:95], v[104:107], v[152:155]
  v_mfma_f32_16x16x32_bf16 v[156:159], v[92:95], v[108:111], v[156:159]
  buffer_load_dwordx4 v[88:91], v27, s[56:59], s66 offen offset:0 sc1
  v_mfma_f32_16x16x32_bf16 v[160:163], v[92:95], v[112:115], v[160:163]
  ds_read_b128 v[124:127], v8 offset:29696
  v_mfma_f32_16x16x32_bf16 v[164:167], v[92:95], v[116:119], v[164:167]
  v_mfma_f32_16x16x32_bf16 v[168:171], v[96:99], v[104:107], v[168:171]
  v_mfma_f32_16x16x32_bf16 v[172:175], v[96:99], v[108:111], v[172:175]
  buffer_load_dwordx4 v[92:95], v28, s[56:59], s66 offen offset:0 sc1
  v_mfma_f32_16x16x32_bf16 v[176:179], v[96:99], v[112:115], v[176:179]
  ds_read_b128 v[128:131], v9 offset:11264
  v_mfma_f32_16x16x32_bf16 v[180:183], v[96:99], v[116:119], v[180:183]
  v_mfma_f32_16x16x32_bf16 v[184:187], v[100:103], v[104:107], v[184:187]
  s_add_u32 s66, s66, 36864
  v_mfma_f32_16x16x32_bf16 v[188:191], v[100:103], v[108:111], v[188:191]
  buffer_load_dwordx4 v[96:99], v24, s[56:59], s66 offen offset:0 sc1
  v_mfma_f32_16x16x32_bf16 v[192:195], v[100:103], v[112:115], v[192:195]
  ds_read_b128 v[132:135], v9 offset:29696
  v_mfma_f32_16x16x32_bf16 v[196:199], v[100:103], v[116:119], v[196:199]
  v_mfma_f32_16x16x32_bf16 v[200:203], v[32:35], v[104:107], v[200:203]
  v_mfma_f32_16x16x32_bf16 v[204:207], v[32:35], v[108:111], v[204:207]
  buffer_load_dwordx4 v[100:103], v25, s[56:59], s66 offen offset:0 sc1
  v_mfma_f32_16x16x32_bf16 v[208:211], v[32:35], v[112:115], v[208:211]
  v_mfma_f32_16x16x32_bf16 v[212:215], v[32:35], v[116:119], v[212:215]
  s_waitcnt vmcnt(12) lgkmcnt(0)
  v_mfma_f32_16x16x32_bf16 v[136:139], v[36:39], v[120:123], v[136:139]
  v_mfma_f32_16x16x32_bf16 v[140:143], v[36:39], v[124:127], v[140:143]
  buffer_load_dwordx4 v[32:35], v26, s[56:59], s66 offen offset:0 sc1
  v_mfma_f32_16x16x32_bf16 v[144:147], v[36:39], v[128:131], v[144:147]
  v_mfma_f32_16x16x32_bf16 v[148:151], v[36:39], v[132:135], v[148:151]
  v_mfma_f32_16x16x32_bf16 v[152:155], v[40:43], v[120:123], v[152:155]
  v_mfma_f32_16x16x32_bf16 v[156:159], v[40:43], v[124:127], v[156:159]
  buffer_load_dwordx4 v[36:39], v27, s[56:59], s66 offen offset:0 sc1
  v_mfma_f32_16x16x32_bf16 v[160:163], v[40:43], v[128:131], v[160:163]
  v_mfma_f32_16x16x32_bf16 v[164:167], v[40:43], v[132:135], v[164:167]
  v_mfma_f32_16x16x32_bf16 v[168:171], v[44:47], v[120:123], v[168:171]
  v_mfma_f32_16x16x32_bf16 v[172:175], v[44:47], v[124:127], v[172:175]
  buffer_load_dwordx4 v[40:43], v28, s[56:59], s66 offen offset:0 sc1
  v_mfma_f32_16x16x32_bf16 v[176:179], v[44:47], v[128:131], v[176:179]
  v_mfma_f32_16x16x32_bf16 v[180:183], v[44:47], v[132:135], v[180:183]
  v_mfma_f32_16x16x32_bf16 v[184:187], v[48:51], v[120:123], v[184:187]
  s_add_u32 s66, s66, 36864
  v_mfma_f32_16x16x32_bf16 v[188:191], v[48:51], v[124:127], v[188:191]
  buffer_load_dwordx4 v[44:47], v24, s[56:59], s66 offen offset:0 sc1
  v_mfma_f32_16x16x32_bf16 v[192:195], v[48:51], v[128:131], v[192:195]
  v_mfma_f32_16x16x32_bf16 v[196:199], v[48:51], v[132:135], v[196:199]
  v_mfma_f32_16x16x32_bf16 v[200:203], v[52:55], v[120:123], v[200:203]
  v_mfma_f32_16x16x32_bf16 v[204:207], v[52:55], v[124:127], v[204:207]
  buffer_load_dwordx4 v[48:51], v25, s[56:59], s66 offen offset:0 sc1
  v_mfma_f32_16x16x32_bf16 v[208:211], v[52:55], v[128:131], v[208:211]
  v_mfma_f32_16x16x32_bf16 v[212:215], v[52:55], v[132:135], v[212:215]
  buffer_load_dwordx4 v[52:55], v26, s[56:59], s66 offen offset:0 sc1
  s_setprio 0
LW_89:
  ds_read_b32 v5, v16 offset:28
  s_waitcnt lgkmcnt(0)
  v_readfirstlane_b32 s7, v5
  s_cmp_ge_u32 s7, 4
  s_cbranch_scc1 LD_90
  s_sleep 1
  s_branch LW_89
LD_90:
  s_setprio 1
  ds_read_b128 v[104:107], v8 offset:12288
  ds_read_b128 v[108:111], v8 offset:30720
  ds_read_b128 v[112:115], v9 offset:12288
  ds_read_b128 v[116:119], v9 offset:30720
  s_waitcnt vmcnt(13) lgkmcnt(0)
  v_mfma_f32_16x16x32_bf16 v[136:139], v[56:59], v[104:107], v[136:139]
  v_mfma_f32_16x16x32_bf16 v[140:143], v[56:59], v[108:111], v[140:143]
  v_mfma_f32_16x16x32_bf16 v[144:147], v[56:59], v[112:115], v[144:147]
  ds_read_b128 v[120:123], v8 offset:13312
  v_mfma_f32_16x16x32_bf16 v[148:151], v[56:59], v[116:119], v[148:151]
  v_mfma_f32_16x16x32_bf16 v[152:155], v[60:63], v[104:107], v[152:155]
  v_mfma_f32_16x16x32_bf16 v[156:159], v[60:63], v[108:111], v[156:159]
  buffer_load_dwordx4 v[56:59], v27, s[56:59], s66 offen offset:0 sc1
  v_mfma_f32_16x16x32_bf16 v[160:163], v[60:63], v[112:115], v[160:163]
  ds_read_b128 v[124:127], v8 offset:31744
  v_mfma_f32_16x16x32_bf16 v[164:167], v[60:63], v[116:119], v[164:167]
  v_mfma_f32_16x16x32_bf16 v[168:171], v[64:67], v[104:107], v[168:171]
  v_mfma_f32_16x16x32_bf16 v[172:175], v[64:67], v[108:111], v[172:175]
  buffer_load_dwordx4 v[60:63], v28, s[56:59], s66 offen offset:0 sc1
  v_mfma_f32_16x16x32_bf16 v[176:179], v[64:67], v[112:115], v[176:179]
  ds_read_b128 v[128:131], v9 offset:13312
  v_mfma_f32_16x16x32_bf16 v[180:183], v[64:67], v[116:119], v[180:183]
  v_mfma_f32_16x16x32_bf16 v[184:187], v[68:71], v[104:107], v[184:187]
  s_add_u32 s66, s66, 36864
  v_mfma_f32_16x16x32_bf16 v[188:191], v[68:71], v[108:111], v[188:191]
  buffer_load_dwordx4 v[64:67], v24, s[56:59], s66 offen offset:0 sc1
  v_mfma_f32_16x16x32_bf16 v[192:195], v[68:71], v[112:115], v[192:195]
  ds_read_b128 v[132:135], v9 offset:31744
  v_mfma_f32_16x16x32_bf16 v[196:199], v[68:71], v[116:119], v[196:199]
  v_mfma_f32_16x16x32_bf16 v[200:203], v[72:75], v[104:107], v[200:203]
  v_mfma_f32_16x16x32_bf16 v[204:207], v[72:75], v[108:111], v[204:207]
  buffer_load_dwordx4 v[68:71], v25, s[56:59], s66 offen offset:0 sc1
  v_mfma_f32_16x16x32_bf16 v[208:211], v[72:75], v[112:115], v[208:211]
  v_mfma_f32_16x16x32_bf16 v[212:215], v[72:75], v[116:119], v[212:215]
  s_waitcnt vmcnt(12) lgkmcnt(0)
  v_mfma_f32_16x16x32_bf16 v[136:139], v[76:79], v[120:123], v[136:139]
  v_mfma_f32_16x16x32_bf16 v[140:143], v[76:79], v[124:127], v[140:143]
  buffer_load_dwordx4 v[72:75], v26, s[56:59], s66 offen offset:0 sc1
  v_mfma_f32_16x16x32_bf16 v[144:147], v[76:79], v[128:131], v[144:147]
  ds_read_b128 v[104:107], v8 offset:14336
  v_mfma_f32_16x16x32_bf16 v[148:151], v[76:79], v[132:135], v[148:151]
  v_mfma_f32_16x16x32_bf16 v[152:155], v[80:83], v[120:123], v[152:155]
  v_mfma_f32_16x16x32_bf16 v[156:159], v[80:83], v[124:127], v[156:159]
  buffer_load_dwordx4 v[76:79], v27, s[56:59], s66 offen offset:0 sc1
  v_mfma_f32_16x16x32_bf16 v[160:163], v[80:83], v[128:131], v[160:163]
  ds_read_b128 v[108:111], v8 offset:32768
  v_mfma_f32_16x16x32_bf16 v[164:167], v[80:83], v[132:135], v[164:167]
  v_mfma_f32_16x16x32_bf16 v[168:171], v[84:87], v[120:123], v[168:171]
  v_mfma_f32_16x16x32_bf16 v[172:175], v[84:87], v[124:127], v[172:175]
  buffer_load_dwordx4 v[80:83], v28, s[56:59], s66 offen offset:0 sc1
  v_mfma_f32_16x16x32_bf16 v[176:179], v[84:87], v[128:131], v[176:179]
  ds_read_b128 v[112:115], v9 offset:14336
  v_mfma_f32_16x16x32_bf16 v[180:183], v[84:87], v[132:135], v[180:183]
  v_mfma_f32_16x16x32_bf16 v[184:187], v[88:91], v[120:123], v[184:187]
  s_add_u32 s66, s66, 36864
  v_mfma_f32_16x16x32_bf16 v[188:191], v[88:91], v[124:127], v[188:191]
  buffer_load_dwordx4 v[84:87], v24, s[56:59], s66 offen offset:0 sc1
  v_mfma_f32_16x16x32_bf16 v[192:195], v[88:91], v[128:131], v[192:195]
  ds_read_b128 v[116:119], v9 offset:32768
  v_mfma_f32_16x16x32_bf16 v[196:199], v[88:91], v[132:135], v[196:199]
  v_mfma_f32_16x16x32_bf16 v[200:203], v[92:95], v[120:123], v[200:203]
  v_mfma_f32_16x16x32_bf16 v[204:207], v[92:95], v[124:127], v[204:207]
  buffer_load_dwordx4 v[88:91], v25, s[56:59], s66 offen offset:0 sc1
  v_mfma_f32_16x16x32_bf16 v[208:211], v[92:95], v[128:131], v[208:211]
  v_mfma_f32_16x16x32_bf16 v[212:215], v[92:95], v[132:135], v[212:215]
  s_waitcnt vmcnt(12) lgkmcnt(0)
  v_mfma_f32_16x16x32_bf16 v[136:139], v[96:99], v[104:107], v[136:139]
  v_mfma_f32_16x16x32_bf16 v[140:143], v[96:99], v[108:111], v[140:143]
  buffer_load_dwordx4 v[92:95], v26, s[56:59], s66 offen offset:0 sc1
  v_mfma_f32_16x16x32_bf16 v[144:147], v[96:99], v[112:115], v[144:147]
  ds_read_b128 v[120:123], v8 offset:15360
  v_mfma_f32_16x16x32_bf16 v[148:151], v[96:99], v[116:119], v[148:151]
  v_mfma_f32_16x16x32_bf16 v[152:155], v[100:103], v[104:107], v[152:155]
  v_mfma_f32_16x16x32_bf16 v[156:159], v[100:103], v[108:111], v[156:159]
  buffer_load_dwordx4 v[96:99], v27, s[56:59], s66 offen offset:0 sc1
  v_mfma_f32_16x16x32_bf16 v[160:163], v[100:103], v[112:115], v[160:163]
  ds_read_b128 v[124:127], v8 offset:33792
  v_mfma_f32_16x16x32_bf16 v[164:167], v[100:103], v[116:119], v[164:167]
  v_mfma_f32_16x16x32_bf16 v[168:171], v[32:35], v[104:107], v[168:171]
  v_mfma_f32_16x16x32_bf16 v[172:175], v[32:35], v[108:111], v[172:175]
  buffer_load_dwordx4 v[100:103], v28, s[56:59], s66 offen offset:0 sc1
  v_mfma_f32_16x16x32_bf16 v[176:179], v[32:35], v[112:115], v[176:179]
  ds_read_b128 v[128:131], v9 offset:15360
  v_mfma_f32_16x16x32_bf16 v[180:183], v[32:35], v[116:119], v[180:183]
  v_mfma_f32_16x16x32_bf16 v[184:187], v[36:39], v[104:107], v[184:187]
  v_mfma_f32_16x16x32_bf16 v[188:191], v[36:39], v[108:111], v[188:191]
  v_mfma_f32_16x16x32_bf16 v[192:195], v[36:39], v[112:115], v[192:195]
  ds_read_b128 v[132:135], v9 offset:33792
  v_mfma_f32_16x16x32_bf16 v[196:199], v[36:39], v[116:119], v[196:199]
  v_mfma_f32_16x16x32_bf16 v[200:203], v[40:43], v[104:107], v[200:203]
  v_mfma_f32_16x16x32_bf16 v[204:207], v[40:43], v[108:111], v[204:207]
  v_mfma_f32_16x16x32_bf16 v[208:211], v[40:43], v[112:115], v[208:211]
  v_mfma_f32_16x16x32_bf16 v[212:215], v[40:43], v[116:119], v[212:215]
  s_waitcnt vmcnt(10) lgkmcnt(0)
  v_mfma_f32_16x16x32_bf16 v[136:139], v[44:47], v[120:123], v[136:139]
  v_mfma_f32_16x16x32_bf16 v[140:143], v[44:47], v[124:127], v[140:143]
  v_mfma_f32_16x16x32_bf16 v[144:147], v[44:47], v[128:131], v[144:147]
  ds_read_b128 v[104:107], v8 offset:16384
  v_mfma_f32_16x16x32_bf16 v[148:151], v[44:47], v[132:135], v[148:151]
  v_mfma_f32_16x16x32_bf16 v[152:155], v[48:51], v[120:123], v[152:155]
  v_mfma_f32_16x16x32_bf16 v[156:159], v[48:51], v[124:127], v[156:159]
  v_mfma_f32_16x16x32_bf16 v[160:163], v[48:51], v[128:131], v[160:163]
  ds_read_b128 v[108:111], v8 offset:34816
  v_mfma_f32_16x16x32_bf16 v[164:167], v[48:51], v[132:135], v[164:167]
  v_mfma_f32_16x16x32_bf16 v[168:171], v[52:55], v[120:123], v[168:171]
  v_mfma_f32_16x16x32_bf16 v[172:175], v[52:55], v[124:127], v[172:175]
  v_mfma_f32_16x16x32_bf16 v[176:179], v[52:55], v[128:131], v[176:179]
  ds_read_b128 v[112:115], v9 offset:16384
  v_mfma_f32_16x16x32_bf16 v[180:183], v[52:55], v[132:135], v[180:183]
  v_mfma_f32_16x16x32_bf16 v[184:187], v[56:59], v[120:123], v[184:187]
  v_mfma_f32_16x16x32_bf16 v[188:191], v[56:59], v[124:127], v[188:191]
  v_mfma_f32_16x16x32_bf16 v[192:195], v[56:59], v[128:131], v[192:195]
  ds_read_b128 v[116:119], v9 offset:34816
  v_mfma_f32_16x16x32_bf16 v[196:199], v[56:59], v[132:135], v[196:199]
  v_mfma_f32_16x16x32_bf16 v[200:203], v[60:63], v[120:123], v[200:203]
  v_mfma_f32_16x16x32_bf16 v[204:207], v[60:63], v[124:127], v[204:207]
  v_mfma_f32_16x16x32_bf16 v[208:211], v[60:63], v[128:131], v[208:211]
  v_mfma_f32_16x16x32_bf16 v[212:215], v[60:63], v[132:135], v[212:215]
  s_waitcnt vmcnt(5) lgkmcnt(0)
  v_mfma_f32_16x16x32_bf16 v[136:139], v[64:67], v[104:107], v[136:139]
  v_mfma_f32_16x16x32_bf16 v[140:143], v[64:67], v[108:111], v[140:143]
  v_mfma_f32_16x16x32_bf16 v[144:147], v[64:67], v[112:115], v[144:147]
  ds_read_b128 v[120:123], v8 offset:17408
  v_mfma_f32_16x16x32_bf16 v[148:151], v[64:67], v[116:119], v[148:151]
  v_mfma_f32_16x16x32_bf16 v[152:155], v[68:71], v[104:107], v[152:155]
  v_mfma_f32_16x16x32_bf16 v[156:159], v[68:71], v[108:111], v[156:159]
  v_mfma_f32_16x16x32_bf16 v[160:163], v[68:71], v[112:115], v[160:163]
  ds_read_b128 v[124:127], v8 offset:35840
  v_mfma_f32_16x16x32_bf16 v[164:167], v[68:71], v[116:119], v[164:167]
  v_mfma_f32_16x16x32_bf16 v[168:171], v[72:75], v[104:107], v[168:171]
  v_mfma_f32_16x16x32_bf16 v[172:175], v[72:75], v[108:111], v[172:175]
  v_mfma_f32_16x16x32_bf16 v[176:179], v[72:75], v[112:115], v[176:179]
  ds_read_b128 v[128:131], v9 offset:17408
  v_mfma_f32_16x16x32_bf16 v[180:183], v[72:75], v[116:119], v[180:183]
  v_mfma_f32_16x16x32_bf16 v[184:187], v[76:79], v[104:107], v[184:187]
  v_mfma_f32_16x16x32_bf16 v[188:191], v[76:79], v[108:111], v[188:191]
  v_mfma_f32_16x16x32_bf16 v[192:195], v[76:79], v[112:115], v[192:195]
  ds_read_b128 v[132:135], v9 offset:35840
  v_mfma_f32_16x16x32_bf16 v[196:199], v[76:79], v[116:119], v[196:199]
  v_mfma_f32_16x16x32_bf16 v[200:203], v[80:83], v[104:107], v[200:203]
  v_mfma_f32_16x16x32_bf16 v[204:207], v[80:83], v[108:111], v[204:207]
  v_mfma_f32_16x16x32_bf16 v[208:211], v[80:83], v[112:115], v[208:211]
  v_mfma_f32_16x16x32_bf16 v[212:215], v[80:83], v[116:119], v[212:215]
  s_waitcnt vmcnt(0) lgkmcnt(0)
  v_mfma_f32_16x16x32_bf16 v[136:139], v[84:87], v[120:123], v[136:139]
  v_mfma_f32_16x16x32_bf16 v[140:143], v[84:87], v[124:127], v[140:143]
  v_mfma_f32_16x16x32_bf16 v[144:147], v[84:87], v[128:131], v[144:147]
  v_mfma_f32_16x16x32_bf16 v[148:151], v[84:87], v[132:135], v[148:151]
  v_mfma_f32_16x16x32_bf16 v[152:155], v[88:91], v[120:123], v[152:155]
  v_mfma_f32_16x16x32_bf16 v[156:159], v[88:91], v[124:127], v[156:159]
  v_mfma_f32_16x16x32_bf16 v[160:163], v[88:91], v[128:131], v[160:163]
  v_mfma_f32_16x16x32_bf16 v[164:167], v[88:91], v[132:135], v[164:167]
  v_mfma_f32_16x16x32_bf16 v[168:171], v[92:95], v[120:123], v[168:171]
  v_mfma_f32_16x16x32_bf16 v[172:175], v[92:95], v[124:127], v[172:175]
  v_mfma_f32_16x16x32_bf16 v[176:179], v[92:95], v[128:131], v[176:179]
  v_mfma_f32_16x16x32_bf16 v[180:183], v[92:95], v[132:135], v[180:183]
  v_mfma_f32_16x16x32_bf16 v[184:187], v[96:99], v[120:123], v[184:187]
  v_mfma_f32_16x16x32_bf16 v[188:191], v[96:99], v[124:127], v[188:191]
  v_mfma_f32_16x16x32_bf16 v[192:195], v[96:99], v[128:131], v[192:195]
  v_mfma_f32_16x16x32_bf16 v[196:199], v[96:99], v[132:135], v[196:199]
  v_mfma_f32_16x16x32_bf16 v[200:203], v[100:103], v[120:123], v[200:203]
  v_mfma_f32_16x16x32_bf16 v[204:207], v[100:103], v[124:127], v[204:207]
  v_mfma_f32_16x16x32_bf16 v[208:211], v[100:103], v[128:131], v[208:211]
  v_mfma_f32_16x16x32_bf16 v[212:215], v[100:103], v[132:135], v[212:215]
  s_setprio 0
  s_setprio 1
  s_nop 7
  s_lshl_b32 s6, s44, 1
  s_add_u32 s6, s6, s67
  v_cvt_pk_bf16_f32 v224, v136, v137
  v_cvt_pk_bf16_f32 v225, v138, v139
  v_cvt_pk_bf16_f32 v226, v140, v141
  v_cvt_pk_bf16_f32 v227, v142, v143
  buffer_store_dwordx4 v[224:227], v2, s[56:59], s6 offen offset:0 sc1
  v_cvt_pk_bf16_f32 v228, v144, v145
  v_cvt_pk_bf16_f32 v229, v146, v147
  v_cvt_pk_bf16_f32 v230, v148, v149
  v_cvt_pk_bf16_f32 v231, v150, v151
  buffer_store_dwordx4 v[228:231], v2, s[56:59], s6 offen offset:1024 sc1
  s_lshl_b32 s6, s45, 1
  s_add_u32 s6, s6, s67
  v_cvt_pk_bf16_f32 v232, v152, v153
  v_cvt_pk_bf16_f32 v233, v154, v155
  v_cvt_pk_bf16_f32 v234, v156, v157
  v_cvt_pk_bf16_f32 v235, v158, v159
  buffer_store_dwordx4 v[232:235], v2, s[56:59], s6 offen offset:0 sc1
  v_cvt_pk_bf16_f32 v236, v160, v161
  v_cvt_pk_bf16_f32 v237, v162, v163
  v_cvt_pk_bf16_f32 v238, v164, v165
  v_cvt_pk_bf16_f32 v239, v166, v167
  buffer_store_dwordx4 v[236:239], v2, s[56:59], s6 offen offset:1024 sc1
  s_lshl_b32 s6, s46, 1
  s_add_u32 s6, s6, s67
  v_cvt_pk_bf16_f32 v224, v168, v169
  v_cvt_pk_bf16_f32 v225, v170, v171
  v_cvt_pk_bf16_f32 v226, v172, v173
  v_cvt_pk_bf16_f32 v227, v174, v175
  buffer_store_dwordx4 v[224:227], v2, s[56:59], s6 offen offset:0 sc1
  v_cvt_pk_bf16_f32 v228, v176, v177
  v_cvt_pk_bf16_f32 v229, v178, v179
  v_cvt_pk_bf16_f32 v230, v180, v181
  v_cvt_pk_bf16_f32 v231, v182, v183
  buffer_store_dwordx4 v[228:231], v2, s[56:59], s6 offen offset:1024 sc1
  s_lshl_b32 s6, s47, 1
  s_add_u32 s6, s6, s67
  v_cvt_pk_bf16_f32 v232, v184, v185
  v_cvt_pk_bf16_f32 v233, v186, v187
  v_cvt_pk_bf16_f32 v234, v188, v189
  v_cvt_pk_bf16_f32 v235, v190, v191
  buffer_store_dwordx4 v[232:235], v2, s[56:59], s6 offen offset:0 sc1
  v_cvt_pk_bf16_f32 v236, v192, v193
  v_cvt_pk_bf16_f32 v237, v194, v195
  v_cvt_pk_bf16_f32 v238, v196, v197
  v_cvt_pk_bf16_f32 v239, v198, v199
  buffer_store_dwordx4 v[236:239], v2, s[56:59], s6 offen offset:1024 sc1
  s_lshl_b32 s6, s48, 1
  s_add_u32 s6, s6, s67
  v_cvt_pk_bf16_f32 v224, v200, v201
  v_cvt_pk_bf16_f32 v225, v202, v203
  v_cvt_pk_bf16_f32 v226, v204, v205
  v_cvt_pk_bf16_f32 v227, v206, v207
  buffer_store_dwordx4 v[224:227], v2, s[56:59], s6 offen offset:0 sc1
  v_cvt_pk_bf16_f32 v228, v208, v209
  v_cvt_pk_bf16_f32 v229, v210, v211
  v_cvt_pk_bf16_f32 v230, v212, v213
  v_cvt_pk_bf16_f32 v231, v214, v215
  buffer_store_dwordx4 v[228:231], v2, s[56:59], s6 offen offset:1024 sc1
LW_91:
  ds_read_b32 v5, v16 offset:24
  s_waitcnt lgkmcnt(0)
  v_readfirstlane_b32 s7, v5
  s_cmp_ge_u32 s7, 4
  s_cbranch_scc1 LD_92
  s_sleep 1
  s_branch LW_91
LD_92:
  s_waitcnt vmcnt(0)
  s_mov_b64 exec, 31
  buffer_store_dword v17, v29, s[56:59], s69 offen sc1
  s_mov_b64 exec, -1
  s_setprio 1
  s_and_b32 s6, s4, 1
  s_cmp_lt_u32 s3, 6
  s_cselect_b32 s6, s6, 0
  s_cmp_eq_u32 s6, 0
  s_cbranch_scc1 K6_qe
  s_mov_b32 s48, s38
  s_mov_b32 s49, s39
  s_mov_b32 s50, 2359296
  s_mov_b32 s51, 0x20000
  s_and_b32 s60, s3, 3
  s_lshr_b32 s61, s4, 1
  s_and_b32 s62, s4, 1
  s_mul_i32 s52, s61, 9
  s_lshl_b32 s6, s62, 2
  s_add_u32 s52, s52, s6
  s_cmp_lt_u32 s4, 4
  s_cselect_b32 s53, 12288, 0
  s_mul_i32 s54, s5, 73728
  s_lshl_b32 s6, s52, 5
  s_add_u32 s55, s54, s6
  v_and_b32 v5, 15, v1
  v_lshrrev_b32 v6, 4, v1
  v_mul_u32_u24 v7, 160, v5
  v_lshl_add_u32 v7, v6, 3, v7
  v_add_u32 v7, s53, v7
  v_lshrrev_b32 v8, 1, v6
  v_mul_u32_u24 v8, 18432, v8
  v_bfe_u32 v9, v1, 2, 3
  v_lshl_add_u32 v8, v9, 7, v8
  v_and_b32 v9, 3, v1
  v_lshl_add_u32 v8, v9, 3, v8
  v_add_u32 v8, s53, v8
  v_add_u32 v8, 3072, v8
  v_lshlrev_b32 v11, 4, v5
  v_add_u32 v11, 158720, v11
  v_lshrrev_b32 v5, 5, v1
  v_bfe_u32 v6, v1, 1, 4
  v_and_b32 v9, 1, v1
  v_mul_u32_u24 v18, 18432, v5
  v_lshl_add_u32 v18, v9, 4, v18
  v_mul_u32_u24 v19, 160, v6
  v_add3_u32 v19, v19, v18, s53
  v_mul_u32_u24 v6, 1152, v6
  v_add_u32 v18, v18, v6
  s_cmp_lt_u32 s60, 2
  s_cselect_b32 s63, s62, 0
  s_lshr_b32 s64, s4, 1
  s_lshl_b32 s64, s64, 3
  s_lshr_b32 s64, 0x060e0005, s64
  s_and_b32 s64, s64, 0xff
  s_lshl_b32 s64, s64, 10
  s_and_b32 s7, s3, 3
  s_mul_i32 s7, s7, 18432
  s_add_u32 s64, s64, s7
  v_add_u32 v10, s64, v2
  s_mov_b32 s6, 4
  s_mov_b32 s7, s60
  s_add_u32 s8, s6, s52
  s_mul_i32 s9, s7, 36864
  s_lshr_b32 s10, s8, 1
  s_lshl_b32 s10, s10, 10
  s_and_b32 s11, s8, 1
  s_lshl_b32 s11, s11, 3
  s_add_u32 s10, s10, s11
  s_add_u32 s10, s10, s9
  v_add_u32 v12, s10, v2
  s_lshl_b32 s10, s6, 5
  s_add_u32 s67, s10, s9
  v_add_u32 v13, s67, v7
  s_lshl_b32 s10, s7, 9
  v_add_u32 v14, s10, v11
  s_and_b32 s10, s6, 1
  s_mul_i32 s10, s10, 36864
  s_lshr_b32 s11, s6, 1
  s_lshl_b32 s11, s11, 10
  s_add_u32 s10, s10, s11
  s_lshl_b32 s11, s7, 6
  s_add_u32 s10, s10, s11
  v_add_u32 v15, s10, v8
  ds_read_b64 v[240:241], v12 offset:0
  ds_read_b64 v[244:245], v13 offset:0
  ds_read_b128 v[216:219], v14 offset:0
  ds_read_b64_tr_b16 v[248:249], v15 offset:0
  ds_read_b64 v[242:243], v12 offset:18432
  ds_read_b64 v[246:247], v13 offset:18432
  ds_read_b128 v[220:223], v14 offset:256
  ds_read_b64_tr_b16 v[250:251], v15 offset:32
  s_lshl_b32 s9, s8, 11
  s_lshl_b32 s11, s7, 10
  s_add_u32 s9, s9, s11
  s_add_u32 s9, s9, s54
  s_add_u32 s71, s9, 21102592
  s_lshl_b32 s9, s8, 5
  s_add_u32 s97, s9, s69
  s_waitcnt lgkmcnt(0)
  v_lshlrev_b32 v200, 16, v244
  v_and_b32 v201, 0xffff0000, v244
  v_lshlrev_b32 v192, 16, v240
  v_and_b32 v193, 0xffff0000, v240
  v_lshlrev_b32 v208, 16, v248
  v_and_b32 v209, 0xffff0000, v248
  v_fma_f32 v252, v200, v218, v219
  v_fma_f32 v253, v201, v218, v219
  v_add_f32 v192, v192, v217
  v_add_f32 v193, v193, v217
  v_mul_f32 v208, v208, v252
  v_mul_f32 v209, v209, v253
  v_lshlrev_b32 v202, 16, v245
  v_and_b32 v203, 0xffff0000, v245
  v_lshlrev_b32 v194, 16, v241
  v_and_b32 v195, 0xffff0000, v241
  v_lshlrev_b32 v210, 16, v249
  v_and_b32 v211, 0xffff0000, v249
  v_fma_f32 v252, v202, v218, v219
  v_fma_f32 v253, v203, v218, v219
  v_add_f32 v194, v194, v217
  v_add_f32 v195, v195, v217
  v_mul_f32 v210, v210, v252
  v_mul_f32 v211, v211, v253
  v_lshlrev_b32 v204, 16, v246
  v_and_b32 v205, 0xffff0000, v246
  v_lshlrev_b32 v196, 16, v242
  v_and_b32 v197, 0xffff0000, v242
  v_lshlrev_b32 v212, 16, v250
  v_and_b32 v213, 0xffff0000, v250
  v_fma_f32 v252, v204, v222, v223
  v_fma_f32 v253, v205, v222, v223
  v_add_f32 v196, v196, v221
  v_add_f32 v197, v197, v221
  v_mul_f32 v212, v212, v252
  v_mul_f32 v213, v213, v253
  v_lshlrev_b32 v206, 16, v247
  v_and_b32 v207, 0xffff0000, v247
  v_lshlrev_b32 v198, 16, v243
  v_and_b32 v199, 0xffff0000, v243
  v_lshlrev_b32 v214, 16, v251
  v_and_b32 v215, 0xffff0000, v251
  v_fma_f32 v252, v206, v222, v223
  v_fma_f32 v253, v207, v222, v223
  v_add_f32 v198, v198, v221
  v_add_f32 v199, v199, v221
  v_mul_f32 v214, v214, v252
  v_mul_f32 v215, v215, v253
  v_mov_b32 v184, 0
  v_mov_b32 v185, 0
  v_mov_b32 v186, 0
  v_mov_b32 v187, 0
  v_mov_b32 v188, 0
  v_mov_b32 v189, 0
  v_mov_b32 v190, 0
  v_mov_b32 v191, 0
  s_mov_b32 s13, 0x40000
FP_93:
  s_load_dwordx8 s[16:23], s[42:43], s97 glc
  s_waitcnt lgkmcnt(0)
  s_and_b32 s16, s16, s17
  s_and_b32 s16, s16, s18
  s_cbranch_scc1 FD_94
  s_sleep 1
  s_sub_u32 s13, s13, 1
  s_cbranch_scc0 FP_93
FD_94:
  s_sub_u32 s6, s4, 0
  s_and_b32 s6, s6, 7
  s_mul_i32 s6, s6, 2359296
  s_add_u32 s6, s6, s71
  buffer_load_dwordx4 v[160:163], v2, s[56:59], s6 offen sc1
  s_sub_u32 s6, s4, 1
  s_and_b32 s6, s6, 7
  s_mul_i32 s6, s6, 2359296
  s_add_u32 s6, s6, s71
  buffer_load_dwordx4 v[164:167], v2, s[56:59], s6 offen sc1
  s_sub_u32 s6, s4, 2
  s_and_b32 s6, s6, 7
  s_mul_i32 s6, s6, 2359296
  s_add_u32 s6, s6, s71
  buffer_load_dwordx4 v[168:171], v2, s[56:59], s6 offen sc1
  s_waitcnt vmcnt(0)
  v_lshlrev_b32 v240, 16, v160
  v_and_b32 v241, 0xffff0000, v160
  v_lshlrev_b32 v242, 16, v161
  v_and_b32 v243, 0xffff0000, v161
  v_lshlrev_b32 v244, 16, v162
  v_and_b32 v245, 0xffff0000, v162
  v_lshlrev_b32 v246, 16, v163
  v_and_b32 v247, 0xffff0000, v163
  v_pk_add_f32 v[184:185], v[184:185], v[240:241]
  v_pk_add_f32 v[186:187], v[186:187], v[242:243]
  v_pk_add_f32 v[188:189], v[188:189], v[244:245]
  v_pk_add_f32 v[190:191], v[190:191], v[246:247]
  v_lshlrev_b32 v240, 16, v164
  v_and_b32 v241, 0xffff0000, v164
  v_lshlrev_b32 v242, 16, v165
  v_and_b32 v243, 0xffff0000, v165
  v_lshlrev_b32 v244, 16, v166
  v_and_b32 v245, 0xffff0000, v166
  v_lshlrev_b32 v246, 16, v167
  v_and_b32 v247, 0xffff0000, v167
  v_pk_add_f32 v[184:185], v[184:185], v[240:241]
  v_pk_add_f32 v[186:187], v[186:187], v[242:243]
  v_pk_add_f32 v[188:189], v[188:189], v[244:245]
  v_pk_add_f32 v[190:191], v[190:191], v[246:247]
  v_lshlrev_b32 v240, 16, v168
  v_and_b32 v241, 0xffff0000, v168
  v_lshlrev_b32 v242, 16, v169
  v_and_b32 v243, 0xffff0000, v169
  v_lshlrev_b32 v244, 16, v170
  v_and_b32 v245, 0xffff0000, v170
  v_lshlrev_b32 v246, 16, v171
  v_and_b32 v247, 0xffff0000, v171
  v_pk_add_f32 v[184:185], v[184:185], v[240:241]
  v_pk_add_f32 v[186:187], v[186:187], v[242:243]
  v_pk_add_f32 v[188:189], v[188:189], v[244:245]
  v_pk_add_f32 v[190:191], v[190:191], v[246:247]
  s_mov_b32 s13, 0x40000
FP_95:
  s_load_dwordx8 s[16:23], s[42:43], s97 glc
  s_waitcnt lgkmcnt(0)
  s_and_b32 s19, s19, s20
  s_and_b32 s19, s19, s21
  s_and_b32 s19, s19, s22
  s_and_b32 s19, s19, s23
  s_cbranch_scc1 FD_96
  s_sleep 1
  s_sub_u32 s13, s13, 1
  s_cbranch_scc0 FP_95
FD_96:
  s_sub_u32 s6, s4, 3
  s_and_b32 s6, s6, 7
  s_mul_i32 s6, s6, 2359296
  s_add_u32 s6, s6, s71
  buffer_load_dwordx4 v[160:163], v2, s[56:59], s6 offen sc1
  s_sub_u32 s6, s4, 4
  s_and_b32 s6, s6, 7
  s_mul_i32 s6, s6, 2359296
  s_add_u32 s6, s6, s71
  buffer_load_dwordx4 v[164:167], v2, s[56:59], s6 offen sc1
  s_sub_u32 s6, s4, 5
  s_and_b32 s6, s6, 7
  s_mul_i32 s6, s6, 2359296
  s_add_u32 s6, s6, s71
  buffer_load_dwordx4 v[168:171], v2, s[56:59], s6 offen sc1
  s_sub_u32 s6, s4, 6
  s_and_b32 s6, s6, 7
  s_mul_i32 s6, s6, 2359296
  s_add_u32 s6, s6, s71
  buffer_load_dwordx4 v[172:175], v2, s[56:59], s6 offen sc1
  s_sub_u32 s6, s4, 7
  s_and_b32 s6, s6, 7
  s_mul_i32 s6, s6, 2359296
  s_add_u32 s6, s6, s71
  buffer_load_dwordx4 v[176:179], v2, s[56:59], s6 offen sc1
  s_waitcnt vmcnt(0)
  v_lshlrev_b32 v240, 16, v160
  v_and_b32 v241, 0xffff0000, v160
  v_lshlrev_b32 v242, 16, v161
  v_and_b32 v243, 0xffff0000, v161
  v_lshlrev_b32 v244, 16, v162
  v_and_b32 v245, 0xffff0000, v162
  v_lshlrev_b32 v246, 16, v163
  v_and_b32 v247, 0xffff0000, v163
  v_pk_add_f32 v[184:185], v[184:185], v[240:241]
  v_pk_add_f32 v[186:187], v[186:187], v[242:243]
  v_pk_add_f32 v[188:189], v[188:189], v[244:245]
  v_pk_add_f32 v[190:191], v[190:191], v[246:247]
  v_lshlrev_b32 v240, 16, v164
  v_and_b32 v241, 0xffff0000, v164
  v_lshlrev_b32 v242, 16, v165
  v_and_b32 v243, 0xffff0000, v165
  v_lshlrev_b32 v244, 16, v166
  v_and_b32 v245, 0xffff0000, v166
  v_lshlrev_b32 v246, 16, v167
  v_and_b32 v247, 0xffff0000, v167
  v_pk_add_f32 v[184:185], v[184:185], v[240:241]
  v_pk_add_f32 v[186:187], v[186:187], v[242:243]
  v_pk_add_f32 v[188:189], v[188:189], v[244:245]
  v_pk_add_f32 v[190:191], v[190:191], v[246:247]
  v_lshlrev_b32 v240, 16, v168
  v_and_b32 v241, 0xffff0000, v168
  v_lshlrev_b32 v242, 16, v169
  v_and_b32 v243, 0xffff0000, v169
  v_lshlrev_b32 v244, 16, v170
  v_and_b32 v245, 0xffff0000, v170
  v_lshlrev_b32 v246, 16, v171
  v_and_b32 v247, 0xffff0000, v171
  v_pk_add_f32 v[184:185], v[184:185], v[240:241]
  v_pk_add_f32 v[186:187], v[186:187], v[242:243]
  v_pk_add_f32 v[188:189], v[188:189], v[244:245]
  v_pk_add_f32 v[190:191], v[190:191], v[246:247]
  v_lshlrev_b32 v240, 16, v172
  v_and_b32 v241, 0xffff0000, v172
  v_lshlrev_b32 v242, 16, v173
  v_and_b32 v243, 0xffff0000, v173
  v_lshlrev_b32 v244, 16, v174
  v_and_b32 v245, 0xffff0000, v174
  v_lshlrev_b32 v246, 16, v175
  v_and_b32 v247, 0xffff0000, v175
  v_pk_add_f32 v[184:185], v[184:185], v[240:241]
  v_pk_add_f32 v[186:187], v[186:187], v[242:243]
  v_pk_add_f32 v[188:189], v[188:189], v[244:245]
  v_pk_add_f32 v[190:191], v[190:191], v[246:247]
  v_lshlrev_b32 v240, 16, v176
  v_and_b32 v241, 0xffff0000, v176
  v_lshlrev_b32 v242, 16, v177
  v_and_b32 v243, 0xffff0000, v177
  v_lshlrev_b32 v244, 16, v178
  v_and_b32 v245, 0xffff0000, v178
  v_lshlrev_b32 v246, 16, v179
  v_and_b32 v247, 0xffff0000, v179
  v_pk_add_f32 v[184:185], v[184:185], v[240:241]
  v_pk_add_f32 v[186:187], v[186:187], v[242:243]
  v_pk_add_f32 v[188:189], v[188:189], v[244:245]
  v_pk_add_f32 v[190:191], v[190:191], v[246:247]
  v_fma_f32 v184, v184, v216, v192
  v_fma_f32 v185, v185, v216, v193
  v_fma_f32 v186, v186, v216, v194
  v_fma_f32 v187, v187, v216, v195
  v_fma_f32 v188, v188, v220, v196
  v_fma_f32 v189, v189, v220, v197
  v_fma_f32 v190, v190, v220, v198
  v_fma_f32 v191, v191, v220, v199
  v_mul_f32 v160, 0xbfb8aa3b, v184
  v_mul_f32 v161, 0xbfb8aa3b, v185
  v_mul_f32 v162, 0xbfb8aa3b, v186
  v_mul_f32 v163, 0xbfb8aa3b, v187
  v_mul_f32 v164, 0xbfb8aa3b, v188
  v_mul_f32 v165, 0xbfb8aa3b, v189
  v_mul_f32 v166, 0xbfb8aa3b, v190
  v_mul_f32 v167, 0xbfb8aa3b, v191
  v_exp_f32 v160, v160
  v_exp_f32 v161, v161
  v_exp_f32 v162, v162
  v_exp_f32 v163, v163
  v_exp_f32 v164, v164
  v_exp_f32 v165, v165
  v_exp_f32 v166, v166
  v_exp_f32 v167, v167
  v_add_f32 v160, 1.0, v160
  v_add_f32 v161, 1.0, v161
  v_add_f32 v162, 1.0, v162
  v_add_f32 v163, 1.0, v163
  v_add_f32 v164, 1.0, v164
  v_add_f32 v165, 1.0, v165
  v_add_f32 v166, 1.0, v166
  v_add_f32 v167, 1.0, v167
  v_rcp_f32 v160, v160
  v_rcp_f32 v161, v161
  v_rcp_f32 v162, v162
  v_rcp_f32 v163, v163
  v_rcp_f32 v164, v164
  v_rcp_f32 v165, v165
  v_rcp_f32 v166, v166
  v_rcp_f32 v167, v167
  v_mul_f32 v184, v184, v208
  v_mul_f32 v185, v185, v209
  v_mul_f32 v186, v186, v210
  v_mul_f32 v187, v187, v211
  v_mul_f32 v188, v188, v212
  v_mul_f32 v189, v189, v213
  v_mul_f32 v190, v190, v214
  v_mul_f32 v191, v191, v215
  v_fma_f32 v184, v184, v160, v200
  v_fma_f32 v185, v185, v161, v201
  v_fma_f32 v186, v186, v162, v202
  v_fma_f32 v187, v187, v163, v203
  v_fma_f32 v188, v188, v164, v204
  v_fma_f32 v189, v189, v165, v205
  v_fma_f32 v190, v190, v166, v206
  v_fma_f32 v191, v191, v167, v207
  v_cvt_pk_bf16_f32 v168, v184, v185
  v_cvt_pk_bf16_f32 v169, v186, v187
  v_cvt_pk_bf16_f32 v170, v188, v189
  v_cvt_pk_bf16_f32 v171, v190, v191
  v_add_u32 v13, s67, v7
  v_add_u32 v20, s67, v19
  s_add_u32 s67, s67, s55
  ds_write_b64 v13, v[168:169] offset:0
  ds_write_b64 v13, v[170:171] offset:18432
  ds_read_b128 v[172:175], v20
  s_waitcnt lgkmcnt(0)
  buffer_store_dwordx4 v[172:175], v18, s[48:51], s67 offen
K6_qe:
  s_endpgm
K6_end:
  s_endpgm
CODE_END:
.section .rodata,"a"
.p2align 6
.amdhsa_kernel recurrent_scan__ssm_conv_h3__mixer_s_mlp__prompt_kernel
  .amdhsa_next_free_vgpr 256
  .amdhsa_next_free_sgpr 102
  .amdhsa_accum_offset 256
  .amdhsa_group_segment_fixed_size 0
  .amdhsa_kernarg_size 112
  .amdhsa_user_sgpr_count 2
  .amdhsa_user_sgpr_kernarg_segment_ptr 1
  .amdhsa_system_sgpr_workgroup_id_x 1
  .amdhsa_float_denorm_mode_32 3
.end_amdhsa_kernel
```
